```python
import torch

def _softmax(x, axis=-1):
    return torch.softmax(x, dim=axis)
def _gelu(x):
    return torch.nn.functional.gelu(x, approximate="tanh")
def _silu(x):
    return torch.nn.functional.silu(x)
def _sigmoid(x):
    return torch.sigmoid(x)
def _layernorm(x, axis=-1, eps=1e-5):
    m = x.mean(dim=axis, keepdim=True)
    v = x.var(dim=axis, keepdim=True, unbiased=False)
    return (x - m) / torch.sqrt(v + eps)
def _scatter_add(tgt, idx, src, axis=0):
    return tgt.clone().index_add_(axis, idx, src)
def _segment_sum(src, seg, n):
    out = torch.zeros((n,) + src.shape[1:], dtype=src.dtype)
    return out.index_add_(0, seg, src)
def _pad(x, pw):
    flat = tuple(v for pair in reversed(pw) for v in pair)
    return torch.nn.functional.pad(x, flat)

kernel_name = 'interleave_layers__sliding_block__moe_arch_mod__prompt'

def setup_inputs():

    _w = (lambda a: (lambda t: t.to(torch.bfloat16) if t.is_floating_point() else t)(torch.as_tensor(a)))
    def _A_setup():
        B, S, D = 1, 2048, 512
        return {
            "x": _w((lambda *s: torch.randn(*s, dtype=torch.bfloat16) * 0.05)(B, S, D)),
            "wqkv": _w((lambda *s: torch.randn(*s, dtype=torch.bfloat16) * 0.05)(D, 3 * D)),
            "wo": _w((lambda *s: torch.randn(*s, dtype=torch.bfloat16) * 0.05)(D, D)),
        }
    _A_in = _A_setup()

    def _B_setup():
        B, S, D, F, C = 1, 2048, 512, 1792, 1
        return {
            "x": _w((lambda *s: torch.randn(*s, dtype=torch.bfloat16) * 0.05)(B, S, D)),
            "w_r": _w((lambda *s: torch.randn(*s, dtype=torch.bfloat16) * 0.05)(D)),
            "w_gate": _w((lambda *s: torch.randn(*s, dtype=torch.bfloat16) * 0.05)(D, F)),
            "w_up": _w((lambda *s: torch.randn(*s, dtype=torch.bfloat16) * 0.05)(D, F)),
            "w_down": _w((lambda *s: torch.randn(*s, dtype=torch.bfloat16) * 0.05)(F, D)),
        }
    _B_in = _B_setup()

    return {
        "A_x": _A_in["x"],
        "A_wqkv": _A_in["wqkv"],
        "A_wo": _A_in["wo"],
        "B_x": _B_in["x"],
        "B_w_r": _B_in["w_r"],
        "B_w_gate": _B_in["w_gate"],
        "B_w_up": _B_in["w_up"],
        "B_w_down": _B_in["w_down"],
    }

def reference(A_x, A_wqkv, A_wo, B_x, B_w_r, B_w_gate, B_w_up, B_w_down):
    def _A_ref(x, wqkv, wo):
        B, S, D = x.shape
        H = 32; Dh = D // H; W = 256
        qkv = (lambda x, *d: x.permute(*d))((x @ wqkv).reshape(B, S, 3, H, Dh), 2, 0, 3, 1, 4)
        q, k, v = qkv[0], qkv[1], qkv[2]
        scores = torch.einsum("bhqd,bhkd->bhqk", q, k) * (Dh ** -0.5)
        idx = torch.arange(S)
        mask = (idx[:, None] - idx[None, :] >= 0) & (idx[:, None] - idx[None, :] < W)
        scores = torch.where(mask[None, None], scores, -1e9)
        p = _softmax(scores, axis=-1)
        o = torch.einsum("bhqk,bhkd->bhqd", p, v)
        return (lambda x, *d: x.permute(*d))(o, 0, 2, 1, 3).reshape(B, S, D) @ wo

    def _B_ref(x, w_r, w_gate, w_up, w_down):
        B, S, D = x.shape
        C = 1
        r = x @ w_r
        idx = torch.argsort(-r, axis=-1)[:, :C]
        idx_e = (lambda x, n, axis: torch.repeat_interleave(x, n, dim=axis))(idx.reshape(B, C, 1), D, axis=2)
        x_sel = (lambda x, i, axis: torch.take_along_dim(x, i, dim=axis))(x, idx_e, axis=1)
        g = _silu(x_sel @ w_gate)
        u = x_sel @ w_up
        y = (g * u) @ w_down
        r_sel = _sigmoid((lambda x, i, axis: torch.take_along_dim(x, i, dim=axis))(r, idx, axis=1))
        y = y * r_sel.reshape(B, C, 1)
        b_off = (torch.arange(B) * S).reshape(B, 1)
        flat_idx = (idx + b_off).reshape(B * C)
        zero = (x * 0.0).reshape(B * S, D)
        upd = _scatter_add(zero, flat_idx, y.reshape(B * C, D), axis=0)
        return x + upd.reshape(B, S, D)

    x = A_x
    x = x + _A_ref(_layernorm(x, axis=-1), A_wqkv, A_wo)
    x = x + _B_ref(_layernorm(x, axis=-1), B_w_r, B_w_gate, B_w_up, B_w_down)
    x = x + _A_ref(_layernorm(x, axis=-1), A_wqkv, A_wo)
    x = x + _B_ref(_layernorm(x, axis=-1), B_w_r, B_w_gate, B_w_up, B_w_down)
    return x
```

```asm
; @launch grid=(256,1,1) block=(256,1,1) lds=163840
.amdgcn_target "amdgcn-amd-amdhsa--gfx950"
.text
.globl interleave_layers__sliding_block__moe_arch_mod__prompt_kernel
.p2align 8
.type interleave_layers__sliding_block__moe_arch_mod__prompt_kernel,@function
interleave_layers__sliding_block__moe_arch_mod__prompt_kernel:
K_START:
    s_cmp_ge_u32 s2, 256
    s_cbranch_scc1 K_END
    s_load_dwordx16 s[48:63], s[0:1], 0
    s_load_dwordx4 s[64:67], s[0:1], 64
    s_load_dwordx2 s[68:69], s[0:1], 80
    s_getpc_b64 s[70:71]
K_PC:
    v_lshlrev_b32 v50, 7, v0
    s_mov_b32 s25, K_END-K_PC
    v_min_u32 v51, s25, v50
    global_load_dword v49, v51, s[70:71]
    v_add_u32 v50, 0x8000, v50
    v_min_u32 v51, s25, v50
    global_load_dword v49, v51, s[70:71]
    v_and_b32 v1, 63, v0
    v_lshrrev_b32 v40, 6, v0
    s_and_b32 s20, s2, 7
    v_readfirstlane_b32 s22, v40
    s_lshr_b32 s21, s2, 3
    v_and_b32 v13, 15, v1
    v_lshrrev_b32 v25, 4, v1
    v_lshlrev_b32 v7, 4, v1
    v_lshlrev_b32 v8, 4, v0
    s_and_b32 s34, s22, 1
    s_lshr_b32 s35, s22, 1
    s_and_b32 s25, s21, 1
    s_lshl_b32 s36, s20, 1
    s_add_u32 s36, s36, s25
    s_lshr_b32 s45, s21, 1
    s_xor_b32 s45, s45, 0
    s_mul_i32 s46, s20, 7
    s_add_u32 s46, s46, s21
    s_sub_u32 s46, s46, 1
    v_lshrrev_b32 v40, 3, v1
    v_lshlrev_b32 v40, 10, v40
    v_and_b32 v41, 7, v1
    v_xor_b32 v42, v41, v25
    v_lshl_add_u32 v2, v42, 4, v40
    v_xor_b32 v42, 4, v42
    v_lshl_add_u32 v3, v42, 4, v40
    v_add_u32 v3, 7168, v3
    v_lshrrev_b32 v40, 1, v13
    v_xor_b32 v40, v40, v25
    v_lshlrev_b32 v40, 4, v40
    v_lshl_add_u32 v40, v13, 7, v40
    s_lshl_b32 s25, s35, 14
    v_add_u32 v4, s25, v40
    v_xor_b32 v5, 64, v4
    v_lshrrev_b32 v40, 2, v13
    v_lshl_add_u32 v6, v25, 3, v40
    v_and_b32 v40, 3, v13
    v_lshlrev_b32 v9, 3, v40
    v_lshrrev_b32 v40, 1, v25
    v_lshlrev_b32 v40, 11, v40
    v_and_b32 v41, 1, v25
    v_lshl_add_u32 v40, v41, 3, v40
    v_lshl_add_u32 v40, v13, 4, v40
    s_lshl_b32 s25, s34, 12
    s_lshl_b32 s26, s35, 10
    s_add_u32 s25, s25, s26
    s_add_u32 s25, s25, 131072
    v_add_u32 v11, s25, v40
    s_lshl_b32 s25, s35, 3
    v_and_b32 v41, 1, v25
    v_add_u32 v41, s25, v41
    v_xor_b32 v41, v41, v13
    v_lshlrev_b32 v41, 4, v41
    v_lshl_add_u32 v41, v13, 8, v41
    v_lshrrev_b32 v40, 1, v25
    v_lshl_add_u32 v41, v40, 3, v41
    s_lshl_b32 s25, s34, 13
    s_add_u32 s25, s25, 143360
    v_add_u32 v12, s25, v41
    s_waitcnt lgkmcnt(0)
    s_mov_b32 s4, s48
    s_and_b32 s5, s49, 0xffff
    s_mov_b32 s6, 0x200000
    s_mov_b32 s7, 0x20000
    s_mov_b32 s8, s68
    s_and_b32 s9, s69, 0xffff
    s_mov_b32 s10, 0x1200000
    s_mov_b32 s11, 0x20000
    s_mov_b32 s12, s50
    s_and_b32 s13, s51, 0xffff
    s_mov_b32 s14, 0x180000
    s_mov_b32 s15, 0x20000
    s_lshl_b32 s25, s20, 8
    s_lshl_b32 s26, s21, 3
    s_add_u32 s25, s25, s26
    s_lshl_b32 s26, s22, 1
    s_add_u32 s43, s25, s26
    s_lshl_b32 s25, s43, 10
    buffer_load_dwordx4 v[40:43], v7, s[4:7], s25 offen
    buffer_load_dwordx4 v[44:47], v7, s[4:7], s25 offen offset:1024
    buffer_load_dword v48, off, s[8:11], 0 sc1
    v_lshrrev_b32 v52, 2, v1
    s_mov_b32 s25, 3072
    v_mul_lo_u32 v52, v52, s25
    v_and_b32 v53, 3, v1
    v_lshrrev_b32 v54, 5, v1
    v_lshlrev_b32 v54, 1, v54
    v_xor_b32 v53, v53, v54
    v_lshl_add_u32 v52, v53, 4, v52
    s_mov_b32 s29, s22
    s_mul_i32 s26, s29, 393216
    s_lshl_b32 s27, s45, 6
    s_add_u32 s26, s26, s27
    s_lshl_b32 s27, s29, 13
    s_add_u32 s27, s27, 32768
    s_add_u32 m0, s27, 0
    s_add_u32 s28, s26, 0
    buffer_load_dwordx4 v52, s[12:15], s28 offen lds
    s_add_u32 m0, s27, 1024
    s_add_u32 s28, s26, 49152
    buffer_load_dwordx4 v52, s[12:15], s28 offen lds
    s_add_u32 m0, s27, 32768
    s_add_u32 s28, s26, 1024
    buffer_load_dwordx4 v52, s[12:15], s28 offen lds
    s_add_u32 m0, s27, 33792
    s_add_u32 s28, s26, 50176
    buffer_load_dwordx4 v52, s[12:15], s28 offen lds
    s_add_u32 m0, s27, 65536
    s_add_u32 s28, s26, 2048
    buffer_load_dwordx4 v52, s[12:15], s28 offen lds
    s_add_u32 m0, s27, 66560
    s_add_u32 s28, s26, 51200
    buffer_load_dwordx4 v52, s[12:15], s28 offen lds
    s_add_u32 m0, s27, 2048
    s_add_u32 s28, s26, 98304
    buffer_load_dwordx4 v52, s[12:15], s28 offen lds
    s_add_u32 m0, s27, 3072
    s_add_u32 s28, s26, 147456
    buffer_load_dwordx4 v52, s[12:15], s28 offen lds
    s_add_u32 m0, s27, 34816
    s_add_u32 s28, s26, 99328
    buffer_load_dwordx4 v52, s[12:15], s28 offen lds
    s_add_u32 m0, s27, 35840
    s_add_u32 s28, s26, 148480
    buffer_load_dwordx4 v52, s[12:15], s28 offen lds
    s_add_u32 m0, s27, 67584
    s_add_u32 s28, s26, 100352
    buffer_load_dwordx4 v52, s[12:15], s28 offen lds
    s_add_u32 m0, s27, 68608
    s_add_u32 s28, s26, 149504
    buffer_load_dwordx4 v52, s[12:15], s28 offen lds
    s_add_u32 m0, s27, 4096
    s_add_u32 s28, s26, 196608
    buffer_load_dwordx4 v52, s[12:15], s28 offen lds
    s_add_u32 m0, s27, 5120
    s_add_u32 s28, s26, 245760
    buffer_load_dwordx4 v52, s[12:15], s28 offen lds
    s_add_u32 m0, s27, 36864
    s_add_u32 s28, s26, 197632
    buffer_load_dwordx4 v52, s[12:15], s28 offen lds
    s_add_u32 m0, s27, 37888
    s_add_u32 s28, s26, 246784
    buffer_load_dwordx4 v52, s[12:15], s28 offen lds
    s_add_u32 m0, s27, 69632
    s_add_u32 s28, s26, 198656
    buffer_load_dwordx4 v52, s[12:15], s28 offen lds
    s_add_u32 m0, s27, 70656
    s_add_u32 s28, s26, 247808
    buffer_load_dwordx4 v52, s[12:15], s28 offen lds
    s_add_u32 m0, s27, 6144
    s_add_u32 s28, s26, 294912
    buffer_load_dwordx4 v52, s[12:15], s28 offen lds
    s_add_u32 m0, s27, 7168
    s_add_u32 s28, s26, 344064
    buffer_load_dwordx4 v52, s[12:15], s28 offen lds
    s_add_u32 m0, s27, 38912
    s_add_u32 s28, s26, 295936
    buffer_load_dwordx4 v52, s[12:15], s28 offen lds
    s_add_u32 m0, s27, 39936
    s_add_u32 s28, s26, 345088
    buffer_load_dwordx4 v52, s[12:15], s28 offen lds
    s_add_u32 m0, s27, 71680
    s_add_u32 s28, s26, 296960
    buffer_load_dwordx4 v52, s[12:15], s28 offen lds
    s_add_u32 m0, s27, 72704
    s_add_u32 s28, s26, 346112
    buffer_load_dwordx4 v52, s[12:15], s28 offen lds
    s_mov_b32 s16, s4
    s_mov_b32 s17, s5
    s_mov_b32 s18, s6
    s_mov_b32 s19, 0x20000
    s_lshl_b32 s25, s36, 7
    s_lshl_b32 s26, s35, 6
    s_add_u32 s25, s25, s26
    s_lshl_b32 s25, s25, 10
    s_lshl_b32 s26, s34, 9
    s_add_u32 s37, s25, s26
    s_mov_b32 s39, 128
    s_mov_b32 s38, 15872
    s_mov_b32 s40, s37
    s_lshl_b32 s47, s35, 14
    s_lshl_b32 s25, s34, 13
    s_add_u32 s47, s47, s25
    s_add_u32 m0, s47, 0
    s_nop 0
    buffer_load_dwordx4 v2, s[16:19], s40 offen sc1 lds
    buffer_load_dwordx4 v3, s[16:19], s40 offen offset:1024 sc1 lds
    s_add_u32 s40, s40, s39
    s_add_u32 m0, s47, 2048
    s_nop 0
    buffer_load_dwordx4 v2, s[16:19], s40 offen sc1 lds
    buffer_load_dwordx4 v3, s[16:19], s40 offen offset:1024 sc1 lds
    s_add_u32 s40, s40, s39
    s_add_u32 m0, s47, 4096
    s_nop 0
    buffer_load_dwordx4 v2, s[16:19], s40 offen sc1 lds
    buffer_load_dwordx4 v3, s[16:19], s40 offen offset:1024 sc1 lds
    s_add_u32 s40, s40, s39
    s_add_u32 m0, s47, 6144
    s_nop 0
    buffer_load_dwordx4 v2, s[16:19], s40 offen sc1 lds
    buffer_load_dwordx4 v3, s[16:19], s40 offen offset:1024 sc1 lds
    s_add_u32 s40, s40, s39
    s_add_u32 s40, s40, s38
    v_lshlrev_b32 v53, 21, v1
    v_mov_b32 v215, 0
    buffer_load_dword v49, v53, s[8:11], 0 offen
    s_mov_b32 s12, s56
    s_and_b32 s13, s57, 0xffff
    s_mov_b32 s14, 0x400
    s_mov_b32 s15, 0x20000
    buffer_load_dword v49, off, s[12:15], 0
    s_mov_b32 s12, s64
    s_and_b32 s13, s65, 0xffff
    s_mov_b32 s14, 0x200000
    s_mov_b32 s15, 0x20000
    buffer_load_dword v49, off, s[12:15], 0
    s_cmp_eq_u32 s22, 1
    s_cselect_b32 s12, s60, s58
    s_cselect_b32 s13, s61, s59
    s_cmp_eq_u32 s22, 2
    s_cselect_b32 s12, s62, s12
    s_cselect_b32 s13, s63, s13
    s_cmp_eq_u32 s22, 3
    s_cselect_b32 s12, s52, s12
    s_cselect_b32 s13, s53, s13
    s_mov_b32 s14, 0x1c0000
    s_cselect_b32 s14, 0x80000, s14
    s_mov_b32 s25, 7168
    s_cselect_b32 s25, 0x800, s25
    s_and_b32 s13, s13, 0xffff
    s_mov_b32 s15, 0x20000
    s_mul_i32 s26, s2, s25
    v_lshlrev_b32 v53, 7, v1
    s_sub_u32 s25, s25, 128
    v_min_u32 v53, s25, v53
    buffer_load_dword v49, v53, s[12:15], s26 offen
    s_waitcnt vmcnt(36)
    v_readfirstlane_b32 s25, v48
    s_nop 1
    s_mul_i32 s25, s25, 0x9E3779B1
    s_add_u32 s23, s25, 0x7F4A7C15
    v_lshlrev_b32 v56, 16, v40
    v_and_b32 v57, 0xffff0000, v40
    v_lshlrev_b32 v64, 16, v44
    v_and_b32 v65, 0xffff0000, v44
    v_lshlrev_b32 v58, 16, v41
    v_and_b32 v59, 0xffff0000, v41
    v_lshlrev_b32 v66, 16, v45
    v_and_b32 v67, 0xffff0000, v45
    v_lshlrev_b32 v60, 16, v42
    v_and_b32 v61, 0xffff0000, v42
    v_lshlrev_b32 v68, 16, v46
    v_and_b32 v69, 0xffff0000, v46
    v_lshlrev_b32 v62, 16, v43
    v_and_b32 v63, 0xffff0000, v43
    v_lshlrev_b32 v70, 16, v47
    v_and_b32 v71, 0xffff0000, v47
    v_add_f32 v72, v56, v57
    v_mul_f32 v73, v56, v56
    v_fmac_f32 v73, v57, v57
    v_add_f32 v72, v72, v58
    v_fmac_f32 v73, v58, v58
    v_add_f32 v72, v72, v59
    v_fmac_f32 v73, v59, v59
    v_add_f32 v72, v72, v60
    v_fmac_f32 v73, v60, v60
    v_add_f32 v72, v72, v61
    v_fmac_f32 v73, v61, v61
    v_add_f32 v72, v72, v62
    v_fmac_f32 v73, v62, v62
    v_add_f32 v72, v72, v63
    v_fmac_f32 v73, v63, v63
    v_add_f32 v74, v64, v65
    v_mul_f32 v75, v64, v64
    v_fmac_f32 v75, v65, v65
    v_add_f32 v74, v74, v66
    v_fmac_f32 v75, v66, v66
    v_add_f32 v74, v74, v67
    v_fmac_f32 v75, v67, v67
    v_add_f32 v74, v74, v68
    v_fmac_f32 v75, v68, v68
    v_add_f32 v74, v74, v69
    v_fmac_f32 v75, v69, v69
    v_add_f32 v74, v74, v70
    v_fmac_f32 v75, v70, v70
    v_add_f32 v74, v74, v71
    v_fmac_f32 v75, v71, v71
    v_add_f32_dpp v72, v72, v72 quad_perm:[1,0,3,2] row_mask:0xf bank_mask:0xf
    v_add_f32_dpp v73, v73, v73 quad_perm:[1,0,3,2] row_mask:0xf bank_mask:0xf
    v_add_f32_dpp v74, v74, v74 quad_perm:[1,0,3,2] row_mask:0xf bank_mask:0xf
    v_add_f32_dpp v75, v75, v75 quad_perm:[1,0,3,2] row_mask:0xf bank_mask:0xf
    v_add_f32_dpp v72, v72, v72 quad_perm:[2,3,0,1] row_mask:0xf bank_mask:0xf
    v_add_f32_dpp v73, v73, v73 quad_perm:[2,3,0,1] row_mask:0xf bank_mask:0xf
    v_add_f32_dpp v74, v74, v74 quad_perm:[2,3,0,1] row_mask:0xf bank_mask:0xf
    v_add_f32_dpp v75, v75, v75 quad_perm:[2,3,0,1] row_mask:0xf bank_mask:0xf
    v_add_f32_dpp v72, v72, v72 row_half_mirror row_mask:0xf bank_mask:0xf
    v_add_f32_dpp v73, v73, v73 row_half_mirror row_mask:0xf bank_mask:0xf
    v_add_f32_dpp v74, v74, v74 row_half_mirror row_mask:0xf bank_mask:0xf
    v_add_f32_dpp v75, v75, v75 row_half_mirror row_mask:0xf bank_mask:0xf
    v_add_f32_dpp v72, v72, v72 row_mirror row_mask:0xf bank_mask:0xf
    v_add_f32_dpp v73, v73, v73 row_mirror row_mask:0xf bank_mask:0xf
    v_add_f32_dpp v74, v74, v74 row_mirror row_mask:0xf bank_mask:0xf
    v_add_f32_dpp v75, v75, v75 row_mirror row_mask:0xf bank_mask:0xf
    v_mov_b32 v76, v72
    v_mov_b32 v77, v73
    v_mov_b32 v78, v74
    v_mov_b32 v79, v75
    v_permlane16_swap_b32 v72, v76
    v_permlane16_swap_b32 v73, v77
    v_permlane16_swap_b32 v74, v78
    v_permlane16_swap_b32 v75, v79
    v_add_f32 v72, v72, v76
    v_add_f32 v73, v73, v77
    v_add_f32 v74, v74, v78
    v_add_f32 v75, v75, v79
    v_mov_b32 v76, v72
    v_mov_b32 v77, v73
    v_mov_b32 v78, v74
    v_mov_b32 v79, v75
    v_permlane32_swap_b32 v72, v76
    v_permlane32_swap_b32 v73, v77
    v_permlane32_swap_b32 v74, v78
    v_permlane32_swap_b32 v75, v79
    v_add_f32 v72, v72, v76
    v_add_f32 v73, v73, v77
    v_add_f32 v74, v74, v78
    v_add_f32 v75, v75, v79
    s_mov_b32 s25, 0x3b000000
    s_mov_b32 s26, 0x3727c5ac
    v_mul_f32 v80, s25, v72
    v_mul_f32 v73, s25, v73
    v_fma_f32 v73, -v80, v80, v73
    v_add_f32 v73, s26, v73
    v_rsq_f32 v81, v73
    v_mov_b32 v83, s23
    v_mov_b32 v82, v81
    v_mul_f32 v84, s25, v74
    v_mul_f32 v75, s25, v75
    v_fma_f32 v75, -v84, v84, v75
    v_add_f32 v75, s26, v75
    v_rsq_f32 v85, v75
    v_mov_b32 v87, s23
    v_mov_b32 v86, v85
    v_cmp_eq_u32 vcc, 1, v1
    s_nop 1
    v_cndmask_b32 v80, v80, v84, vcc
    v_cndmask_b32 v81, v81, v85, vcc
    v_cndmask_b32 v82, v82, v86, vcc
    s_lshl_b32 s25, s43, 4
    s_add_u32 s25, s25, 0x48000
    s_mov_b64 exec, 3
    buffer_store_dwordx4 v[80:83], v7, s[8:11], s25 offen sc1
    s_mov_b64 exec, 15
    v_mov_b32 v84, 0
    v_mov_b32 v85, 0
    v_mov_b32 v86, 0
    v_mov_b32 v87, 0
    s_lshl_b32 s25, s2, 6
    s_add_u32 s25, s25, 0xe2000
    buffer_store_dwordx4 v[84:87], v7, s[8:11], s25 offen sc1
    s_mov_b64 exec, -1
    v_lshlrev_b32 v52, 6, v6
    v_add_u32 v52, v52, v9
    v_and_b32 v53, 1, v25
    v_xor_b32 v53, s34, v53
    v_lshl_add_u32 v52, v53, 5, v52
    v_add_u32 v52, 32768, v52
    s_waitcnt vmcnt(14)
    s_barrier
    ds_read_b64_tr_b16 a[0:1], v52 offset:0
    ds_read_b64_tr_b16 a[2:3], v52 offset:256
    ds_read_b64_tr_b16 a[12:13], v52 offset:2048
    ds_read_b64_tr_b16 a[14:15], v52 offset:2304
    ds_read_b64_tr_b16 a[24:25], v52 offset:4096
    ds_read_b64_tr_b16 a[26:27], v52 offset:4352
    ds_read_b64_tr_b16 a[36:37], v52 offset:6144
    ds_read_b64_tr_b16 a[38:39], v52 offset:6400
    ds_read_b64_tr_b16 a[48:49], v52 offset:8192
    ds_read_b64_tr_b16 a[50:51], v52 offset:8448
    ds_read_b64_tr_b16 a[60:61], v52 offset:10240
    ds_read_b64_tr_b16 a[62:63], v52 offset:10496
    ds_read_b64_tr_b16 a[72:73], v52 offset:12288
    ds_read_b64_tr_b16 a[74:75], v52 offset:12544
    ds_read_b64_tr_b16 a[84:85], v52 offset:14336
    ds_read_b64_tr_b16 a[86:87], v52 offset:14592
    ds_read_b64_tr_b16 a[96:97], v52 offset:16384
    ds_read_b64_tr_b16 a[98:99], v52 offset:16640
    ds_read_b64_tr_b16 a[108:109], v52 offset:18432
    ds_read_b64_tr_b16 a[110:111], v52 offset:18688
    ds_read_b64_tr_b16 a[120:121], v52 offset:20480
    ds_read_b64_tr_b16 a[122:123], v52 offset:20736
    ds_read_b64_tr_b16 a[132:133], v52 offset:22528
    ds_read_b64_tr_b16 a[134:135], v52 offset:22784
    ds_read_b64_tr_b16 a[144:145], v52 offset:24576
    ds_read_b64_tr_b16 a[146:147], v52 offset:24832
    ds_read_b64_tr_b16 a[156:157], v52 offset:26624
    ds_read_b64_tr_b16 a[158:159], v52 offset:26880
    ds_read_b64_tr_b16 a[168:169], v52 offset:28672
    ds_read_b64_tr_b16 a[170:171], v52 offset:28928
    ds_read_b64_tr_b16 a[180:181], v52 offset:30720
    ds_read_b64_tr_b16 a[182:183], v52 offset:30976
    v_add_u32 v52, 32768, v52
    ds_read_b64_tr_b16 a[4:5], v52 offset:0
    ds_read_b64_tr_b16 a[6:7], v52 offset:256
    ds_read_b64_tr_b16 a[16:17], v52 offset:2048
    ds_read_b64_tr_b16 a[18:19], v52 offset:2304
    ds_read_b64_tr_b16 a[28:29], v52 offset:4096
    ds_read_b64_tr_b16 a[30:31], v52 offset:4352
    ds_read_b64_tr_b16 a[40:41], v52 offset:6144
    ds_read_b64_tr_b16 a[42:43], v52 offset:6400
    ds_read_b64_tr_b16 a[52:53], v52 offset:8192
    ds_read_b64_tr_b16 a[54:55], v52 offset:8448
    ds_read_b64_tr_b16 a[64:65], v52 offset:10240
    ds_read_b64_tr_b16 a[66:67], v52 offset:10496
    ds_read_b64_tr_b16 a[76:77], v52 offset:12288
    ds_read_b64_tr_b16 a[78:79], v52 offset:12544
    ds_read_b64_tr_b16 a[88:89], v52 offset:14336
    ds_read_b64_tr_b16 a[90:91], v52 offset:14592
    ds_read_b64_tr_b16 a[100:101], v52 offset:16384
    ds_read_b64_tr_b16 a[102:103], v52 offset:16640
    ds_read_b64_tr_b16 a[112:113], v52 offset:18432
    ds_read_b64_tr_b16 a[114:115], v52 offset:18688
    ds_read_b64_tr_b16 a[124:125], v52 offset:20480
    ds_read_b64_tr_b16 a[126:127], v52 offset:20736
    ds_read_b64_tr_b16 a[136:137], v52 offset:22528
    ds_read_b64_tr_b16 a[138:139], v52 offset:22784
    ds_read_b64_tr_b16 a[148:149], v52 offset:24576
    ds_read_b64_tr_b16 a[150:151], v52 offset:24832
    ds_read_b64_tr_b16 a[160:161], v52 offset:26624
    ds_read_b64_tr_b16 a[162:163], v52 offset:26880
    ds_read_b64_tr_b16 a[172:173], v52 offset:28672
    ds_read_b64_tr_b16 a[174:175], v52 offset:28928
    ds_read_b64_tr_b16 a[184:185], v52 offset:30720
    ds_read_b64_tr_b16 a[186:187], v52 offset:30976
    v_add_u32 v52, 32768, v52
    ds_read_b64_tr_b16 a[8:9], v52 offset:0
    ds_read_b64_tr_b16 a[10:11], v52 offset:256
    ds_read_b64_tr_b16 a[20:21], v52 offset:2048
    ds_read_b64_tr_b16 a[22:23], v52 offset:2304
    ds_read_b64_tr_b16 a[32:33], v52 offset:4096
    ds_read_b64_tr_b16 a[34:35], v52 offset:4352
    ds_read_b64_tr_b16 a[44:45], v52 offset:6144
    ds_read_b64_tr_b16 a[46:47], v52 offset:6400
    ds_read_b64_tr_b16 a[56:57], v52 offset:8192
    ds_read_b64_tr_b16 a[58:59], v52 offset:8448
    ds_read_b64_tr_b16 a[68:69], v52 offset:10240
    ds_read_b64_tr_b16 a[70:71], v52 offset:10496
    ds_read_b64_tr_b16 a[80:81], v52 offset:12288
    ds_read_b64_tr_b16 a[82:83], v52 offset:12544
    ds_read_b64_tr_b16 a[92:93], v52 offset:14336
    ds_read_b64_tr_b16 a[94:95], v52 offset:14592
    ds_read_b64_tr_b16 a[104:105], v52 offset:16384
    ds_read_b64_tr_b16 a[106:107], v52 offset:16640
    ds_read_b64_tr_b16 a[116:117], v52 offset:18432
    ds_read_b64_tr_b16 a[118:119], v52 offset:18688
    ds_read_b64_tr_b16 a[128:129], v52 offset:20480
    ds_read_b64_tr_b16 a[130:131], v52 offset:20736
    ds_read_b64_tr_b16 a[140:141], v52 offset:22528
    ds_read_b64_tr_b16 a[142:143], v52 offset:22784
    ds_read_b64_tr_b16 a[152:153], v52 offset:24576
    ds_read_b64_tr_b16 a[154:155], v52 offset:24832
    ds_read_b64_tr_b16 a[164:165], v52 offset:26624
    ds_read_b64_tr_b16 a[166:167], v52 offset:26880
    ds_read_b64_tr_b16 a[176:177], v52 offset:28672
    ds_read_b64_tr_b16 a[178:179], v52 offset:28928
    ds_read_b64_tr_b16 a[188:189], v52 offset:30720
    ds_read_b64_tr_b16 a[190:191], v52 offset:30976
    v_mov_b32 v52, 0x3f803f80
    v_mov_b32 v53, 0x3f803f80
    v_mov_b32 v54, 0x3f803f80
    v_mov_b32 v55, 0x3f803f80
    v_add_u32 v56, 155648, v7
    ds_write_b128 v56, v[52:55]
    s_waitcnt lgkmcnt(0)
    s_barrier
    s_mov_b32 s24, 0
LAYER:
    s_add_u32 m0, s47, 32768
    s_nop 0
    buffer_load_dwordx4 v2, s[16:19], s40 offen sc1 lds
    buffer_load_dwordx4 v3, s[16:19], s40 offen offset:1024 sc1 lds
    s_add_u32 s40, s40, s39
    s_add_u32 m0, s47, 34816
    s_nop 0
    buffer_load_dwordx4 v2, s[16:19], s40 offen sc1 lds
    buffer_load_dwordx4 v3, s[16:19], s40 offen offset:1024 sc1 lds
    s_add_u32 s40, s40, s39
    s_add_u32 m0, s47, 36864
    s_nop 0
    buffer_load_dwordx4 v2, s[16:19], s40 offen sc1 lds
    buffer_load_dwordx4 v3, s[16:19], s40 offen offset:1024 sc1 lds
    s_add_u32 s40, s40, s39
    s_add_u32 m0, s47, 38912
    s_nop 0
    buffer_load_dwordx4 v2, s[16:19], s40 offen sc1 lds
    buffer_load_dwordx4 v3, s[16:19], s40 offen offset:1024 sc1 lds
    s_add_u32 s40, s40, s39
    s_add_u32 s40, s40, s38
    s_lshl_b32 s25, s36, 11
    s_lshl_b32 s26, s24, 15
    s_add_u32 s25, s25, s26
    s_add_u32 s43, s25, 0x48000
    v_and_b32 v212, 127, v0
    v_lshlrev_b32 v213, 4, v212
    v_and_b32 v214, 31, v1
    v_lshlrev_b32 v214, 4, v214
    s_mov_b32 s33, 0xe0000
    buffer_load_dwordx4 v[204:207], v214, s[8:11], s33 offen sc1
    s_waitcnt vmcnt(9)
    s_barrier
    s_cmp_eq_u32 s24, 0
    s_cbranch_scc1 FN1_1
    s_sub_u32 s3, s2, 8
    s_cmp_ge_u32 s3, 56
    s_cbranch_scc1 FN1_1
    v_lshlrev_b32 v152, 10, v6
    v_add_u32 v152, v152, v9
    s_lshl_b32 s25, s22, 8
    s_add_u32 s25, s25, 65536
    v_add_u32 v152, s25, v152
    v_bfe_u32 v153, v13, 2, 2
    v_and_b32 v154, 1, v25
    v_lshl_or_b32 v153, v154, 2, v153
    v_lshl_add_u32 v152, v153, 5, v152
    v_xor_b32 v153, 0, v152
    ds_read_b64_tr_b16 v[224:225], v153
    ds_read_b64_tr_b16 v[226:227], v153 offset:4096
    v_xor_b32 v153, 32, v152
    ds_read_b64_tr_b16 v[228:229], v153
    ds_read_b64_tr_b16 v[230:231], v153 offset:4096
    v_xor_b32 v153, 64, v152
    ds_read_b64_tr_b16 v[232:233], v153
    ds_read_b64_tr_b16 v[234:235], v153 offset:4096
    v_xor_b32 v153, 96, v152
    ds_read_b64_tr_b16 v[236:237], v153
    ds_read_b64_tr_b16 v[238:239], v153 offset:4096
    v_xor_b32 v153, 128, v152
    ds_read_b64_tr_b16 v[240:241], v153
    ds_read_b64_tr_b16 v[242:243], v153 offset:4096
    v_xor_b32 v153, 160, v152
    ds_read_b64_tr_b16 v[244:245], v153
    ds_read_b64_tr_b16 v[246:247], v153 offset:4096
    v_xor_b32 v153, 192, v152
    ds_read_b64_tr_b16 v[248:249], v153
    ds_read_b64_tr_b16 v[250:251], v153 offset:4096
    v_xor_b32 v153, 224, v152
    ds_read_b64_tr_b16 v[252:253], v153
    ds_read_b64_tr_b16 v[254:255], v153 offset:4096
    s_waitcnt lgkmcnt(0)
    s_barrier
FN1_1:
    s_mov_b32 s72, 0
    s_sub_u32 s3, s2, 8
    s_cmp_ge_u32 s3, 56
    s_cbranch_scc1 GUS_2
    s_mov_b32 s72, 2
    s_cmp_lg_u32 s24, 0
    s_cbranch_scc1 GUS_2
    s_mov_b32 s72, 1
    s_mov_b32 s12, s58
    s_and_b32 s13, s59, 0xffff
    s_mov_b32 s14, 0x1c0000
    s_mov_b32 s15, 0x20000
    v_lshrrev_b32 v76, 2, v1
    s_mov_b32 s28, 3584
    v_mul_lo_u32 v76, v76, s28
    v_and_b32 v77, 3, v1
    v_lshrrev_b32 v78, 5, v1
    v_lshlrev_b32 v78, 1, v78
    v_xor_b32 v77, v77, v78
    v_lshl_add_u32 v76, v77, 4, v76
    s_lshl_b32 s30, s46, 6
    s_mul_i32 s29, s22, 458752
    s_add_u32 s30, s30, s29
    s_lshl_b32 s31, s22, 13
GUS_2:
    s_cmp_eq_u32 s72, 1
    s_cbranch_scc1 GEMMGU_4
    s_cmp_eq_u32 s72, 2
    s_cbranch_scc1 GEMMFF_6
    ds_read_b128 v[40:43], v4 offset:0
    ds_read_b128 v[44:47], v5 offset:0
    ds_read_b128 v[48:51], v4 offset:2048
    ds_read_b128 v[52:55], v5 offset:2048
    ds_read_b128 v[56:59], v4 offset:4096
    ds_read_b128 v[60:63], v5 offset:4096
    ds_read_b128 v[64:67], v4 offset:6144
    s_waitcnt lgkmcnt(6)
    v_mfma_f32_16x16x32_bf16 v[104:107], a[0:3], v[40:43], 0
    v_mfma_f32_16x16x32_bf16 v[108:111], a[4:7], v[40:43], 0
    v_mfma_f32_16x16x32_bf16 v[112:115], v[40:43], a[8:11], 0
    ds_read_b128 v[68:71], v5 offset:6144
    s_waitcnt lgkmcnt(6)
    v_mfma_f32_16x16x32_bf16 v[104:107], a[12:15], v[44:47], v[104:107]
    v_mfma_f32_16x16x32_bf16 v[108:111], a[16:19], v[44:47], v[108:111]
    v_mfma_f32_16x16x32_bf16 v[112:115], v[44:47], a[20:23], v[112:115]
    s_add_u32 m0, s47, 65536
    s_nop 0
    buffer_load_dwordx4 v2, s[16:19], s40 offen sc1 lds
    buffer_load_dwordx4 v3, s[16:19], s40 offen offset:1024 sc1 lds
    s_add_u32 s40, s40, s39
    ds_read_b128 v[40:43], v4 offset:8192
    s_waitcnt lgkmcnt(6)
    v_mfma_f32_16x16x32_bf16 v[104:107], a[24:27], v[48:51], v[104:107]
    v_mfma_f32_16x16x32_bf16 v[108:111], a[28:31], v[48:51], v[108:111]
    v_mfma_f32_16x16x32_bf16 v[112:115], v[48:51], a[32:35], v[112:115]
    ds_read_b128 v[44:47], v5 offset:8192
    s_waitcnt lgkmcnt(6)
    v_mfma_f32_16x16x32_bf16 v[104:107], a[36:39], v[52:55], v[104:107]
    v_mfma_f32_16x16x32_bf16 v[108:111], a[40:43], v[52:55], v[108:111]
    v_mfma_f32_16x16x32_bf16 v[112:115], v[52:55], a[44:47], v[112:115]
    ds_read_b128 v[48:51], v4 offset:10240
    s_waitcnt lgkmcnt(6)
    v_mfma_f32_16x16x32_bf16 v[104:107], a[48:51], v[56:59], v[104:107]
    v_mfma_f32_16x16x32_bf16 v[108:111], a[52:55], v[56:59], v[108:111]
    v_mfma_f32_16x16x32_bf16 v[112:115], v[56:59], a[56:59], v[112:115]
    ds_read_b128 v[52:55], v5 offset:10240
    s_waitcnt lgkmcnt(6)
    v_mfma_f32_16x16x32_bf16 v[104:107], a[60:63], v[60:63], v[104:107]
    v_mfma_f32_16x16x32_bf16 v[108:111], a[64:67], v[60:63], v[108:111]
    v_mfma_f32_16x16x32_bf16 v[112:115], v[60:63], a[68:71], v[112:115]
    s_add_u32 m0, s47, 67584
    s_nop 0
    buffer_load_dwordx4 v2, s[16:19], s40 offen sc1 lds
    buffer_load_dwordx4 v3, s[16:19], s40 offen offset:1024 sc1 lds
    s_add_u32 s40, s40, s39
    ds_read_b128 v[56:59], v4 offset:12288
    s_waitcnt lgkmcnt(6)
    v_mfma_f32_16x16x32_bf16 v[104:107], a[72:75], v[64:67], v[104:107]
    v_mfma_f32_16x16x32_bf16 v[108:111], a[76:79], v[64:67], v[108:111]
    v_mfma_f32_16x16x32_bf16 v[112:115], v[64:67], a[80:83], v[112:115]
    ds_read_b128 v[60:63], v5 offset:12288
    s_waitcnt lgkmcnt(6)
    v_mfma_f32_16x16x32_bf16 v[104:107], a[84:87], v[68:71], v[104:107]
    v_mfma_f32_16x16x32_bf16 v[108:111], a[88:91], v[68:71], v[108:111]
    v_mfma_f32_16x16x32_bf16 v[112:115], v[68:71], a[92:95], v[112:115]
    ds_read_b128 v[64:67], v4 offset:14336
    s_waitcnt lgkmcnt(6)
    v_mfma_f32_16x16x32_bf16 v[104:107], a[96:99], v[40:43], v[104:107]
    v_mfma_f32_16x16x32_bf16 v[108:111], a[100:103], v[40:43], v[108:111]
    v_mfma_f32_16x16x32_bf16 v[112:115], v[40:43], a[104:107], v[112:115]
    ds_read_b128 v[68:71], v5 offset:14336
    s_waitcnt lgkmcnt(6)
    v_mfma_f32_16x16x32_bf16 v[104:107], a[108:111], v[44:47], v[104:107]
    v_mfma_f32_16x16x32_bf16 v[108:111], a[112:115], v[44:47], v[108:111]
    v_mfma_f32_16x16x32_bf16 v[112:115], v[44:47], a[116:119], v[112:115]
    s_add_u32 m0, s47, 69632
    s_nop 0
    buffer_load_dwordx4 v2, s[16:19], s40 offen sc1 lds
    buffer_load_dwordx4 v3, s[16:19], s40 offen offset:1024 sc1 lds
    s_add_u32 s40, s40, s39
    s_waitcnt vmcnt(6)
    s_barrier
    ds_read_b128 v[40:43], v4 offset:32768
    s_waitcnt lgkmcnt(6)
    v_mfma_f32_16x16x32_bf16 v[104:107], a[120:123], v[48:51], v[104:107]
    v_mfma_f32_16x16x32_bf16 v[108:111], a[124:127], v[48:51], v[108:111]
    v_mfma_f32_16x16x32_bf16 v[112:115], v[48:51], a[128:131], v[112:115]
    ds_read_b128 v[44:47], v5 offset:32768
    s_waitcnt lgkmcnt(6)
    v_mfma_f32_16x16x32_bf16 v[104:107], a[132:135], v[52:55], v[104:107]
    v_mfma_f32_16x16x32_bf16 v[108:111], a[136:139], v[52:55], v[108:111]
    v_mfma_f32_16x16x32_bf16 v[112:115], v[52:55], a[140:143], v[112:115]
    ds_read_b128 v[48:51], v4 offset:34816
    s_waitcnt lgkmcnt(6)
    v_mfma_f32_16x16x32_bf16 v[104:107], a[144:147], v[56:59], v[104:107]
    v_mfma_f32_16x16x32_bf16 v[108:111], a[148:151], v[56:59], v[108:111]
    v_mfma_f32_16x16x32_bf16 v[112:115], v[56:59], a[152:155], v[112:115]
    ds_read_b128 v[52:55], v5 offset:34816
    s_waitcnt lgkmcnt(6)
    v_mfma_f32_16x16x32_bf16 v[104:107], a[156:159], v[60:63], v[104:107]
    v_mfma_f32_16x16x32_bf16 v[108:111], a[160:163], v[60:63], v[108:111]
    v_mfma_f32_16x16x32_bf16 v[112:115], v[60:63], a[164:167], v[112:115]
    s_add_u32 m0, s47, 71680
    s_nop 0
    buffer_load_dwordx4 v2, s[16:19], s40 offen sc1 lds
    buffer_load_dwordx4 v3, s[16:19], s40 offen offset:1024 sc1 lds
    s_add_u32 s40, s40, s39
    s_add_u32 s40, s40, s38
    ds_read_b128 v[56:59], v4 offset:36864
    s_waitcnt lgkmcnt(6)
    v_mfma_f32_16x16x32_bf16 v[104:107], a[168:171], v[64:67], v[104:107]
    v_mfma_f32_16x16x32_bf16 v[108:111], a[172:175], v[64:67], v[108:111]
    v_mfma_f32_16x16x32_bf16 v[112:115], v[64:67], a[176:179], v[112:115]
    ds_read_b128 v[60:63], v5 offset:36864
    s_waitcnt lgkmcnt(6)
    v_mfma_f32_16x16x32_bf16 v[104:107], a[180:183], v[68:71], v[104:107]
    v_mfma_f32_16x16x32_bf16 v[108:111], a[184:187], v[68:71], v[108:111]
    v_mfma_f32_16x16x32_bf16 v[112:115], v[68:71], a[188:191], v[112:115]
    s_cmp_lg_u32 s24, 0
    s_cbranch_scc1 CSS_7
    v_mov_b32 v156, 0x3f803f80
    v_mov_b32 v157, 0x3f803f80
    v_mov_b32 v158, 0x3f803f80
    v_mov_b32 v159, 0x3f803f80
    s_nop 1
    v_mfma_f32_16x16x32_bf16 v[14:17], a[0:3], v[156:159], 0
    v_mfma_f32_16x16x32_bf16 v[18:21], a[4:7], v[156:159], 0
    v_mfma_f32_16x16x32_bf16 v[160:163], v[156:159], a[8:11], 0
    v_mfma_f32_16x16x32_bf16 v[14:17], a[12:15], v[156:159], v[14:17]
    v_mfma_f32_16x16x32_bf16 v[18:21], a[16:19], v[156:159], v[18:21]
    v_mfma_f32_16x16x32_bf16 v[160:163], v[156:159], a[20:23], v[160:163]
    v_mfma_f32_16x16x32_bf16 v[14:17], a[24:27], v[156:159], v[14:17]
    v_mfma_f32_16x16x32_bf16 v[18:21], a[28:31], v[156:159], v[18:21]
    v_mfma_f32_16x16x32_bf16 v[160:163], v[156:159], a[32:35], v[160:163]
    v_mfma_f32_16x16x32_bf16 v[14:17], a[36:39], v[156:159], v[14:17]
    v_mfma_f32_16x16x32_bf16 v[18:21], a[40:43], v[156:159], v[18:21]
    v_mfma_f32_16x16x32_bf16 v[160:163], v[156:159], a[44:47], v[160:163]
    v_mfma_f32_16x16x32_bf16 v[14:17], a[48:51], v[156:159], v[14:17]
    v_mfma_f32_16x16x32_bf16 v[18:21], a[52:55], v[156:159], v[18:21]
    v_mfma_f32_16x16x32_bf16 v[160:163], v[156:159], a[56:59], v[160:163]
    v_mfma_f32_16x16x32_bf16 v[14:17], a[60:63], v[156:159], v[14:17]
    v_mfma_f32_16x16x32_bf16 v[18:21], a[64:67], v[156:159], v[18:21]
    v_mfma_f32_16x16x32_bf16 v[160:163], v[156:159], a[68:71], v[160:163]
    v_mfma_f32_16x16x32_bf16 v[14:17], a[72:75], v[156:159], v[14:17]
    v_mfma_f32_16x16x32_bf16 v[18:21], a[76:79], v[156:159], v[18:21]
    v_mfma_f32_16x16x32_bf16 v[160:163], v[156:159], a[80:83], v[160:163]
    v_mfma_f32_16x16x32_bf16 v[14:17], a[84:87], v[156:159], v[14:17]
    v_mfma_f32_16x16x32_bf16 v[18:21], a[88:91], v[156:159], v[18:21]
    v_mfma_f32_16x16x32_bf16 v[160:163], v[156:159], a[92:95], v[160:163]
    v_mfma_f32_16x16x32_bf16 v[14:17], a[96:99], v[156:159], v[14:17]
    v_mfma_f32_16x16x32_bf16 v[18:21], a[100:103], v[156:159], v[18:21]
    v_mfma_f32_16x16x32_bf16 v[160:163], v[156:159], a[104:107], v[160:163]
    v_mfma_f32_16x16x32_bf16 v[14:17], a[108:111], v[156:159], v[14:17]
    v_mfma_f32_16x16x32_bf16 v[18:21], a[112:115], v[156:159], v[18:21]
    v_mfma_f32_16x16x32_bf16 v[160:163], v[156:159], a[116:119], v[160:163]
    v_mfma_f32_16x16x32_bf16 v[14:17], a[120:123], v[156:159], v[14:17]
    v_mfma_f32_16x16x32_bf16 v[18:21], a[124:127], v[156:159], v[18:21]
    v_mfma_f32_16x16x32_bf16 v[160:163], v[156:159], a[128:131], v[160:163]
    v_mfma_f32_16x16x32_bf16 v[14:17], a[132:135], v[156:159], v[14:17]
    v_mfma_f32_16x16x32_bf16 v[18:21], a[136:139], v[156:159], v[18:21]
    v_mfma_f32_16x16x32_bf16 v[160:163], v[156:159], a[140:143], v[160:163]
    v_mfma_f32_16x16x32_bf16 v[14:17], a[144:147], v[156:159], v[14:17]
    v_mfma_f32_16x16x32_bf16 v[18:21], a[148:151], v[156:159], v[18:21]
    v_mfma_f32_16x16x32_bf16 v[160:163], v[156:159], a[152:155], v[160:163]
    v_mfma_f32_16x16x32_bf16 v[14:17], a[156:159], v[156:159], v[14:17]
    v_mfma_f32_16x16x32_bf16 v[18:21], a[160:163], v[156:159], v[18:21]
    v_mfma_f32_16x16x32_bf16 v[160:163], v[156:159], a[164:167], v[160:163]
    v_mfma_f32_16x16x32_bf16 v[14:17], a[168:171], v[156:159], v[14:17]
    v_mfma_f32_16x16x32_bf16 v[18:21], a[172:175], v[156:159], v[18:21]
    v_mfma_f32_16x16x32_bf16 v[160:163], v[156:159], a[176:179], v[160:163]
    v_mfma_f32_16x16x32_bf16 v[14:17], a[180:183], v[156:159], v[14:17]
    v_mfma_f32_16x16x32_bf16 v[18:21], a[184:187], v[156:159], v[18:21]
    v_mfma_f32_16x16x32_bf16 v[160:163], v[156:159], a[188:191], v[160:163]
    s_nop 7
    v_mov_b32 v22, v160
CSS_7:
    ds_read_b128 v[64:67], v4 offset:38912
    s_waitcnt lgkmcnt(6)
    v_mfma_f32_16x16x32_bf16 v[116:119], a[0:3], v[40:43], 0
    v_mfma_f32_16x16x32_bf16 v[120:123], a[4:7], v[40:43], 0
    v_mfma_f32_16x16x32_bf16 v[124:127], v[40:43], a[8:11], 0
    ds_read_b128 v[68:71], v5 offset:38912
    s_waitcnt lgkmcnt(6)
    v_mfma_f32_16x16x32_bf16 v[116:119], a[12:15], v[44:47], v[116:119]
    v_mfma_f32_16x16x32_bf16 v[120:123], a[16:19], v[44:47], v[120:123]
    v_mfma_f32_16x16x32_bf16 v[124:127], v[44:47], a[20:23], v[124:127]
    s_add_u32 m0, s47, 98304
    s_nop 0
    buffer_load_dwordx4 v2, s[16:19], s40 offen sc1 lds
    buffer_load_dwordx4 v3, s[16:19], s40 offen offset:1024 sc1 lds
    s_add_u32 s40, s40, s39
    ds_read_b128 v[40:43], v4 offset:40960
    s_waitcnt lgkmcnt(6)
    v_mfma_f32_16x16x32_bf16 v[116:119], a[24:27], v[48:51], v[116:119]
    v_mfma_f32_16x16x32_bf16 v[120:123], a[28:31], v[48:51], v[120:123]
    v_mfma_f32_16x16x32_bf16 v[124:127], v[48:51], a[32:35], v[124:127]
    ds_read_b128 v[44:47], v5 offset:40960
    s_waitcnt lgkmcnt(6)
    v_mfma_f32_16x16x32_bf16 v[116:119], a[36:39], v[52:55], v[116:119]
    v_mfma_f32_16x16x32_bf16 v[120:123], a[40:43], v[52:55], v[120:123]
    v_mfma_f32_16x16x32_bf16 v[124:127], v[52:55], a[44:47], v[124:127]
    ds_read_b128 v[48:51], v4 offset:43008
    s_waitcnt lgkmcnt(6)
    v_mfma_f32_16x16x32_bf16 v[116:119], a[48:51], v[56:59], v[116:119]
    v_mfma_f32_16x16x32_bf16 v[120:123], a[52:55], v[56:59], v[120:123]
    v_mfma_f32_16x16x32_bf16 v[124:127], v[56:59], a[56:59], v[124:127]
    ds_read_b128 v[52:55], v5 offset:43008
    s_waitcnt lgkmcnt(6)
    v_mfma_f32_16x16x32_bf16 v[116:119], a[60:63], v[60:63], v[116:119]
    v_mfma_f32_16x16x32_bf16 v[120:123], a[64:67], v[60:63], v[120:123]
    v_mfma_f32_16x16x32_bf16 v[124:127], v[60:63], a[68:71], v[124:127]
    s_add_u32 m0, s47, 100352
    s_nop 0
    buffer_load_dwordx4 v2, s[16:19], s40 offen sc1 lds
    buffer_load_dwordx4 v3, s[16:19], s40 offen offset:1024 sc1 lds
    s_add_u32 s40, s40, s39
    ds_read_b128 v[56:59], v4 offset:45056
    s_waitcnt lgkmcnt(6)
    v_mfma_f32_16x16x32_bf16 v[116:119], a[72:75], v[64:67], v[116:119]
    v_mfma_f32_16x16x32_bf16 v[120:123], a[76:79], v[64:67], v[120:123]
    v_mfma_f32_16x16x32_bf16 v[124:127], v[64:67], a[80:83], v[124:127]
    ds_read_b128 v[60:63], v5 offset:45056
    s_waitcnt lgkmcnt(6)
    v_mfma_f32_16x16x32_bf16 v[116:119], a[84:87], v[68:71], v[116:119]
    v_mfma_f32_16x16x32_bf16 v[120:123], a[88:91], v[68:71], v[120:123]
    v_mfma_f32_16x16x32_bf16 v[124:127], v[68:71], a[92:95], v[124:127]
    ds_read_b128 v[64:67], v4 offset:47104
    s_waitcnt lgkmcnt(6)
    v_mfma_f32_16x16x32_bf16 v[116:119], a[96:99], v[40:43], v[116:119]
    v_mfma_f32_16x16x32_bf16 v[120:123], a[100:103], v[40:43], v[120:123]
    v_mfma_f32_16x16x32_bf16 v[124:127], v[40:43], a[104:107], v[124:127]
    ds_read_b128 v[68:71], v5 offset:47104
    s_waitcnt lgkmcnt(6)
    v_mfma_f32_16x16x32_bf16 v[116:119], a[108:111], v[44:47], v[116:119]
    v_mfma_f32_16x16x32_bf16 v[120:123], a[112:115], v[44:47], v[120:123]
    v_mfma_f32_16x16x32_bf16 v[124:127], v[44:47], a[116:119], v[124:127]
    s_add_u32 m0, s47, 102400
    s_nop 0
    buffer_load_dwordx4 v2, s[16:19], s40 offen sc1 lds
    buffer_load_dwordx4 v3, s[16:19], s40 offen offset:1024 sc1 lds
    s_add_u32 s40, s40, s39
    s_waitcnt vmcnt(6)
    s_barrier
    v_add_u32 v4, 0x10000, v4
    v_add_u32 v5, 0x10000, v5
    ds_read_b128 v[40:43], v4 offset:0
    s_waitcnt lgkmcnt(6)
    v_mfma_f32_16x16x32_bf16 v[116:119], a[120:123], v[48:51], v[116:119]
    v_mfma_f32_16x16x32_bf16 v[120:123], a[124:127], v[48:51], v[120:123]
    v_mfma_f32_16x16x32_bf16 v[124:127], v[48:51], a[128:131], v[124:127]
    ds_read_b128 v[44:47], v5 offset:0
    s_waitcnt lgkmcnt(6)
    v_mfma_f32_16x16x32_bf16 v[116:119], a[132:135], v[52:55], v[116:119]
    v_mfma_f32_16x16x32_bf16 v[120:123], a[136:139], v[52:55], v[120:123]
    v_mfma_f32_16x16x32_bf16 v[124:127], v[52:55], a[140:143], v[124:127]
    ds_read_b128 v[48:51], v4 offset:2048
    s_waitcnt lgkmcnt(6)
    v_mfma_f32_16x16x32_bf16 v[116:119], a[144:147], v[56:59], v[116:119]
    v_mfma_f32_16x16x32_bf16 v[120:123], a[148:151], v[56:59], v[120:123]
    v_mfma_f32_16x16x32_bf16 v[124:127], v[56:59], a[152:155], v[124:127]
    ds_read_b128 v[52:55], v5 offset:2048
    s_waitcnt lgkmcnt(6)
    v_mfma_f32_16x16x32_bf16 v[116:119], a[156:159], v[60:63], v[116:119]
    v_mfma_f32_16x16x32_bf16 v[120:123], a[160:163], v[60:63], v[120:123]
    v_mfma_f32_16x16x32_bf16 v[124:127], v[60:63], a[164:167], v[124:127]
    s_add_u32 m0, s47, 104448
    s_nop 0
    buffer_load_dwordx4 v2, s[16:19], s40 offen sc1 lds
    buffer_load_dwordx4 v3, s[16:19], s40 offen offset:1024 sc1 lds
    s_add_u32 s40, s40, s39
    s_add_u32 s40, s40, s38
    ds_read_b128 v[56:59], v4 offset:4096
    s_waitcnt lgkmcnt(6)
    v_mfma_f32_16x16x32_bf16 v[116:119], a[168:171], v[64:67], v[116:119]
    v_mfma_f32_16x16x32_bf16 v[120:123], a[172:175], v[64:67], v[120:123]
    v_mfma_f32_16x16x32_bf16 v[124:127], v[64:67], a[176:179], v[124:127]
    ds_read_b128 v[60:63], v5 offset:4096
    s_waitcnt lgkmcnt(6)
    v_mfma_f32_16x16x32_bf16 v[116:119], a[180:183], v[68:71], v[116:119]
    v_mfma_f32_16x16x32_bf16 v[120:123], a[184:187], v[68:71], v[120:123]
    v_mfma_f32_16x16x32_bf16 v[124:127], v[68:71], a[188:191], v[124:127]
    ds_read_b128 v[64:67], v4 offset:6144
    s_waitcnt lgkmcnt(6)
    v_mfma_f32_16x16x32_bf16 v[128:131], a[0:3], v[40:43], 0
    v_mfma_f32_16x16x32_bf16 v[132:135], a[4:7], v[40:43], 0
    v_mfma_f32_16x16x32_bf16 v[136:139], v[40:43], a[8:11], 0
    ds_read_b128 v[68:71], v5 offset:6144
    s_waitcnt lgkmcnt(6)
    v_mfma_f32_16x16x32_bf16 v[128:131], a[12:15], v[44:47], v[128:131]
    v_mfma_f32_16x16x32_bf16 v[132:135], a[16:19], v[44:47], v[132:135]
    v_mfma_f32_16x16x32_bf16 v[136:139], v[44:47], a[20:23], v[136:139]
    ds_read_b128 v[40:43], v4 offset:8192
    s_waitcnt lgkmcnt(6)
    v_mfma_f32_16x16x32_bf16 v[128:131], a[24:27], v[48:51], v[128:131]
    v_mfma_f32_16x16x32_bf16 v[132:135], a[28:31], v[48:51], v[132:135]
    v_mfma_f32_16x16x32_bf16 v[136:139], v[48:51], a[32:35], v[136:139]
    ds_read_b128 v[44:47], v5 offset:8192
    s_waitcnt lgkmcnt(6)
    v_mfma_f32_16x16x32_bf16 v[128:131], a[36:39], v[52:55], v[128:131]
    v_mfma_f32_16x16x32_bf16 v[132:135], a[40:43], v[52:55], v[132:135]
    v_mfma_f32_16x16x32_bf16 v[136:139], v[52:55], a[44:47], v[136:139]
    ds_read_b128 v[48:51], v4 offset:10240
    s_waitcnt lgkmcnt(6)
    v_mfma_f32_16x16x32_bf16 v[128:131], a[48:51], v[56:59], v[128:131]
    v_mfma_f32_16x16x32_bf16 v[132:135], a[52:55], v[56:59], v[132:135]
    v_mfma_f32_16x16x32_bf16 v[136:139], v[56:59], a[56:59], v[136:139]
    ds_read_b128 v[52:55], v5 offset:10240
    s_waitcnt lgkmcnt(6)
    v_mfma_f32_16x16x32_bf16 v[128:131], a[60:63], v[60:63], v[128:131]
    v_mfma_f32_16x16x32_bf16 v[132:135], a[64:67], v[60:63], v[132:135]
    v_mfma_f32_16x16x32_bf16 v[136:139], v[60:63], a[68:71], v[136:139]
    ds_read_b128 v[56:59], v4 offset:12288
    s_waitcnt lgkmcnt(6)
    v_mfma_f32_16x16x32_bf16 v[128:131], a[72:75], v[64:67], v[128:131]
    v_mfma_f32_16x16x32_bf16 v[132:135], a[76:79], v[64:67], v[132:135]
    v_mfma_f32_16x16x32_bf16 v[136:139], v[64:67], a[80:83], v[136:139]
    ds_read_b128 v[60:63], v5 offset:12288
    s_waitcnt lgkmcnt(6)
    v_mfma_f32_16x16x32_bf16 v[128:131], a[84:87], v[68:71], v[128:131]
    v_mfma_f32_16x16x32_bf16 v[132:135], a[88:91], v[68:71], v[132:135]
    v_mfma_f32_16x16x32_bf16 v[136:139], v[68:71], a[92:95], v[136:139]
    ds_read_b128 v[64:67], v4 offset:14336
    s_waitcnt lgkmcnt(6)
    v_mfma_f32_16x16x32_bf16 v[128:131], a[96:99], v[40:43], v[128:131]
    v_mfma_f32_16x16x32_bf16 v[132:135], a[100:103], v[40:43], v[132:135]
    v_mfma_f32_16x16x32_bf16 v[136:139], v[40:43], a[104:107], v[136:139]
    ds_read_b128 v[68:71], v5 offset:14336
    s_waitcnt lgkmcnt(6)
    v_mfma_f32_16x16x32_bf16 v[128:131], a[108:111], v[44:47], v[128:131]
    v_mfma_f32_16x16x32_bf16 v[132:135], a[112:115], v[44:47], v[132:135]
    v_mfma_f32_16x16x32_bf16 v[136:139], v[44:47], a[116:119], v[136:139]
    s_waitcnt vmcnt(0)
    s_barrier
    buffer_load_dwordx4 v[208:211], v213, s[8:11], s43 offen sc1
    ds_read_b128 v[40:43], v4 offset:32768
    s_waitcnt lgkmcnt(6)
    v_mfma_f32_16x16x32_bf16 v[128:131], a[120:123], v[48:51], v[128:131]
    v_mfma_f32_16x16x32_bf16 v[132:135], a[124:127], v[48:51], v[132:135]
    v_mfma_f32_16x16x32_bf16 v[136:139], v[48:51], a[128:131], v[136:139]
    ds_read_b128 v[44:47], v5 offset:32768
    s_waitcnt lgkmcnt(6)
    v_mfma_f32_16x16x32_bf16 v[128:131], a[132:135], v[52:55], v[128:131]
    v_mfma_f32_16x16x32_bf16 v[132:135], a[136:139], v[52:55], v[132:135]
    v_mfma_f32_16x16x32_bf16 v[136:139], v[52:55], a[140:143], v[136:139]
    ds_read_b128 v[48:51], v4 offset:34816
    s_waitcnt lgkmcnt(6)
    v_mfma_f32_16x16x32_bf16 v[128:131], a[144:147], v[56:59], v[128:131]
    v_mfma_f32_16x16x32_bf16 v[132:135], a[148:151], v[56:59], v[132:135]
    v_mfma_f32_16x16x32_bf16 v[136:139], v[56:59], a[152:155], v[136:139]
    ds_read_b128 v[52:55], v5 offset:34816
    s_waitcnt lgkmcnt(6)
    v_mfma_f32_16x16x32_bf16 v[128:131], a[156:159], v[60:63], v[128:131]
    v_mfma_f32_16x16x32_bf16 v[132:135], a[160:163], v[60:63], v[132:135]
    v_mfma_f32_16x16x32_bf16 v[136:139], v[60:63], a[164:167], v[136:139]
    ds_read_b128 v[56:59], v4 offset:36864
    s_waitcnt lgkmcnt(6)
    v_mfma_f32_16x16x32_bf16 v[128:131], a[168:171], v[64:67], v[128:131]
    v_mfma_f32_16x16x32_bf16 v[132:135], a[172:175], v[64:67], v[132:135]
    v_mfma_f32_16x16x32_bf16 v[136:139], v[64:67], a[176:179], v[136:139]
    ds_read_b128 v[60:63], v5 offset:36864
    s_waitcnt lgkmcnt(6)
    v_mfma_f32_16x16x32_bf16 v[128:131], a[180:183], v[68:71], v[128:131]
    v_mfma_f32_16x16x32_bf16 v[132:135], a[184:187], v[68:71], v[132:135]
    v_mfma_f32_16x16x32_bf16 v[136:139], v[68:71], a[188:191], v[136:139]
    ds_read_b128 v[64:67], v4 offset:38912
    s_waitcnt lgkmcnt(6)
    v_mfma_f32_16x16x32_bf16 v[140:143], a[0:3], v[40:43], 0
    v_mfma_f32_16x16x32_bf16 v[144:147], a[4:7], v[40:43], 0
    v_mfma_f32_16x16x32_bf16 v[148:151], v[40:43], a[8:11], 0
    ds_read_b128 v[68:71], v5 offset:38912
    s_waitcnt lgkmcnt(6)
    v_mfma_f32_16x16x32_bf16 v[140:143], a[12:15], v[44:47], v[140:143]
    v_mfma_f32_16x16x32_bf16 v[144:147], a[16:19], v[44:47], v[144:147]
    v_mfma_f32_16x16x32_bf16 v[148:151], v[44:47], a[20:23], v[148:151]
    ds_read_b128 v[40:43], v4 offset:40960
    s_waitcnt lgkmcnt(6)
    v_mfma_f32_16x16x32_bf16 v[140:143], a[24:27], v[48:51], v[140:143]
    v_mfma_f32_16x16x32_bf16 v[144:147], a[28:31], v[48:51], v[144:147]
    v_mfma_f32_16x16x32_bf16 v[148:151], v[48:51], a[32:35], v[148:151]
    ds_read_b128 v[44:47], v5 offset:40960
    s_waitcnt lgkmcnt(6)
    v_mfma_f32_16x16x32_bf16 v[140:143], a[36:39], v[52:55], v[140:143]
    v_mfma_f32_16x16x32_bf16 v[144:147], a[40:43], v[52:55], v[144:147]
    v_mfma_f32_16x16x32_bf16 v[148:151], v[52:55], a[44:47], v[148:151]
    ds_read_b128 v[48:51], v4 offset:43008
    s_waitcnt lgkmcnt(6)
    v_mfma_f32_16x16x32_bf16 v[140:143], a[48:51], v[56:59], v[140:143]
    v_mfma_f32_16x16x32_bf16 v[144:147], a[52:55], v[56:59], v[144:147]
    v_mfma_f32_16x16x32_bf16 v[148:151], v[56:59], a[56:59], v[148:151]
    ds_read_b128 v[52:55], v5 offset:43008
    s_waitcnt lgkmcnt(6)
    v_mfma_f32_16x16x32_bf16 v[140:143], a[60:63], v[60:63], v[140:143]
    v_mfma_f32_16x16x32_bf16 v[144:147], a[64:67], v[60:63], v[144:147]
    v_mfma_f32_16x16x32_bf16 v[148:151], v[60:63], a[68:71], v[148:151]
    ds_read_b128 v[56:59], v4 offset:45056
    s_waitcnt lgkmcnt(6)
    v_mfma_f32_16x16x32_bf16 v[140:143], a[72:75], v[64:67], v[140:143]
    v_mfma_f32_16x16x32_bf16 v[144:147], a[76:79], v[64:67], v[144:147]
    v_mfma_f32_16x16x32_bf16 v[148:151], v[64:67], a[80:83], v[148:151]
    ds_read_b128 v[60:63], v5 offset:45056
    s_waitcnt lgkmcnt(6)
    v_mfma_f32_16x16x32_bf16 v[140:143], a[84:87], v[68:71], v[140:143]
    v_mfma_f32_16x16x32_bf16 v[144:147], a[88:91], v[68:71], v[144:147]
    v_mfma_f32_16x16x32_bf16 v[148:151], v[68:71], a[92:95], v[148:151]
    ds_read_b128 v[64:67], v4 offset:47104
    s_waitcnt lgkmcnt(6)
    v_mfma_f32_16x16x32_bf16 v[140:143], a[96:99], v[40:43], v[140:143]
    v_mfma_f32_16x16x32_bf16 v[144:147], a[100:103], v[40:43], v[144:147]
    v_mfma_f32_16x16x32_bf16 v[148:151], v[40:43], a[104:107], v[148:151]
    ds_read_b128 v[68:71], v5 offset:47104
    s_waitcnt lgkmcnt(6)
    v_mfma_f32_16x16x32_bf16 v[140:143], a[108:111], v[44:47], v[140:143]
    v_mfma_f32_16x16x32_bf16 v[144:147], a[112:115], v[44:47], v[144:147]
    v_mfma_f32_16x16x32_bf16 v[148:151], v[44:47], a[116:119], v[148:151]
    s_waitcnt lgkmcnt(5)
    v_mfma_f32_16x16x32_bf16 v[140:143], a[120:123], v[48:51], v[140:143]
    v_mfma_f32_16x16x32_bf16 v[144:147], a[124:127], v[48:51], v[144:147]
    v_mfma_f32_16x16x32_bf16 v[148:151], v[48:51], a[128:131], v[148:151]
    s_waitcnt lgkmcnt(4)
    v_mfma_f32_16x16x32_bf16 v[140:143], a[132:135], v[52:55], v[140:143]
    v_mfma_f32_16x16x32_bf16 v[144:147], a[136:139], v[52:55], v[144:147]
    v_mfma_f32_16x16x32_bf16 v[148:151], v[52:55], a[140:143], v[148:151]
    s_waitcnt lgkmcnt(3)
    v_mfma_f32_16x16x32_bf16 v[140:143], a[144:147], v[56:59], v[140:143]
    v_mfma_f32_16x16x32_bf16 v[144:147], a[148:151], v[56:59], v[144:147]
    v_mfma_f32_16x16x32_bf16 v[148:151], v[56:59], a[152:155], v[148:151]
    s_waitcnt lgkmcnt(2)
    v_mfma_f32_16x16x32_bf16 v[140:143], a[156:159], v[60:63], v[140:143]
    v_mfma_f32_16x16x32_bf16 v[144:147], a[160:163], v[60:63], v[144:147]
    v_mfma_f32_16x16x32_bf16 v[148:151], v[60:63], a[164:167], v[148:151]
    s_waitcnt lgkmcnt(1)
    v_mfma_f32_16x16x32_bf16 v[140:143], a[168:171], v[64:67], v[140:143]
    v_mfma_f32_16x16x32_bf16 v[144:147], a[172:175], v[64:67], v[144:147]
    v_mfma_f32_16x16x32_bf16 v[148:151], v[64:67], a[176:179], v[148:151]
    s_waitcnt lgkmcnt(0)
    v_mfma_f32_16x16x32_bf16 v[140:143], a[180:183], v[68:71], v[140:143]
    v_mfma_f32_16x16x32_bf16 v[144:147], a[184:187], v[68:71], v[144:147]
    v_mfma_f32_16x16x32_bf16 v[148:151], v[68:71], a[188:191], v[148:151]
    s_branch GEMME_5
GEMMGU_4:
    ds_read_b128 v[40:43], v4 offset:0
    ds_read_b128 v[44:47], v5 offset:0
    ds_read_b128 v[48:51], v4 offset:2048
    ds_read_b128 v[52:55], v5 offset:2048
    ds_read_b128 v[56:59], v4 offset:4096
    ds_read_b128 v[60:63], v5 offset:4096
    ds_read_b128 v[64:67], v4 offset:6144
    s_waitcnt lgkmcnt(6)
    v_mfma_f32_16x16x32_bf16 v[104:107], a[0:3], v[40:43], 0
    v_mfma_f32_16x16x32_bf16 v[108:111], a[4:7], v[40:43], 0
    v_mfma_f32_16x16x32_bf16 v[112:115], v[40:43], a[8:11], 0
    ds_read_b128 v[68:71], v5 offset:6144
    s_waitcnt lgkmcnt(6)
    v_mfma_f32_16x16x32_bf16 v[104:107], a[12:15], v[44:47], v[104:107]
    v_mfma_f32_16x16x32_bf16 v[108:111], a[16:19], v[44:47], v[108:111]
    v_mfma_f32_16x16x32_bf16 v[112:115], v[44:47], a[20:23], v[112:115]
    s_add_u32 m0, s47, 65536
    s_nop 0
    buffer_load_dwordx4 v2, s[16:19], s40 offen sc1 lds
    buffer_load_dwordx4 v3, s[16:19], s40 offen offset:1024 sc1 lds
    s_add_u32 s40, s40, s39
    ds_read_b128 v[40:43], v4 offset:8192
    s_waitcnt lgkmcnt(6)
    v_mfma_f32_16x16x32_bf16 v[104:107], a[24:27], v[48:51], v[104:107]
    v_mfma_f32_16x16x32_bf16 v[108:111], a[28:31], v[48:51], v[108:111]
    v_mfma_f32_16x16x32_bf16 v[112:115], v[48:51], a[32:35], v[112:115]
    ds_read_b128 v[44:47], v5 offset:8192
    s_waitcnt lgkmcnt(6)
    v_mfma_f32_16x16x32_bf16 v[104:107], a[36:39], v[52:55], v[104:107]
    v_mfma_f32_16x16x32_bf16 v[108:111], a[40:43], v[52:55], v[108:111]
    v_mfma_f32_16x16x32_bf16 v[112:115], v[52:55], a[44:47], v[112:115]
    ds_read_b128 v[48:51], v4 offset:10240
    s_waitcnt lgkmcnt(6)
    v_mfma_f32_16x16x32_bf16 v[104:107], a[48:51], v[56:59], v[104:107]
    v_mfma_f32_16x16x32_bf16 v[108:111], a[52:55], v[56:59], v[108:111]
    v_mfma_f32_16x16x32_bf16 v[112:115], v[56:59], a[56:59], v[112:115]
    ds_read_b128 v[52:55], v5 offset:10240
    s_waitcnt lgkmcnt(6)
    v_mfma_f32_16x16x32_bf16 v[104:107], a[60:63], v[60:63], v[104:107]
    v_mfma_f32_16x16x32_bf16 v[108:111], a[64:67], v[60:63], v[108:111]
    v_mfma_f32_16x16x32_bf16 v[112:115], v[60:63], a[68:71], v[112:115]
    s_add_u32 m0, s47, 67584
    s_nop 0
    buffer_load_dwordx4 v2, s[16:19], s40 offen sc1 lds
    buffer_load_dwordx4 v3, s[16:19], s40 offen offset:1024 sc1 lds
    s_add_u32 s40, s40, s39
    ds_read_b128 v[56:59], v4 offset:12288
    s_waitcnt lgkmcnt(6)
    v_mfma_f32_16x16x32_bf16 v[104:107], a[72:75], v[64:67], v[104:107]
    v_mfma_f32_16x16x32_bf16 v[108:111], a[76:79], v[64:67], v[108:111]
    v_mfma_f32_16x16x32_bf16 v[112:115], v[64:67], a[80:83], v[112:115]
    ds_read_b128 v[60:63], v5 offset:12288
    s_waitcnt lgkmcnt(6)
    v_mfma_f32_16x16x32_bf16 v[104:107], a[84:87], v[68:71], v[104:107]
    v_mfma_f32_16x16x32_bf16 v[108:111], a[88:91], v[68:71], v[108:111]
    v_mfma_f32_16x16x32_bf16 v[112:115], v[68:71], a[92:95], v[112:115]
    ds_read_b128 v[64:67], v4 offset:14336
    s_waitcnt lgkmcnt(6)
    v_mfma_f32_16x16x32_bf16 v[104:107], a[96:99], v[40:43], v[104:107]
    v_mfma_f32_16x16x32_bf16 v[108:111], a[100:103], v[40:43], v[108:111]
    v_mfma_f32_16x16x32_bf16 v[112:115], v[40:43], a[104:107], v[112:115]
    ds_read_b128 v[68:71], v5 offset:14336
    s_waitcnt lgkmcnt(6)
    v_mfma_f32_16x16x32_bf16 v[104:107], a[108:111], v[44:47], v[104:107]
    v_mfma_f32_16x16x32_bf16 v[108:111], a[112:115], v[44:47], v[108:111]
    v_mfma_f32_16x16x32_bf16 v[112:115], v[44:47], a[116:119], v[112:115]
    s_add_u32 m0, s47, 69632
    s_nop 0
    buffer_load_dwordx4 v2, s[16:19], s40 offen sc1 lds
    buffer_load_dwordx4 v3, s[16:19], s40 offen offset:1024 sc1 lds
    s_add_u32 s40, s40, s39
    s_waitcnt vmcnt(6)
    s_barrier
    ds_read_b128 v[40:43], v4 offset:32768
    s_waitcnt lgkmcnt(6)
    v_mfma_f32_16x16x32_bf16 v[104:107], a[120:123], v[48:51], v[104:107]
    v_mfma_f32_16x16x32_bf16 v[108:111], a[124:127], v[48:51], v[108:111]
    v_mfma_f32_16x16x32_bf16 v[112:115], v[48:51], a[128:131], v[112:115]
    ds_read_b128 v[44:47], v5 offset:32768
    s_waitcnt lgkmcnt(6)
    v_mfma_f32_16x16x32_bf16 v[104:107], a[132:135], v[52:55], v[104:107]
    v_mfma_f32_16x16x32_bf16 v[108:111], a[136:139], v[52:55], v[108:111]
    v_mfma_f32_16x16x32_bf16 v[112:115], v[52:55], a[140:143], v[112:115]
    ds_read_b128 v[48:51], v4 offset:34816
    s_waitcnt lgkmcnt(6)
    v_mfma_f32_16x16x32_bf16 v[104:107], a[144:147], v[56:59], v[104:107]
    v_mfma_f32_16x16x32_bf16 v[108:111], a[148:151], v[56:59], v[108:111]
    v_mfma_f32_16x16x32_bf16 v[112:115], v[56:59], a[152:155], v[112:115]
    ds_read_b128 v[52:55], v5 offset:34816
    s_waitcnt lgkmcnt(6)
    v_mfma_f32_16x16x32_bf16 v[104:107], a[156:159], v[60:63], v[104:107]
    v_mfma_f32_16x16x32_bf16 v[108:111], a[160:163], v[60:63], v[108:111]
    v_mfma_f32_16x16x32_bf16 v[112:115], v[60:63], a[164:167], v[112:115]
    s_add_u32 m0, s47, 71680
    s_nop 0
    buffer_load_dwordx4 v2, s[16:19], s40 offen sc1 lds
    buffer_load_dwordx4 v3, s[16:19], s40 offen offset:1024 sc1 lds
    s_add_u32 s40, s40, s39
    s_add_u32 s40, s40, s38
    ds_read_b128 v[56:59], v4 offset:36864
    s_waitcnt lgkmcnt(6)
    v_mfma_f32_16x16x32_bf16 v[104:107], a[168:171], v[64:67], v[104:107]
    v_mfma_f32_16x16x32_bf16 v[108:111], a[172:175], v[64:67], v[108:111]
    v_mfma_f32_16x16x32_bf16 v[112:115], v[64:67], a[176:179], v[112:115]
    ds_read_b128 v[60:63], v5 offset:36864
    s_waitcnt lgkmcnt(6)
    v_mfma_f32_16x16x32_bf16 v[104:107], a[180:183], v[68:71], v[104:107]
    v_mfma_f32_16x16x32_bf16 v[108:111], a[184:187], v[68:71], v[108:111]
    v_mfma_f32_16x16x32_bf16 v[112:115], v[68:71], a[188:191], v[112:115]
    v_mov_b32 v156, 0x3f803f80
    v_mov_b32 v157, 0x3f803f80
    v_mov_b32 v158, 0x3f803f80
    v_mov_b32 v159, 0x3f803f80
    s_nop 1
    v_mfma_f32_16x16x32_bf16 v[14:17], a[0:3], v[156:159], 0
    v_mfma_f32_16x16x32_bf16 v[18:21], a[4:7], v[156:159], 0
    v_mfma_f32_16x16x32_bf16 v[160:163], v[156:159], a[8:11], 0
    v_mfma_f32_16x16x32_bf16 v[14:17], a[12:15], v[156:159], v[14:17]
    v_mfma_f32_16x16x32_bf16 v[18:21], a[16:19], v[156:159], v[18:21]
    v_mfma_f32_16x16x32_bf16 v[160:163], v[156:159], a[20:23], v[160:163]
    v_mfma_f32_16x16x32_bf16 v[14:17], a[24:27], v[156:159], v[14:17]
    v_mfma_f32_16x16x32_bf16 v[18:21], a[28:31], v[156:159], v[18:21]
    v_mfma_f32_16x16x32_bf16 v[160:163], v[156:159], a[32:35], v[160:163]
    v_mfma_f32_16x16x32_bf16 v[14:17], a[36:39], v[156:159], v[14:17]
    v_mfma_f32_16x16x32_bf16 v[18:21], a[40:43], v[156:159], v[18:21]
    v_mfma_f32_16x16x32_bf16 v[160:163], v[156:159], a[44:47], v[160:163]
    v_mfma_f32_16x16x32_bf16 v[14:17], a[48:51], v[156:159], v[14:17]
    v_mfma_f32_16x16x32_bf16 v[18:21], a[52:55], v[156:159], v[18:21]
    v_mfma_f32_16x16x32_bf16 v[160:163], v[156:159], a[56:59], v[160:163]
    v_mfma_f32_16x16x32_bf16 v[14:17], a[60:63], v[156:159], v[14:17]
    v_mfma_f32_16x16x32_bf16 v[18:21], a[64:67], v[156:159], v[18:21]
    v_mfma_f32_16x16x32_bf16 v[160:163], v[156:159], a[68:71], v[160:163]
    v_mfma_f32_16x16x32_bf16 v[14:17], a[72:75], v[156:159], v[14:17]
    v_mfma_f32_16x16x32_bf16 v[18:21], a[76:79], v[156:159], v[18:21]
    v_mfma_f32_16x16x32_bf16 v[160:163], v[156:159], a[80:83], v[160:163]
    v_mfma_f32_16x16x32_bf16 v[14:17], a[84:87], v[156:159], v[14:17]
    v_mfma_f32_16x16x32_bf16 v[18:21], a[88:91], v[156:159], v[18:21]
    v_mfma_f32_16x16x32_bf16 v[160:163], v[156:159], a[92:95], v[160:163]
    v_mfma_f32_16x16x32_bf16 v[14:17], a[96:99], v[156:159], v[14:17]
    v_mfma_f32_16x16x32_bf16 v[18:21], a[100:103], v[156:159], v[18:21]
    v_mfma_f32_16x16x32_bf16 v[160:163], v[156:159], a[104:107], v[160:163]
    v_mfma_f32_16x16x32_bf16 v[14:17], a[108:111], v[156:159], v[14:17]
    v_mfma_f32_16x16x32_bf16 v[18:21], a[112:115], v[156:159], v[18:21]
    v_mfma_f32_16x16x32_bf16 v[160:163], v[156:159], a[116:119], v[160:163]
    v_mfma_f32_16x16x32_bf16 v[14:17], a[120:123], v[156:159], v[14:17]
    v_mfma_f32_16x16x32_bf16 v[18:21], a[124:127], v[156:159], v[18:21]
    v_mfma_f32_16x16x32_bf16 v[160:163], v[156:159], a[128:131], v[160:163]
    v_mfma_f32_16x16x32_bf16 v[14:17], a[132:135], v[156:159], v[14:17]
    v_mfma_f32_16x16x32_bf16 v[18:21], a[136:139], v[156:159], v[18:21]
    v_mfma_f32_16x16x32_bf16 v[160:163], v[156:159], a[140:143], v[160:163]
    v_mfma_f32_16x16x32_bf16 v[14:17], a[144:147], v[156:159], v[14:17]
    v_mfma_f32_16x16x32_bf16 v[18:21], a[148:151], v[156:159], v[18:21]
    v_mfma_f32_16x16x32_bf16 v[160:163], v[156:159], a[152:155], v[160:163]
    v_mfma_f32_16x16x32_bf16 v[14:17], a[156:159], v[156:159], v[14:17]
    v_mfma_f32_16x16x32_bf16 v[18:21], a[160:163], v[156:159], v[18:21]
    v_mfma_f32_16x16x32_bf16 v[160:163], v[156:159], a[164:167], v[160:163]
    v_mfma_f32_16x16x32_bf16 v[14:17], a[168:171], v[156:159], v[14:17]
    v_mfma_f32_16x16x32_bf16 v[18:21], a[172:175], v[156:159], v[18:21]
    v_mfma_f32_16x16x32_bf16 v[160:163], v[156:159], a[176:179], v[160:163]
    v_mfma_f32_16x16x32_bf16 v[14:17], a[180:183], v[156:159], v[14:17]
    v_mfma_f32_16x16x32_bf16 v[18:21], a[184:187], v[156:159], v[18:21]
    v_mfma_f32_16x16x32_bf16 v[160:163], v[156:159], a[188:191], v[160:163]
    s_nop 7
    v_mov_b32 v22, v160
CSS_8:
    ds_read_b128 v[64:67], v4 offset:38912
    s_waitcnt lgkmcnt(6)
    v_mfma_f32_16x16x32_bf16 v[116:119], a[0:3], v[40:43], 0
    v_mfma_f32_16x16x32_bf16 v[120:123], a[4:7], v[40:43], 0
    v_mfma_f32_16x16x32_bf16 v[124:127], v[40:43], a[8:11], 0
    ds_read_b128 v[68:71], v5 offset:38912
    s_waitcnt lgkmcnt(6)
    v_mfma_f32_16x16x32_bf16 v[116:119], a[12:15], v[44:47], v[116:119]
    v_mfma_f32_16x16x32_bf16 v[120:123], a[16:19], v[44:47], v[120:123]
    v_mfma_f32_16x16x32_bf16 v[124:127], v[44:47], a[20:23], v[124:127]
    s_add_u32 m0, s47, 98304
    s_nop 0
    buffer_load_dwordx4 v2, s[16:19], s40 offen sc1 lds
    buffer_load_dwordx4 v3, s[16:19], s40 offen offset:1024 sc1 lds
    s_add_u32 s40, s40, s39
    ds_read_b128 v[40:43], v4 offset:40960
    s_waitcnt lgkmcnt(6)
    v_mfma_f32_16x16x32_bf16 v[116:119], a[24:27], v[48:51], v[116:119]
    v_mfma_f32_16x16x32_bf16 v[120:123], a[28:31], v[48:51], v[120:123]
    v_mfma_f32_16x16x32_bf16 v[124:127], v[48:51], a[32:35], v[124:127]
    ds_read_b128 v[44:47], v5 offset:40960
    s_waitcnt lgkmcnt(6)
    v_mfma_f32_16x16x32_bf16 v[116:119], a[36:39], v[52:55], v[116:119]
    v_mfma_f32_16x16x32_bf16 v[120:123], a[40:43], v[52:55], v[120:123]
    v_mfma_f32_16x16x32_bf16 v[124:127], v[52:55], a[44:47], v[124:127]
    ds_read_b128 v[48:51], v4 offset:43008
    s_waitcnt lgkmcnt(6)
    v_mfma_f32_16x16x32_bf16 v[116:119], a[48:51], v[56:59], v[116:119]
    v_mfma_f32_16x16x32_bf16 v[120:123], a[52:55], v[56:59], v[120:123]
    v_mfma_f32_16x16x32_bf16 v[124:127], v[56:59], a[56:59], v[124:127]
    ds_read_b128 v[52:55], v5 offset:43008
    s_waitcnt lgkmcnt(6)
    v_mfma_f32_16x16x32_bf16 v[116:119], a[60:63], v[60:63], v[116:119]
    v_mfma_f32_16x16x32_bf16 v[120:123], a[64:67], v[60:63], v[120:123]
    v_mfma_f32_16x16x32_bf16 v[124:127], v[60:63], a[68:71], v[124:127]
    s_add_u32 m0, s47, 100352
    s_nop 0
    buffer_load_dwordx4 v2, s[16:19], s40 offen sc1 lds
    buffer_load_dwordx4 v3, s[16:19], s40 offen offset:1024 sc1 lds
    s_add_u32 s40, s40, s39
    ds_read_b128 v[56:59], v4 offset:45056
    s_waitcnt lgkmcnt(6)
    v_mfma_f32_16x16x32_bf16 v[116:119], a[72:75], v[64:67], v[116:119]
    v_mfma_f32_16x16x32_bf16 v[120:123], a[76:79], v[64:67], v[120:123]
    v_mfma_f32_16x16x32_bf16 v[124:127], v[64:67], a[80:83], v[124:127]
    ds_read_b128 v[60:63], v5 offset:45056
    s_waitcnt lgkmcnt(6)
    v_mfma_f32_16x16x32_bf16 v[116:119], a[84:87], v[68:71], v[116:119]
    v_mfma_f32_16x16x32_bf16 v[120:123], a[88:91], v[68:71], v[120:123]
    v_mfma_f32_16x16x32_bf16 v[124:127], v[68:71], a[92:95], v[124:127]
    ds_read_b128 v[64:67], v4 offset:47104
    s_waitcnt lgkmcnt(6)
    v_mfma_f32_16x16x32_bf16 v[116:119], a[96:99], v[40:43], v[116:119]
    v_mfma_f32_16x16x32_bf16 v[120:123], a[100:103], v[40:43], v[120:123]
    v_mfma_f32_16x16x32_bf16 v[124:127], v[40:43], a[104:107], v[124:127]
    ds_read_b128 v[68:71], v5 offset:47104
    s_waitcnt lgkmcnt(6)
    v_mfma_f32_16x16x32_bf16 v[116:119], a[108:111], v[44:47], v[116:119]
    v_mfma_f32_16x16x32_bf16 v[120:123], a[112:115], v[44:47], v[120:123]
    v_mfma_f32_16x16x32_bf16 v[124:127], v[44:47], a[116:119], v[124:127]
    s_add_u32 m0, s47, 102400
    s_nop 0
    buffer_load_dwordx4 v2, s[16:19], s40 offen sc1 lds
    buffer_load_dwordx4 v3, s[16:19], s40 offen offset:1024 sc1 lds
    s_add_u32 s40, s40, s39
    s_waitcnt vmcnt(6)
    s_barrier
    v_add_u32 v4, 0x10000, v4
    v_add_u32 v5, 0x10000, v5
    ds_read_b128 v[40:43], v4 offset:0
    s_waitcnt lgkmcnt(6)
    v_mfma_f32_16x16x32_bf16 v[116:119], a[120:123], v[48:51], v[116:119]
    v_mfma_f32_16x16x32_bf16 v[120:123], a[124:127], v[48:51], v[120:123]
    v_mfma_f32_16x16x32_bf16 v[124:127], v[48:51], a[128:131], v[124:127]
    ds_read_b128 v[44:47], v5 offset:0
    s_waitcnt lgkmcnt(6)
    v_mfma_f32_16x16x32_bf16 v[116:119], a[132:135], v[52:55], v[116:119]
    v_mfma_f32_16x16x32_bf16 v[120:123], a[136:139], v[52:55], v[120:123]
    v_mfma_f32_16x16x32_bf16 v[124:127], v[52:55], a[140:143], v[124:127]
    s_add_u32 m0, s31, 0
    s_add_u32 s29, s30, 0
    buffer_load_dwordx4 v76, s[12:15], s29 offen lds
    ds_read_b128 v[48:51], v4 offset:2048
    s_waitcnt lgkmcnt(6)
    v_mfma_f32_16x16x32_bf16 v[116:119], a[144:147], v[56:59], v[116:119]
    v_mfma_f32_16x16x32_bf16 v[120:123], a[148:151], v[56:59], v[120:123]
    v_mfma_f32_16x16x32_bf16 v[124:127], v[56:59], a[152:155], v[124:127]
    ds_read_b128 v[52:55], v5 offset:2048
    s_waitcnt lgkmcnt(6)
    v_mfma_f32_16x16x32_bf16 v[116:119], a[156:159], v[60:63], v[116:119]
    v_mfma_f32_16x16x32_bf16 v[120:123], a[160:163], v[60:63], v[120:123]
    v_mfma_f32_16x16x32_bf16 v[124:127], v[60:63], a[164:167], v[124:127]
    s_add_u32 m0, s47, 104448
    s_nop 0
    buffer_load_dwordx4 v2, s[16:19], s40 offen sc1 lds
    buffer_load_dwordx4 v3, s[16:19], s40 offen offset:1024 sc1 lds
    s_add_u32 s40, s40, s39
    s_add_u32 s40, s40, s38
    s_add_u32 m0, s31, 1024
    s_add_u32 s29, s30, 57344
    buffer_load_dwordx4 v76, s[12:15], s29 offen lds
    ds_read_b128 v[56:59], v4 offset:4096
    s_waitcnt lgkmcnt(6)
    v_mfma_f32_16x16x32_bf16 v[116:119], a[168:171], v[64:67], v[116:119]
    v_mfma_f32_16x16x32_bf16 v[120:123], a[172:175], v[64:67], v[120:123]
    v_mfma_f32_16x16x32_bf16 v[124:127], v[64:67], a[176:179], v[124:127]
    ds_read_b128 v[60:63], v5 offset:4096
    s_waitcnt lgkmcnt(6)
    v_mfma_f32_16x16x32_bf16 v[116:119], a[180:183], v[68:71], v[116:119]
    v_mfma_f32_16x16x32_bf16 v[120:123], a[184:187], v[68:71], v[120:123]
    v_mfma_f32_16x16x32_bf16 v[124:127], v[68:71], a[188:191], v[124:127]
    s_add_u32 m0, s31, 2048
    s_add_u32 s29, s30, 114688
    buffer_load_dwordx4 v76, s[12:15], s29 offen lds
    ds_read_b128 v[64:67], v4 offset:6144
    s_waitcnt lgkmcnt(6)
    v_mfma_f32_16x16x32_bf16 v[128:131], a[0:3], v[40:43], 0
    v_mfma_f32_16x16x32_bf16 v[132:135], a[4:7], v[40:43], 0
    v_mfma_f32_16x16x32_bf16 v[136:139], v[40:43], a[8:11], 0
    ds_read_b128 v[68:71], v5 offset:6144
    s_waitcnt lgkmcnt(6)
    v_mfma_f32_16x16x32_bf16 v[128:131], a[12:15], v[44:47], v[128:131]
    v_mfma_f32_16x16x32_bf16 v[132:135], a[16:19], v[44:47], v[132:135]
    v_mfma_f32_16x16x32_bf16 v[136:139], v[44:47], a[20:23], v[136:139]
    s_add_u32 m0, s31, 3072
    s_add_u32 s29, s30, 172032
    buffer_load_dwordx4 v76, s[12:15], s29 offen lds
    ds_read_b128 v[40:43], v4 offset:8192
    s_waitcnt lgkmcnt(6)
    v_mfma_f32_16x16x32_bf16 v[128:131], a[24:27], v[48:51], v[128:131]
    v_mfma_f32_16x16x32_bf16 v[132:135], a[28:31], v[48:51], v[132:135]
    v_mfma_f32_16x16x32_bf16 v[136:139], v[48:51], a[32:35], v[136:139]
    ds_read_b128 v[44:47], v5 offset:8192
    s_waitcnt lgkmcnt(6)
    v_mfma_f32_16x16x32_bf16 v[128:131], a[36:39], v[52:55], v[128:131]
    v_mfma_f32_16x16x32_bf16 v[132:135], a[40:43], v[52:55], v[132:135]
    v_mfma_f32_16x16x32_bf16 v[136:139], v[52:55], a[44:47], v[136:139]
    s_add_u32 m0, s31, 4096
    s_add_u32 s29, s30, 229376
    buffer_load_dwordx4 v76, s[12:15], s29 offen lds
    ds_read_b128 v[48:51], v4 offset:10240
    s_waitcnt lgkmcnt(6)
    v_mfma_f32_16x16x32_bf16 v[128:131], a[48:51], v[56:59], v[128:131]
    v_mfma_f32_16x16x32_bf16 v[132:135], a[52:55], v[56:59], v[132:135]
    v_mfma_f32_16x16x32_bf16 v[136:139], v[56:59], a[56:59], v[136:139]
    ds_read_b128 v[52:55], v5 offset:10240
    s_waitcnt lgkmcnt(6)
    v_mfma_f32_16x16x32_bf16 v[128:131], a[60:63], v[60:63], v[128:131]
    v_mfma_f32_16x16x32_bf16 v[132:135], a[64:67], v[60:63], v[132:135]
    v_mfma_f32_16x16x32_bf16 v[136:139], v[60:63], a[68:71], v[136:139]
    s_add_u32 m0, s31, 5120
    s_add_u32 s29, s30, 286720
    buffer_load_dwordx4 v76, s[12:15], s29 offen lds
    ds_read_b128 v[56:59], v4 offset:12288
    s_waitcnt lgkmcnt(6)
    v_mfma_f32_16x16x32_bf16 v[128:131], a[72:75], v[64:67], v[128:131]
    v_mfma_f32_16x16x32_bf16 v[132:135], a[76:79], v[64:67], v[132:135]
    v_mfma_f32_16x16x32_bf16 v[136:139], v[64:67], a[80:83], v[136:139]
    ds_read_b128 v[60:63], v5 offset:12288
    s_waitcnt lgkmcnt(6)
    v_mfma_f32_16x16x32_bf16 v[128:131], a[84:87], v[68:71], v[128:131]
    v_mfma_f32_16x16x32_bf16 v[132:135], a[88:91], v[68:71], v[132:135]
    v_mfma_f32_16x16x32_bf16 v[136:139], v[68:71], a[92:95], v[136:139]
    s_add_u32 m0, s31, 6144
    s_add_u32 s29, s30, 344064
    buffer_load_dwordx4 v76, s[12:15], s29 offen lds
    ds_read_b128 v[64:67], v4 offset:14336
    s_waitcnt lgkmcnt(6)
    v_mfma_f32_16x16x32_bf16 v[128:131], a[96:99], v[40:43], v[128:131]
    v_mfma_f32_16x16x32_bf16 v[132:135], a[100:103], v[40:43], v[132:135]
    v_mfma_f32_16x16x32_bf16 v[136:139], v[40:43], a[104:107], v[136:139]
    ds_read_b128 v[68:71], v5 offset:14336
    s_waitcnt lgkmcnt(6)
    v_mfma_f32_16x16x32_bf16 v[128:131], a[108:111], v[44:47], v[128:131]
    v_mfma_f32_16x16x32_bf16 v[132:135], a[112:115], v[44:47], v[132:135]
    v_mfma_f32_16x16x32_bf16 v[136:139], v[44:47], a[116:119], v[136:139]
    s_add_u32 m0, s31, 7168
    s_add_u32 s29, s30, 401408
    buffer_load_dwordx4 v76, s[12:15], s29 offen lds
    s_waitcnt vmcnt(7)
    s_barrier
    buffer_load_dwordx4 v[208:211], v213, s[8:11], s43 offen sc1
    s_mov_b32 s12, s60
    s_and_b32 s13, s61, 0xffff
    s_mov_b32 s14, 0x1c0000
    s_mov_b32 s15, 0x20000
    ds_read_b128 v[40:43], v4 offset:32768
    s_waitcnt lgkmcnt(6)
    v_mfma_f32_16x16x32_bf16 v[128:131], a[120:123], v[48:51], v[128:131]
    v_mfma_f32_16x16x32_bf16 v[132:135], a[124:127], v[48:51], v[132:135]
    v_mfma_f32_16x16x32_bf16 v[136:139], v[48:51], a[128:131], v[136:139]
    ds_read_b128 v[44:47], v5 offset:32768
    s_waitcnt lgkmcnt(6)
    v_mfma_f32_16x16x32_bf16 v[128:131], a[132:135], v[52:55], v[128:131]
    v_mfma_f32_16x16x32_bf16 v[132:135], a[136:139], v[52:55], v[132:135]
    v_mfma_f32_16x16x32_bf16 v[136:139], v[52:55], a[140:143], v[136:139]
    s_add_u32 m0, s31, 32768
    s_add_u32 s29, s30, 0
    buffer_load_dwordx4 v76, s[12:15], s29 offen lds
    ds_read_b128 v[48:51], v4 offset:34816
    s_waitcnt lgkmcnt(6)
    v_mfma_f32_16x16x32_bf16 v[128:131], a[144:147], v[56:59], v[128:131]
    v_mfma_f32_16x16x32_bf16 v[132:135], a[148:151], v[56:59], v[132:135]
    v_mfma_f32_16x16x32_bf16 v[136:139], v[56:59], a[152:155], v[136:139]
    ds_read_b128 v[52:55], v5 offset:34816
    s_waitcnt lgkmcnt(6)
    v_mfma_f32_16x16x32_bf16 v[128:131], a[156:159], v[60:63], v[128:131]
    v_mfma_f32_16x16x32_bf16 v[132:135], a[160:163], v[60:63], v[132:135]
    v_mfma_f32_16x16x32_bf16 v[136:139], v[60:63], a[164:167], v[136:139]
    s_add_u32 m0, s31, 33792
    s_add_u32 s29, s30, 57344
    buffer_load_dwordx4 v76, s[12:15], s29 offen lds
    ds_read_b128 v[56:59], v4 offset:36864
    s_waitcnt lgkmcnt(6)
    v_mfma_f32_16x16x32_bf16 v[128:131], a[168:171], v[64:67], v[128:131]
    v_mfma_f32_16x16x32_bf16 v[132:135], a[172:175], v[64:67], v[132:135]
    v_mfma_f32_16x16x32_bf16 v[136:139], v[64:67], a[176:179], v[136:139]
    ds_read_b128 v[60:63], v5 offset:36864
    s_waitcnt lgkmcnt(6)
    v_mfma_f32_16x16x32_bf16 v[128:131], a[180:183], v[68:71], v[128:131]
    v_mfma_f32_16x16x32_bf16 v[132:135], a[184:187], v[68:71], v[132:135]
    v_mfma_f32_16x16x32_bf16 v[136:139], v[68:71], a[188:191], v[136:139]
    s_add_u32 m0, s31, 34816
    s_add_u32 s29, s30, 114688
    buffer_load_dwordx4 v76, s[12:15], s29 offen lds
    ds_read_b128 v[64:67], v4 offset:38912
    s_waitcnt lgkmcnt(6)
    v_mfma_f32_16x16x32_bf16 v[140:143], a[0:3], v[40:43], 0
    v_mfma_f32_16x16x32_bf16 v[144:147], a[4:7], v[40:43], 0
    v_mfma_f32_16x16x32_bf16 v[148:151], v[40:43], a[8:11], 0
    ds_read_b128 v[68:71], v5 offset:38912
    s_waitcnt lgkmcnt(6)
    v_mfma_f32_16x16x32_bf16 v[140:143], a[12:15], v[44:47], v[140:143]
    v_mfma_f32_16x16x32_bf16 v[144:147], a[16:19], v[44:47], v[144:147]
    v_mfma_f32_16x16x32_bf16 v[148:151], v[44:47], a[20:23], v[148:151]
    s_add_u32 m0, s31, 35840
    s_add_u32 s29, s30, 172032
    buffer_load_dwordx4 v76, s[12:15], s29 offen lds
    ds_read_b128 v[40:43], v4 offset:40960
    s_waitcnt lgkmcnt(6)
    v_mfma_f32_16x16x32_bf16 v[140:143], a[24:27], v[48:51], v[140:143]
    v_mfma_f32_16x16x32_bf16 v[144:147], a[28:31], v[48:51], v[144:147]
    v_mfma_f32_16x16x32_bf16 v[148:151], v[48:51], a[32:35], v[148:151]
    ds_read_b128 v[44:47], v5 offset:40960
    s_waitcnt lgkmcnt(6)
    v_mfma_f32_16x16x32_bf16 v[140:143], a[36:39], v[52:55], v[140:143]
    v_mfma_f32_16x16x32_bf16 v[144:147], a[40:43], v[52:55], v[144:147]
    v_mfma_f32_16x16x32_bf16 v[148:151], v[52:55], a[44:47], v[148:151]
    s_add_u32 m0, s31, 36864
    s_add_u32 s29, s30, 229376
    buffer_load_dwordx4 v76, s[12:15], s29 offen lds
    ds_read_b128 v[48:51], v4 offset:43008
    s_waitcnt lgkmcnt(6)
    v_mfma_f32_16x16x32_bf16 v[140:143], a[48:51], v[56:59], v[140:143]
    v_mfma_f32_16x16x32_bf16 v[144:147], a[52:55], v[56:59], v[144:147]
    v_mfma_f32_16x16x32_bf16 v[148:151], v[56:59], a[56:59], v[148:151]
    ds_read_b128 v[52:55], v5 offset:43008
    s_waitcnt lgkmcnt(6)
    v_mfma_f32_16x16x32_bf16 v[140:143], a[60:63], v[60:63], v[140:143]
    v_mfma_f32_16x16x32_bf16 v[144:147], a[64:67], v[60:63], v[144:147]
    v_mfma_f32_16x16x32_bf16 v[148:151], v[60:63], a[68:71], v[148:151]
    s_add_u32 m0, s31, 37888
    s_add_u32 s29, s30, 286720
    buffer_load_dwordx4 v76, s[12:15], s29 offen lds
    ds_read_b128 v[56:59], v4 offset:45056
    s_waitcnt lgkmcnt(6)
    v_mfma_f32_16x16x32_bf16 v[140:143], a[72:75], v[64:67], v[140:143]
    v_mfma_f32_16x16x32_bf16 v[144:147], a[76:79], v[64:67], v[144:147]
    v_mfma_f32_16x16x32_bf16 v[148:151], v[64:67], a[80:83], v[148:151]
    ds_read_b128 v[60:63], v5 offset:45056
    s_waitcnt lgkmcnt(6)
    v_mfma_f32_16x16x32_bf16 v[140:143], a[84:87], v[68:71], v[140:143]
    v_mfma_f32_16x16x32_bf16 v[144:147], a[88:91], v[68:71], v[144:147]
    v_mfma_f32_16x16x32_bf16 v[148:151], v[68:71], a[92:95], v[148:151]
    s_add_u32 m0, s31, 38912
    s_add_u32 s29, s30, 344064
    buffer_load_dwordx4 v76, s[12:15], s29 offen lds
    ds_read_b128 v[64:67], v4 offset:47104
    s_waitcnt lgkmcnt(6)
    v_mfma_f32_16x16x32_bf16 v[140:143], a[96:99], v[40:43], v[140:143]
    v_mfma_f32_16x16x32_bf16 v[144:147], a[100:103], v[40:43], v[144:147]
    v_mfma_f32_16x16x32_bf16 v[148:151], v[40:43], a[104:107], v[148:151]
    ds_read_b128 v[68:71], v5 offset:47104
    s_waitcnt lgkmcnt(6)
    v_mfma_f32_16x16x32_bf16 v[140:143], a[108:111], v[44:47], v[140:143]
    v_mfma_f32_16x16x32_bf16 v[144:147], a[112:115], v[44:47], v[144:147]
    v_mfma_f32_16x16x32_bf16 v[148:151], v[44:47], a[116:119], v[148:151]
    s_add_u32 m0, s31, 39936
    s_add_u32 s29, s30, 401408
    buffer_load_dwordx4 v76, s[12:15], s29 offen lds
    s_waitcnt lgkmcnt(5)
    v_mfma_f32_16x16x32_bf16 v[140:143], a[120:123], v[48:51], v[140:143]
    v_mfma_f32_16x16x32_bf16 v[144:147], a[124:127], v[48:51], v[144:147]
    v_mfma_f32_16x16x32_bf16 v[148:151], v[48:51], a[128:131], v[148:151]
    s_waitcnt lgkmcnt(4)
    v_mfma_f32_16x16x32_bf16 v[140:143], a[132:135], v[52:55], v[140:143]
    v_mfma_f32_16x16x32_bf16 v[144:147], a[136:139], v[52:55], v[144:147]
    v_mfma_f32_16x16x32_bf16 v[148:151], v[52:55], a[140:143], v[148:151]
    s_waitcnt lgkmcnt(3)
    v_mfma_f32_16x16x32_bf16 v[140:143], a[144:147], v[56:59], v[140:143]
    v_mfma_f32_16x16x32_bf16 v[144:147], a[148:151], v[56:59], v[144:147]
    v_mfma_f32_16x16x32_bf16 v[148:151], v[56:59], a[152:155], v[148:151]
    s_waitcnt lgkmcnt(2)
    v_mfma_f32_16x16x32_bf16 v[140:143], a[156:159], v[60:63], v[140:143]
    v_mfma_f32_16x16x32_bf16 v[144:147], a[160:163], v[60:63], v[144:147]
    v_mfma_f32_16x16x32_bf16 v[148:151], v[60:63], a[164:167], v[148:151]
    s_waitcnt lgkmcnt(1)
    v_mfma_f32_16x16x32_bf16 v[140:143], a[168:171], v[64:67], v[140:143]
    v_mfma_f32_16x16x32_bf16 v[144:147], a[172:175], v[64:67], v[144:147]
    v_mfma_f32_16x16x32_bf16 v[148:151], v[64:67], a[176:179], v[148:151]
    s_waitcnt lgkmcnt(0)
    v_mfma_f32_16x16x32_bf16 v[140:143], a[180:183], v[68:71], v[140:143]
    v_mfma_f32_16x16x32_bf16 v[144:147], a[184:187], v[68:71], v[144:147]
    v_mfma_f32_16x16x32_bf16 v[148:151], v[68:71], a[188:191], v[148:151]
    s_branch GEMME_5
GEMMFF_6:
    ds_read_b128 v[40:43], v4 offset:0
    ds_read_b128 v[44:47], v5 offset:0
    ds_read_b128 v[48:51], v4 offset:2048
    ds_read_b128 v[52:55], v5 offset:2048
    ds_read_b128 v[56:59], v4 offset:4096
    ds_read_b128 v[60:63], v5 offset:4096
    ds_read_b128 v[64:67], v4 offset:6144
    s_waitcnt lgkmcnt(6)
    v_mfma_f32_16x16x32_bf16 v[104:107], a[0:3], v[40:43], 0
    v_mfma_f32_16x16x32_bf16 v[108:111], a[4:7], v[40:43], 0
    v_mfma_f32_16x16x32_bf16 v[112:115], v[40:43], a[8:11], 0
    ds_read_b128 v[68:71], v5 offset:6144
    s_waitcnt lgkmcnt(6)
    v_mfma_f32_16x16x32_bf16 v[104:107], a[12:15], v[44:47], v[104:107]
    v_mfma_f32_16x16x32_bf16 v[108:111], a[16:19], v[44:47], v[108:111]
    v_mfma_f32_16x16x32_bf16 v[112:115], v[44:47], a[20:23], v[112:115]
    s_add_u32 m0, s47, 65536
    s_nop 0
    buffer_load_dwordx4 v2, s[16:19], s40 offen sc1 lds
    buffer_load_dwordx4 v3, s[16:19], s40 offen offset:1024 sc1 lds
    s_add_u32 s40, s40, s39
    ds_read_b128 v[40:43], v4 offset:8192
    s_waitcnt lgkmcnt(6)
    v_mfma_f32_16x16x32_bf16 v[104:107], a[24:27], v[48:51], v[104:107]
    v_mfma_f32_16x16x32_bf16 v[108:111], a[28:31], v[48:51], v[108:111]
    v_mfma_f32_16x16x32_bf16 v[112:115], v[48:51], a[32:35], v[112:115]
    ds_read_b128 v[44:47], v5 offset:8192
    s_waitcnt lgkmcnt(6)
    v_mfma_f32_16x16x32_bf16 v[104:107], a[36:39], v[52:55], v[104:107]
    v_mfma_f32_16x16x32_bf16 v[108:111], a[40:43], v[52:55], v[108:111]
    v_mfma_f32_16x16x32_bf16 v[112:115], v[52:55], a[44:47], v[112:115]
    ds_read_b128 v[48:51], v4 offset:10240
    s_waitcnt lgkmcnt(6)
    v_mfma_f32_16x16x32_bf16 v[104:107], a[48:51], v[56:59], v[104:107]
    v_mfma_f32_16x16x32_bf16 v[108:111], a[52:55], v[56:59], v[108:111]
    v_mfma_f32_16x16x32_bf16 v[112:115], v[56:59], a[56:59], v[112:115]
    ds_read_b128 v[52:55], v5 offset:10240
    s_waitcnt lgkmcnt(6)
    v_mfma_f32_16x16x32_bf16 v[104:107], a[60:63], v[60:63], v[104:107]
    v_mfma_f32_16x16x32_bf16 v[108:111], a[64:67], v[60:63], v[108:111]
    v_mfma_f32_16x16x32_bf16 v[112:115], v[60:63], a[68:71], v[112:115]
    s_add_u32 m0, s47, 67584
    s_nop 0
    buffer_load_dwordx4 v2, s[16:19], s40 offen sc1 lds
    buffer_load_dwordx4 v3, s[16:19], s40 offen offset:1024 sc1 lds
    s_add_u32 s40, s40, s39
    ds_read_b128 v[56:59], v4 offset:12288
    s_waitcnt lgkmcnt(6)
    v_mfma_f32_16x16x32_bf16 v[104:107], a[72:75], v[64:67], v[104:107]
    v_mfma_f32_16x16x32_bf16 v[108:111], a[76:79], v[64:67], v[108:111]
    v_mfma_f32_16x16x32_bf16 v[112:115], v[64:67], a[80:83], v[112:115]
    ds_read_b128 v[60:63], v5 offset:12288
    s_waitcnt lgkmcnt(6)
    v_mfma_f32_16x16x32_bf16 v[104:107], a[84:87], v[68:71], v[104:107]
    v_mfma_f32_16x16x32_bf16 v[108:111], a[88:91], v[68:71], v[108:111]
    v_mfma_f32_16x16x32_bf16 v[112:115], v[68:71], a[92:95], v[112:115]
    ds_read_b128 v[64:67], v4 offset:14336
    s_waitcnt lgkmcnt(6)
    v_mfma_f32_16x16x32_bf16 v[104:107], a[96:99], v[40:43], v[104:107]
    v_mfma_f32_16x16x32_bf16 v[108:111], a[100:103], v[40:43], v[108:111]
    v_mfma_f32_16x16x32_bf16 v[112:115], v[40:43], a[104:107], v[112:115]
    ds_read_b128 v[68:71], v5 offset:14336
    s_waitcnt lgkmcnt(6)
    v_mfma_f32_16x16x32_bf16 v[104:107], a[108:111], v[44:47], v[104:107]
    v_mfma_f32_16x16x32_bf16 v[108:111], a[112:115], v[44:47], v[108:111]
    v_mfma_f32_16x16x32_bf16 v[112:115], v[44:47], a[116:119], v[112:115]
    s_add_u32 m0, s47, 69632
    s_nop 0
    buffer_load_dwordx4 v2, s[16:19], s40 offen sc1 lds
    buffer_load_dwordx4 v3, s[16:19], s40 offen offset:1024 sc1 lds
    s_add_u32 s40, s40, s39
    s_waitcnt vmcnt(6)
    s_barrier
    ds_read_b128 v[40:43], v4 offset:32768
    s_waitcnt lgkmcnt(6)
    v_mfma_f32_16x16x32_bf16 v[104:107], a[120:123], v[48:51], v[104:107]
    v_mfma_f32_16x16x32_bf16 v[108:111], a[124:127], v[48:51], v[108:111]
    v_mfma_f32_16x16x32_bf16 v[112:115], v[48:51], a[128:131], v[112:115]
    v_cmp_ne_u32 vcc, s23, v207
    s_nop 1
    s_cmp_eq_u64 vcc, 0
    s_cbranch_scc0 FFB_9
FFR_10:
    v_mov_b32 v192, v204
    s_nop 1
    v_max_f32_dpp v192, v192, v192 quad_perm:[1,0,3,2] row_mask:0xf bank_mask:0xf
    ds_read_b128 v[44:47], v5 offset:32768
    s_waitcnt lgkmcnt(6)
    v_mfma_f32_16x16x32_bf16 v[104:107], a[132:135], v[52:55], v[104:107]
    v_mfma_f32_16x16x32_bf16 v[108:111], a[136:139], v[52:55], v[108:111]
    v_mfma_f32_16x16x32_bf16 v[112:115], v[52:55], a[140:143], v[112:115]
    v_max_f32_dpp v192, v192, v192 quad_perm:[2,3,0,1] row_mask:0xf bank_mask:0xf
    s_nop 1
    v_max_f32_dpp v192, v192, v192 row_half_mirror row_mask:0xf bank_mask:0xf
    s_nop 1
    v_max_f32_dpp v192, v192, v192 row_mirror row_mask:0xf bank_mask:0xf
    v_mov_b32 v194, v192
    s_nop 1
    v_permlane16_swap_b32 v192, v194
    v_max_f32 v192, v192, v194
    ds_read_b128 v[48:51], v4 offset:34816
    s_waitcnt lgkmcnt(6)
    v_mfma_f32_16x16x32_bf16 v[104:107], a[144:147], v[56:59], v[104:107]
    v_mfma_f32_16x16x32_bf16 v[108:111], a[148:151], v[56:59], v[108:111]
    v_mfma_f32_16x16x32_bf16 v[112:115], v[56:59], a[152:155], v[112:115]
    v_mov_b32 v194, v192
    s_nop 1
    v_permlane32_swap_b32 v192, v194
    v_max_f32 v192, v192, v194
    v_cmp_eq_f32 vcc, v192, v204
    s_nop 1
    s_ff1_i32_b64 s28, vcc
    s_nop 3
    ds_read_b128 v[52:55], v5 offset:34816
    s_waitcnt lgkmcnt(6)
    v_mfma_f32_16x16x32_bf16 v[104:107], a[156:159], v[60:63], v[104:107]
    v_mfma_f32_16x16x32_bf16 v[108:111], a[160:163], v[60:63], v[108:111]
    v_mfma_f32_16x16x32_bf16 v[112:115], v[60:63], a[164:167], v[112:115]
    s_add_u32 m0, s47, 71680
    s_nop 0
    buffer_load_dwordx4 v2, s[16:19], s40 offen sc1 lds
    buffer_load_dwordx4 v3, s[16:19], s40 offen offset:1024 sc1 lds
    s_add_u32 s40, s40, s39
    s_add_u32 s40, s40, s38
    v_readlane_b32 s41, v205, s28
    v_readlane_b32 s42, v204, s28
    s_nop 0
    s_lshr_b32 s25, s41, 8
    s_lshr_b32 s26, s41, 6
    s_and_b32 s26, s26, 3
    s_lshl_b32 s27, s26, 13
    ds_read_b128 v[56:59], v4 offset:36864
    s_waitcnt lgkmcnt(6)
    v_mfma_f32_16x16x32_bf16 v[104:107], a[168:171], v[64:67], v[104:107]
    v_mfma_f32_16x16x32_bf16 v[108:111], a[172:175], v[64:67], v[108:111]
    v_mfma_f32_16x16x32_bf16 v[112:115], v[64:67], a[176:179], v[112:115]
    s_lshl_b32 s28, s25, 7
    s_add_u32 s27, s27, s28
    s_add_u32 s31, s27, 0x21000
    v_and_b32 v186, 15, v1
    v_lshrrev_b32 v187, 1, v186
    v_and_b32 v186, 1, v186
    ds_read_b128 v[60:63], v5 offset:36864
    s_waitcnt lgkmcnt(6)
    v_mfma_f32_16x16x32_bf16 v[104:107], a[180:183], v[68:71], v[104:107]
    v_mfma_f32_16x16x32_bf16 v[108:111], a[184:187], v[68:71], v[108:111]
    v_mfma_f32_16x16x32_bf16 v[112:115], v[68:71], a[188:191], v[112:115]
    v_lshlrev_b32 v186, 2, v186
    v_lshl_add_u32 v215, v187, 10, v186
    s_lshl_b32 s30, s41, 4
    s_add_u32 s30, s30, 0x50000
    buffer_load_dword v216, v215, s[8:11], s31 offen sc1
    buffer_load_dwordx4 v[76:79], off, s[8:11], s30 sc1
    ds_read_b128 v[64:67], v4 offset:38912
    s_waitcnt lgkmcnt(6)
    v_mfma_f32_16x16x32_bf16 v[116:119], a[0:3], v[40:43], 0
    v_mfma_f32_16x16x32_bf16 v[120:123], a[4:7], v[40:43], 0
    v_mfma_f32_16x16x32_bf16 v[124:127], v[40:43], a[8:11], 0
    ds_read_b128 v[68:71], v5 offset:38912
    s_waitcnt lgkmcnt(6)
    v_mfma_f32_16x16x32_bf16 v[116:119], a[12:15], v[44:47], v[116:119]
    v_mfma_f32_16x16x32_bf16 v[120:123], a[16:19], v[44:47], v[120:123]
    v_mfma_f32_16x16x32_bf16 v[124:127], v[44:47], a[20:23], v[124:127]
    s_add_u32 m0, s47, 98304
    s_nop 0
    buffer_load_dwordx4 v2, s[16:19], s40 offen sc1 lds
    buffer_load_dwordx4 v3, s[16:19], s40 offen offset:1024 sc1 lds
    s_add_u32 s40, s40, s39
    ds_read_b128 v[40:43], v4 offset:40960
    s_waitcnt lgkmcnt(6)
    v_mfma_f32_16x16x32_bf16 v[116:119], a[24:27], v[48:51], v[116:119]
    v_mfma_f32_16x16x32_bf16 v[120:123], a[28:31], v[48:51], v[120:123]
    v_mfma_f32_16x16x32_bf16 v[124:127], v[48:51], a[32:35], v[124:127]
    ds_read_b128 v[44:47], v5 offset:40960
    s_waitcnt lgkmcnt(6)
    v_mfma_f32_16x16x32_bf16 v[116:119], a[36:39], v[52:55], v[116:119]
    v_mfma_f32_16x16x32_bf16 v[120:123], a[40:43], v[52:55], v[120:123]
    v_mfma_f32_16x16x32_bf16 v[124:127], v[52:55], a[44:47], v[124:127]
    ds_read_b128 v[48:51], v4 offset:43008
    s_waitcnt lgkmcnt(6)
    v_mfma_f32_16x16x32_bf16 v[116:119], a[48:51], v[56:59], v[116:119]
    v_mfma_f32_16x16x32_bf16 v[120:123], a[52:55], v[56:59], v[120:123]
    v_mfma_f32_16x16x32_bf16 v[124:127], v[56:59], a[56:59], v[124:127]
    ds_read_b128 v[52:55], v5 offset:43008
    s_waitcnt lgkmcnt(6)
    v_mfma_f32_16x16x32_bf16 v[116:119], a[60:63], v[60:63], v[116:119]
    v_mfma_f32_16x16x32_bf16 v[120:123], a[64:67], v[60:63], v[120:123]
    v_mfma_f32_16x16x32_bf16 v[124:127], v[60:63], a[68:71], v[124:127]
    s_add_u32 m0, s47, 100352
    s_nop 0
    buffer_load_dwordx4 v2, s[16:19], s40 offen sc1 lds
    buffer_load_dwordx4 v3, s[16:19], s40 offen offset:1024 sc1 lds
    s_add_u32 s40, s40, s39
    ds_read_b128 v[56:59], v4 offset:45056
    s_waitcnt lgkmcnt(6)
    v_mfma_f32_16x16x32_bf16 v[116:119], a[72:75], v[64:67], v[116:119]
    v_mfma_f32_16x16x32_bf16 v[120:123], a[76:79], v[64:67], v[120:123]
    v_mfma_f32_16x16x32_bf16 v[124:127], v[64:67], a[80:83], v[124:127]
    ds_read_b128 v[60:63], v5 offset:45056
    s_waitcnt lgkmcnt(6)
    v_mfma_f32_16x16x32_bf16 v[116:119], a[84:87], v[68:71], v[116:119]
    v_mfma_f32_16x16x32_bf16 v[120:123], a[88:91], v[68:71], v[120:123]
    v_mfma_f32_16x16x32_bf16 v[124:127], v[68:71], a[92:95], v[124:127]
    ds_read_b128 v[64:67], v4 offset:47104
    s_waitcnt lgkmcnt(6)
    v_mfma_f32_16x16x32_bf16 v[116:119], a[96:99], v[40:43], v[116:119]
    v_mfma_f32_16x16x32_bf16 v[120:123], a[100:103], v[40:43], v[120:123]
    v_mfma_f32_16x16x32_bf16 v[124:127], v[40:43], a[104:107], v[124:127]
    ds_read_b128 v[68:71], v5 offset:47104
    s_waitcnt lgkmcnt(6)
    v_mfma_f32_16x16x32_bf16 v[116:119], a[108:111], v[44:47], v[116:119]
    v_mfma_f32_16x16x32_bf16 v[120:123], a[112:115], v[44:47], v[120:123]
    v_mfma_f32_16x16x32_bf16 v[124:127], v[44:47], a[116:119], v[124:127]
    s_add_u32 m0, s47, 102400
    s_nop 0
    buffer_load_dwordx4 v2, s[16:19], s40 offen sc1 lds
    buffer_load_dwordx4 v3, s[16:19], s40 offen offset:1024 sc1 lds
    s_add_u32 s40, s40, s39
    s_waitcnt vmcnt(8)
    s_barrier
    v_add_u32 v4, 0x10000, v4
    v_add_u32 v5, 0x10000, v5
    ds_read_b128 v[40:43], v4 offset:0
    s_waitcnt lgkmcnt(6)
    v_mfma_f32_16x16x32_bf16 v[116:119], a[120:123], v[48:51], v[116:119]
    v_mfma_f32_16x16x32_bf16 v[120:123], a[124:127], v[48:51], v[120:123]
    v_mfma_f32_16x16x32_bf16 v[124:127], v[48:51], a[128:131], v[124:127]
    ds_read_b128 v[44:47], v5 offset:0
    s_waitcnt lgkmcnt(6)
    v_mfma_f32_16x16x32_bf16 v[116:119], a[132:135], v[52:55], v[116:119]
    v_mfma_f32_16x16x32_bf16 v[120:123], a[136:139], v[52:55], v[120:123]
    v_mfma_f32_16x16x32_bf16 v[124:127], v[52:55], a[140:143], v[124:127]
    s_waitcnt vmcnt(6)
    v_cmp_ne_u32 vcc, s23, v216
    s_nop 1
    s_cmp_eq_u64 vcc, 0
    s_cbranch_scc0 FFB_11
FFR_12:
    v_cmp_ne_u32 vcc, s23, v79
    s_nop 1
    s_cmp_eq_u64 vcc, 0
    s_cbranch_scc0 FFB_13
FFR_14:
    ds_read_b128 v[48:51], v4 offset:2048
    s_waitcnt lgkmcnt(6)
    v_mfma_f32_16x16x32_bf16 v[116:119], a[144:147], v[56:59], v[116:119]
    v_mfma_f32_16x16x32_bf16 v[120:123], a[148:151], v[56:59], v[120:123]
    v_mfma_f32_16x16x32_bf16 v[124:127], v[56:59], a[152:155], v[124:127]
    s_lshr_b32 s25, s41, 8
    s_and_b32 s26, s41, 255
    s_lshl_b32 s27, s25, 18
    s_lshl_b32 s28, s26, 7
    s_add_u32 s27, s27, s28
    s_add_u32 s27, s27, 0xd00000
    ds_read_b128 v[52:55], v5 offset:2048
    s_waitcnt lgkmcnt(6)
    v_mfma_f32_16x16x32_bf16 v[116:119], a[156:159], v[60:63], v[116:119]
    v_mfma_f32_16x16x32_bf16 v[120:123], a[160:163], v[60:63], v[120:123]
    v_mfma_f32_16x16x32_bf16 v[124:127], v[60:63], a[164:167], v[124:127]
    s_add_u32 m0, s47, 104448
    s_nop 0
    buffer_load_dwordx4 v2, s[16:19], s40 offen sc1 lds
    buffer_load_dwordx4 v3, s[16:19], s40 offen offset:1024 sc1 lds
    s_add_u32 s40, s40, s39
    s_add_u32 s40, s40, s38
    s_and_b32 s26, s26, 15
    s_lshr_b32 s26, s26, 1
    v_and_b32 v186, 7, v1
    v_xor_b32 v186, s26, v186
    v_lshlrev_b32 v186, 4, v186
    v_lshrrev_b32 v187, 3, v1
    ds_read_b128 v[56:59], v4 offset:4096
    s_waitcnt lgkmcnt(6)
    v_mfma_f32_16x16x32_bf16 v[116:119], a[168:171], v[64:67], v[116:119]
    v_mfma_f32_16x16x32_bf16 v[120:123], a[172:175], v[64:67], v[120:123]
    v_mfma_f32_16x16x32_bf16 v[124:127], v[64:67], a[176:179], v[124:127]
    v_lshl_add_u32 v186, v187, 15, v186
    buffer_load_dwordx4 v[72:75], v186, s[8:11], s27 offen sc1
    ds_read_b128 v[60:63], v5 offset:4096
    s_waitcnt lgkmcnt(6)
    v_mfma_f32_16x16x32_bf16 v[116:119], a[180:183], v[68:71], v[116:119]
    v_mfma_f32_16x16x32_bf16 v[120:123], a[184:187], v[68:71], v[120:123]
    v_mfma_f32_16x16x32_bf16 v[124:127], v[68:71], a[188:191], v[124:127]
    ds_read_b128 v[64:67], v4 offset:6144
    s_waitcnt lgkmcnt(6)
    v_mfma_f32_16x16x32_bf16 v[128:131], a[0:3], v[40:43], 0
    v_mfma_f32_16x16x32_bf16 v[132:135], a[4:7], v[40:43], 0
    v_mfma_f32_16x16x32_bf16 v[136:139], v[40:43], a[8:11], 0
    ds_read_b128 v[68:71], v5 offset:6144
    s_waitcnt lgkmcnt(6)
    v_mfma_f32_16x16x32_bf16 v[128:131], a[12:15], v[44:47], v[128:131]
    v_mfma_f32_16x16x32_bf16 v[132:135], a[16:19], v[44:47], v[132:135]
    v_mfma_f32_16x16x32_bf16 v[136:139], v[44:47], a[20:23], v[136:139]
    ds_read_b128 v[40:43], v4 offset:8192
    s_waitcnt lgkmcnt(6)
    v_mfma_f32_16x16x32_bf16 v[128:131], a[24:27], v[48:51], v[128:131]
    v_mfma_f32_16x16x32_bf16 v[132:135], a[28:31], v[48:51], v[132:135]
    v_mfma_f32_16x16x32_bf16 v[136:139], v[48:51], a[32:35], v[136:139]
    ds_read_b128 v[44:47], v5 offset:8192
    s_waitcnt lgkmcnt(6)
    v_mfma_f32_16x16x32_bf16 v[128:131], a[36:39], v[52:55], v[128:131]
    v_mfma_f32_16x16x32_bf16 v[132:135], a[40:43], v[52:55], v[132:135]
    v_mfma_f32_16x16x32_bf16 v[136:139], v[52:55], a[44:47], v[136:139]
    ds_read_b128 v[48:51], v4 offset:10240
    s_waitcnt lgkmcnt(6)
    v_mfma_f32_16x16x32_bf16 v[128:131], a[48:51], v[56:59], v[128:131]
    v_mfma_f32_16x16x32_bf16 v[132:135], a[52:55], v[56:59], v[132:135]
    v_mfma_f32_16x16x32_bf16 v[136:139], v[56:59], a[56:59], v[136:139]
    ds_read_b128 v[52:55], v5 offset:10240
    s_waitcnt lgkmcnt(6)
    v_mfma_f32_16x16x32_bf16 v[128:131], a[60:63], v[60:63], v[128:131]
    v_mfma_f32_16x16x32_bf16 v[132:135], a[64:67], v[60:63], v[132:135]
    v_mfma_f32_16x16x32_bf16 v[136:139], v[60:63], a[68:71], v[136:139]
    ds_read_b128 v[56:59], v4 offset:12288
    s_waitcnt lgkmcnt(6)
    v_mfma_f32_16x16x32_bf16 v[128:131], a[72:75], v[64:67], v[128:131]
    v_mfma_f32_16x16x32_bf16 v[132:135], a[76:79], v[64:67], v[132:135]
    v_mfma_f32_16x16x32_bf16 v[136:139], v[64:67], a[80:83], v[136:139]
    ds_read_b128 v[60:63], v5 offset:12288
    s_waitcnt lgkmcnt(6)
    v_mfma_f32_16x16x32_bf16 v[128:131], a[84:87], v[68:71], v[128:131]
    v_mfma_f32_16x16x32_bf16 v[132:135], a[88:91], v[68:71], v[132:135]
    v_mfma_f32_16x16x32_bf16 v[136:139], v[68:71], a[92:95], v[136:139]
    ds_read_b128 v[64:67], v4 offset:14336
    s_waitcnt lgkmcnt(6)
    v_mfma_f32_16x16x32_bf16 v[128:131], a[96:99], v[40:43], v[128:131]
    v_mfma_f32_16x16x32_bf16 v[132:135], a[100:103], v[40:43], v[132:135]
    v_mfma_f32_16x16x32_bf16 v[136:139], v[40:43], a[104:107], v[136:139]
    ds_read_b128 v[68:71], v5 offset:14336
    s_waitcnt lgkmcnt(6)
    v_mfma_f32_16x16x32_bf16 v[128:131], a[108:111], v[44:47], v[128:131]
    v_mfma_f32_16x16x32_bf16 v[132:135], a[112:115], v[44:47], v[132:135]
    v_mfma_f32_16x16x32_bf16 v[136:139], v[44:47], a[116:119], v[136:139]
    s_waitcnt vmcnt(0)
    v_lshlrev_b32 v188, 16, v72
    v_and_b32 v189, 0xffff0000, v72
    v_lshlrev_b32 v190, 16, v73
    v_and_b32 v191, 0xffff0000, v73
    v_lshlrev_b32 v192, 16, v74
    v_and_b32 v193, 0xffff0000, v74
    s_waitcnt vmcnt(0)
    s_barrier
    buffer_load_dwordx4 v[208:211], v213, s[8:11], s43 offen sc1
    ds_read_b128 v[40:43], v4 offset:32768
    s_waitcnt lgkmcnt(6)
    v_mfma_f32_16x16x32_bf16 v[128:131], a[120:123], v[48:51], v[128:131]
    v_mfma_f32_16x16x32_bf16 v[132:135], a[124:127], v[48:51], v[132:135]
    v_mfma_f32_16x16x32_bf16 v[136:139], v[48:51], a[128:131], v[136:139]
    v_lshlrev_b32 v194, 16, v75
    v_and_b32 v195, 0xffff0000, v75
    v_mul_f32 v76, v76, v77
    v_fma_f32 v188, v188, v77, -v76
    v_fma_f32 v189, v189, v77, -v76
    v_fma_f32 v190, v190, v77, -v76
    ds_read_b128 v[44:47], v5 offset:32768
    s_waitcnt lgkmcnt(6)
    v_mfma_f32_16x16x32_bf16 v[128:131], a[132:135], v[52:55], v[128:131]
    v_mfma_f32_16x16x32_bf16 v[132:135], a[136:139], v[52:55], v[132:135]
    v_mfma_f32_16x16x32_bf16 v[136:139], v[52:55], a[140:143], v[136:139]
    v_fma_f32 v191, v191, v77, -v76
    v_fma_f32 v192, v192, v77, -v76
    v_fma_f32 v193, v193, v77, -v76
    v_fma_f32 v194, v194, v77, -v76
    v_fma_f32 v195, v195, v77, -v76
    v_cvt_pk_bf16_f32 v200, v188, v189
    ds_read_b128 v[48:51], v4 offset:34816
    s_waitcnt lgkmcnt(6)
    v_mfma_f32_16x16x32_bf16 v[128:131], a[144:147], v[56:59], v[128:131]
    v_mfma_f32_16x16x32_bf16 v[132:135], a[148:151], v[56:59], v[132:135]
    v_mfma_f32_16x16x32_bf16 v[136:139], v[56:59], a[152:155], v[136:139]
    v_cvt_pk_bf16_f32 v201, v190, v191
    v_cvt_pk_bf16_f32 v202, v192, v193
    v_cvt_pk_bf16_f32 v203, v194, v195
    s_lshl_b32 s25, s22, 10
    s_add_u32 s25, s25, 158720
    v_add_u32 v186, s25, v7
    ds_read_b128 v[52:55], v5 offset:34816
    s_waitcnt lgkmcnt(6)
    v_mfma_f32_16x16x32_bf16 v[128:131], a[156:159], v[60:63], v[128:131]
    v_mfma_f32_16x16x32_bf16 v[132:135], a[160:163], v[60:63], v[132:135]
    v_mfma_f32_16x16x32_bf16 v[136:139], v[60:63], a[164:167], v[136:139]
    ds_write_b128 v186, v[200:203]
    v_lshlrev_b32 v186, 4, v25
    v_add_u32 v186, s25, v186
    ds_read_b128 v[56:59], v4 offset:36864
    s_waitcnt lgkmcnt(6)
    v_mfma_f32_16x16x32_bf16 v[128:131], a[168:171], v[64:67], v[128:131]
    v_mfma_f32_16x16x32_bf16 v[132:135], a[172:175], v[64:67], v[132:135]
    v_mfma_f32_16x16x32_bf16 v[136:139], v[64:67], a[176:179], v[136:139]
    ds_read_b128 v[60:63], v5 offset:36864
    s_waitcnt lgkmcnt(6)
    v_mfma_f32_16x16x32_bf16 v[128:131], a[180:183], v[68:71], v[128:131]
    v_mfma_f32_16x16x32_bf16 v[132:135], a[184:187], v[68:71], v[132:135]
    v_mfma_f32_16x16x32_bf16 v[136:139], v[68:71], a[188:191], v[136:139]
    s_waitcnt lgkmcnt(2)
    ds_read_b128 v[152:155], v186 offset:0
    ds_read_b128 v[156:159], v186 offset:64
    ds_read_b128 v[160:163], v186 offset:128
    ds_read_b128 v[164:167], v186 offset:192
    ds_read_b128 v[168:171], v186 offset:256
    ds_read_b128 v[64:67], v4 offset:38912
    s_waitcnt lgkmcnt(6)
    v_mfma_f32_16x16x32_bf16 v[140:143], a[0:3], v[40:43], 0
    v_mfma_f32_16x16x32_bf16 v[144:147], a[4:7], v[40:43], 0
    v_mfma_f32_16x16x32_bf16 v[148:151], v[40:43], a[8:11], 0
    ds_read_b128 v[172:175], v186 offset:320
    ds_read_b128 v[176:179], v186 offset:384
    ds_read_b128 v[180:183], v186 offset:448
    ds_read_b128 v[68:71], v5 offset:38912
    s_waitcnt lgkmcnt(6)
    v_mfma_f32_16x16x32_bf16 v[140:143], a[12:15], v[44:47], v[140:143]
    v_mfma_f32_16x16x32_bf16 v[144:147], a[16:19], v[44:47], v[144:147]
    v_mfma_f32_16x16x32_bf16 v[148:151], v[44:47], a[20:23], v[148:151]
    ds_read_b128 v[40:43], v4 offset:40960
    s_waitcnt lgkmcnt(6)
    v_mfma_f32_16x16x32_bf16 v[140:143], a[24:27], v[48:51], v[140:143]
    v_mfma_f32_16x16x32_bf16 v[144:147], a[28:31], v[48:51], v[144:147]
    v_mfma_f32_16x16x32_bf16 v[148:151], v[48:51], a[32:35], v[148:151]
    s_waitcnt lgkmcnt(2)
    v_mfma_f32_16x16x32_bf16 v[188:191], a[192:195], v[152:155], 0
    v_mfma_f32_16x16x32_bf16 v[188:191], a[196:199], v[156:159], v[188:191]
    v_mfma_f32_16x16x32_bf16 v[188:191], a[200:203], v[160:163], v[188:191]
    v_mfma_f32_16x16x32_bf16 v[188:191], a[204:207], v[164:167], v[188:191]
    v_mfma_f32_16x16x32_bf16 v[188:191], a[208:211], v[168:171], v[188:191]
    ds_read_b128 v[44:47], v5 offset:40960
    s_waitcnt lgkmcnt(6)
    v_mfma_f32_16x16x32_bf16 v[140:143], a[36:39], v[52:55], v[140:143]
    v_mfma_f32_16x16x32_bf16 v[144:147], a[40:43], v[52:55], v[144:147]
    v_mfma_f32_16x16x32_bf16 v[148:151], v[52:55], a[44:47], v[148:151]
    v_mfma_f32_16x16x32_bf16 v[188:191], a[212:215], v[172:175], v[188:191]
    v_mfma_f32_16x16x32_bf16 v[188:191], a[216:219], v[176:179], v[188:191]
    v_mfma_f32_16x16x32_bf16 v[188:191], a[220:223], v[180:183], v[188:191]
    ds_read_b128 v[152:155], v186 offset:512
    ds_read_b128 v[156:159], v186 offset:576
    ds_read_b128 v[160:163], v186 offset:640
    ds_read_b128 v[48:51], v4 offset:43008
    s_waitcnt lgkmcnt(6)
    v_mfma_f32_16x16x32_bf16 v[140:143], a[48:51], v[56:59], v[140:143]
    v_mfma_f32_16x16x32_bf16 v[144:147], a[52:55], v[56:59], v[144:147]
    v_mfma_f32_16x16x32_bf16 v[148:151], v[56:59], a[56:59], v[148:151]
    ds_read_b128 v[164:167], v186 offset:704
    ds_read_b128 v[168:171], v186 offset:768
    ds_read_b128 v[172:175], v186 offset:832
    ds_read_b128 v[176:179], v186 offset:896
    ds_read_b128 v[180:183], v186 offset:960
    ds_read_b128 v[52:55], v5 offset:43008
    s_waitcnt lgkmcnt(6)
    v_mfma_f32_16x16x32_bf16 v[140:143], a[60:63], v[60:63], v[140:143]
    v_mfma_f32_16x16x32_bf16 v[144:147], a[64:67], v[60:63], v[144:147]
    v_mfma_f32_16x16x32_bf16 v[148:151], v[60:63], a[68:71], v[148:151]
    ds_read_b128 v[56:59], v4 offset:45056
    s_waitcnt lgkmcnt(6)
    v_mfma_f32_16x16x32_bf16 v[140:143], a[72:75], v[64:67], v[140:143]
    v_mfma_f32_16x16x32_bf16 v[144:147], a[76:79], v[64:67], v[144:147]
    v_mfma_f32_16x16x32_bf16 v[148:151], v[64:67], a[80:83], v[148:151]
    s_waitcnt lgkmcnt(2)
    v_mfma_f32_16x16x32_bf16 v[188:191], a[224:227], v[152:155], v[188:191]
    v_mfma_f32_16x16x32_bf16 v[188:191], a[228:231], v[156:159], v[188:191]
    v_mfma_f32_16x16x32_bf16 v[188:191], a[232:235], v[160:163], v[188:191]
    v_mfma_f32_16x16x32_bf16 v[188:191], a[236:239], v[164:167], v[188:191]
    v_mfma_f32_16x16x32_bf16 v[188:191], a[240:243], v[168:171], v[188:191]
    ds_read_b128 v[60:63], v5 offset:45056
    s_waitcnt lgkmcnt(6)
    v_mfma_f32_16x16x32_bf16 v[140:143], a[84:87], v[68:71], v[140:143]
    v_mfma_f32_16x16x32_bf16 v[144:147], a[88:91], v[68:71], v[144:147]
    v_mfma_f32_16x16x32_bf16 v[148:151], v[68:71], a[92:95], v[148:151]
    v_mfma_f32_16x16x32_bf16 v[188:191], a[244:247], v[172:175], v[188:191]
    v_mfma_f32_16x16x32_bf16 v[188:191], a[248:251], v[176:179], v[188:191]
    v_mfma_f32_16x16x32_bf16 v[188:191], a[252:255], v[180:183], v[188:191]
    s_lshl_b32 s25, s22, 6
    s_add_u32 s25, s25, 158464
    v_lshlrev_b32 v186, 4, v25
    ds_read_b128 v[64:67], v4 offset:47104
    s_waitcnt lgkmcnt(6)
    v_mfma_f32_16x16x32_bf16 v[140:143], a[96:99], v[40:43], v[140:143]
    v_mfma_f32_16x16x32_bf16 v[144:147], a[100:103], v[40:43], v[144:147]
    v_mfma_f32_16x16x32_bf16 v[148:151], v[40:43], a[104:107], v[148:151]
    v_add_u32 v186, s25, v186
    s_mov_b32 s28, 0x00010001
    s_mov_b32 s29, 0x00010001
    s_mov_b64 exec, s[28:29]
    ds_write_b128 v186, v[188:191]
    s_mov_b64 exec, -1
    ds_read_b128 v[68:71], v5 offset:47104
    s_waitcnt lgkmcnt(6)
    v_mfma_f32_16x16x32_bf16 v[140:143], a[108:111], v[44:47], v[140:143]
    v_mfma_f32_16x16x32_bf16 v[144:147], a[112:115], v[44:47], v[144:147]
    v_mfma_f32_16x16x32_bf16 v[148:151], v[44:47], a[116:119], v[148:151]
    s_waitcnt lgkmcnt(5)
    v_mfma_f32_16x16x32_bf16 v[140:143], a[120:123], v[48:51], v[140:143]
    v_mfma_f32_16x16x32_bf16 v[144:147], a[124:127], v[48:51], v[144:147]
    v_mfma_f32_16x16x32_bf16 v[148:151], v[48:51], a[128:131], v[148:151]
    s_waitcnt lgkmcnt(1)
    s_barrier
    v_lshlrev_b32 v186, 5, v25
    v_add_u32 v186, 158464, v186
    ds_read_b128 v[168:171], v186
    ds_read_b128 v[172:175], v186 offset:16
    s_waitcnt lgkmcnt(4)
    v_mfma_f32_16x16x32_bf16 v[140:143], a[132:135], v[52:55], v[140:143]
    v_mfma_f32_16x16x32_bf16 v[144:147], a[136:139], v[52:55], v[144:147]
    v_mfma_f32_16x16x32_bf16 v[148:151], v[52:55], a[140:143], v[148:151]
    ds_read_b128 v[176:179], v186 offset:128
    ds_read_b128 v[180:183], v186 offset:144
    s_mov_b32 s25, 0xbfb8aa3b
    v_mov_b32 v196, s42
    v_mul_f32 v196, s25, v196
    s_waitcnt lgkmcnt(3)
    v_mfma_f32_16x16x32_bf16 v[140:143], a[144:147], v[56:59], v[140:143]
    v_mfma_f32_16x16x32_bf16 v[144:147], a[148:151], v[56:59], v[144:147]
    v_mfma_f32_16x16x32_bf16 v[148:151], v[56:59], a[152:155], v[148:151]
    s_waitcnt lgkmcnt(2)
    v_mfma_f32_16x16x32_bf16 v[140:143], a[156:159], v[60:63], v[140:143]
    v_mfma_f32_16x16x32_bf16 v[144:147], a[160:163], v[60:63], v[144:147]
    v_mfma_f32_16x16x32_bf16 v[148:151], v[60:63], a[164:167], v[148:151]
    s_waitcnt lgkmcnt(0)
    v_mul_f32 v188, s25, v168
    v_mul_f32 v189, s25, v169
    v_mul_f32 v190, s25, v170
    v_mul_f32 v191, s25, v171
    v_mul_f32 v192, s25, v172
    s_waitcnt lgkmcnt(1)
    v_mfma_f32_16x16x32_bf16 v[140:143], a[168:171], v[64:67], v[140:143]
    v_mfma_f32_16x16x32_bf16 v[144:147], a[172:175], v[64:67], v[144:147]
    v_mfma_f32_16x16x32_bf16 v[148:151], v[64:67], a[176:179], v[148:151]
    v_mul_f32 v193, s25, v173
    v_mul_f32 v194, s25, v174
    v_mul_f32 v195, s25, v175
    v_exp_f32 v188, v188
    v_exp_f32 v189, v189
    v_exp_f32 v190, v190
    s_waitcnt lgkmcnt(0)
    v_mfma_f32_16x16x32_bf16 v[140:143], a[180:183], v[68:71], v[140:143]
    v_mfma_f32_16x16x32_bf16 v[144:147], a[184:187], v[68:71], v[144:147]
    v_mfma_f32_16x16x32_bf16 v[148:151], v[68:71], a[188:191], v[148:151]
    v_exp_f32 v191, v191
    v_exp_f32 v192, v192
    v_exp_f32 v193, v193
    v_exp_f32 v194, v194
    v_exp_f32 v195, v195
    v_exp_f32 v196, v196
    v_add_f32 v188, 1.0, v188
    v_add_f32 v189, 1.0, v189
    v_add_f32 v190, 1.0, v190
    v_add_f32 v191, 1.0, v191
    v_add_f32 v192, 1.0, v192
    v_add_f32 v193, 1.0, v193
    v_add_f32 v194, 1.0, v194
    v_add_f32 v195, 1.0, v195
    v_add_f32 v196, 1.0, v196
    v_rcp_f32 v188, v188
    v_rcp_f32 v189, v189
    v_rcp_f32 v190, v190
    v_rcp_f32 v191, v191
    v_rcp_f32 v192, v192
    v_rcp_f32 v193, v193
    v_rcp_f32 v194, v194
    v_rcp_f32 v195, v195
    v_rcp_f32 v196, v196
    v_mul_f32 v168, v168, v176
    v_mul_f32 v169, v169, v177
    v_mul_f32 v170, v170, v178
    v_mul_f32 v171, v171, v179
    v_mul_f32 v172, v172, v180
    v_mul_f32 v173, v173, v181
    v_mul_f32 v174, v174, v182
    v_mul_f32 v175, v175, v183
    v_mul_f32 v168, v168, v188
    v_mul_f32 v169, v169, v189
    v_mul_f32 v170, v170, v190
    v_mul_f32 v171, v171, v191
    v_mul_f32 v172, v172, v192
    v_mul_f32 v173, v173, v193
    v_mul_f32 v174, v174, v194
    v_mul_f32 v175, v175, v195
    v_cvt_pk_bf16_f32 v184, v168, v169
    v_cvt_pk_bf16_f32 v185, v170, v171
    v_cvt_pk_bf16_f32 v186, v172, v173
    v_cvt_pk_bf16_f32 v187, v174, v175
    s_nop 1
    v_mfma_f32_16x16x32_bf16 v[152:155], v[184:187], v[224:227], 0
    v_mfma_f32_16x16x32_bf16 v[156:159], v[184:187], v[228:231], 0
    v_mfma_f32_16x16x32_bf16 v[160:163], v[184:187], v[232:235], 0
    v_mfma_f32_16x16x32_bf16 v[164:167], v[184:187], v[236:239], 0
    v_mfma_f32_16x16x32_bf16 v[168:171], v[184:187], v[240:243], 0
    v_mfma_f32_16x16x32_bf16 v[172:175], v[184:187], v[244:247], 0
    v_mfma_f32_16x16x32_bf16 v[176:179], v[184:187], v[248:251], 0
    v_mfma_f32_16x16x32_bf16 v[180:183], v[184:187], v[252:255], 0
    v_cmp_le_u32 s[28:29], 1, v25
    v_cmp_le_u32 s[30:31], 2, v25
    v_cmp_le_u32 vcc, 3, v25
    v_cndmask_b32 v190, v152, v156, s[28:29]
    v_cndmask_b32 v190, v190, v160, s[30:31]
    v_cndmask_b32 v190, v190, v164, vcc
    v_mul_f32 v190, v196, v190
    v_cndmask_b32 v192, v168, v172, s[28:29]
    v_cndmask_b32 v192, v192, v176, s[30:31]
    v_cndmask_b32 v192, v192, v180, vcc
    v_mul_f32 v192, v196, v192
    s_and_b32 s25, s2, 1
    s_lshl_b32 s25, s25, 11
    s_lshl_b32 s26, s22, 9
    s_add_u32 s25, s25, s26
    s_add_u32 s25, s25, 0xe2000
    v_lshlrev_b32 v186, 2, v1
    buffer_atomic_add_f32 v190, v186, s[8:11], s25 offen
    buffer_atomic_add_f32 v192, v186, s[8:11], s25 offen offset:256
    s_branch GEMME_5
FFB_9:
    s_mov_b32 s33, 0xe0000
    s_mov_b32 s76, 0
POLL_15:
    buffer_load_dwordx4 v[204:207], v214, s[8:11], s33 offen sc1
    s_waitcnt vmcnt(0)
    v_xor_b32 v219, s23, v207
    v_cmp_ne_u32 vcc, 0, v219
    s_nop 1
    s_cmp_eq_u64 vcc, 0
    s_cbranch_scc1 POLD_16
    s_sleep 4
    s_add_u32 s76, s76, 1
    s_cmp_lt_u32 s76, 0x40000
    s_cbranch_scc1 POLL_15
    s_mov_b32 s12, s66
    s_and_b32 s13, s67, 0xffff
    s_mov_b32 s14, 0x100
    s_mov_b32 s15, 0x20000
    v_mov_b32 v221, 7
    buffer_store_dword v221, off, s[12:15], 0
    s_waitcnt vmcnt(0)
POLD_16:
    s_branch FFR_10
FFB_11:
    s_mov_b32 s76, 0
POLL_18:
    buffer_load_dword v216, v215, s[8:11], s31 offen sc1
    s_waitcnt vmcnt(0)
    v_xor_b32 v219, s23, v216
    v_cmp_ne_u32 vcc, 0, v219
    s_nop 1
    s_cmp_eq_u64 vcc, 0
    s_cbranch_scc1 POLD_19
    s_sleep 4
    s_add_u32 s76, s76, 1
    s_cmp_lt_u32 s76, 0x40000
    s_cbranch_scc1 POLL_18
    s_mov_b32 s12, s66
    s_and_b32 s13, s67, 0xffff
    s_mov_b32 s14, 0x100
    s_mov_b32 s15, 0x20000
    v_mov_b32 v221, 8
    buffer_store_dword v221, off, s[12:15], 0
    s_waitcnt vmcnt(0)
POLD_19:
    s_branch FFR_12
FFB_13:
    v_mov_b32 v217, 0
    s_mov_b32 s76, 0
POLL_22:
    buffer_load_dwordx4 v[76:79], v217, s[8:11], s30 offen sc1
    s_waitcnt vmcnt(0)
    v_xor_b32 v219, s23, v79
    v_cmp_ne_u32 vcc, 0, v219
    s_nop 1
    s_cmp_eq_u64 vcc, 0
    s_cbranch_scc1 POLD_23
    s_sleep 4
    s_add_u32 s76, s76, 1
    s_cmp_lt_u32 s76, 0x40000
    s_cbranch_scc1 POLL_22
    s_mov_b32 s12, s66
    s_and_b32 s13, s67, 0xffff
    s_mov_b32 s14, 0x100
    s_mov_b32 s15, 0x20000
    v_mov_b32 v221, 16
    buffer_store_dword v221, off, s[12:15], 0
    s_waitcnt vmcnt(0)
POLD_23:
    s_branch FFR_14
GEMME_5:
    v_subrev_u32 v4, 0x10000, v4
    v_subrev_u32 v5, 0x10000, v5
    s_cmp_lg_u32 s24, 0
    s_cbranch_scc1 GP1_25
    s_cmp_lg_u32 s72, 1
    s_cbranch_scc1 GW0_27
    s_waitcnt vmcnt(8)
    s_branch GW2_28
GW0_27:
    s_waitcnt vmcnt(0)
GW2_28:
    v_cmp_ne_u32 vcc, s23, v211
    s_nop 1
    s_cmp_eq_u64 vcc, 0
    s_cbranch_scc1 PND_29
    s_mov_b32 s76, 0
POLL_30:
    buffer_load_dwordx4 v[208:211], v213, s[8:11], s43 offen sc1
    s_waitcnt vmcnt(0)
    v_xor_b32 v219, s23, v211
    v_cmp_ne_u32 vcc, 0, v219
    s_nop 1
    s_cmp_eq_u64 vcc, 0
    s_cbranch_scc1 POLD_31
    s_sleep 4
    s_add_u32 s76, s76, 1
    s_cmp_lt_u32 s76, 0x40000
    s_cbranch_scc1 POLL_30
    s_mov_b32 s12, s66
    s_and_b32 s13, s67, 0xffff
    s_mov_b32 s14, 0x100
    s_mov_b32 s15, 0x20000
    v_mov_b32 v221, 1
    buffer_store_dword v221, off, s[12:15], 0
    s_waitcnt vmcnt(0)
POLD_31:
PND_29:
    s_branch GP2_26
GP1_25:
    s_mov_b32 s33, 0xe0000
    s_mov_b32 s76, 0
    s_branch POLC_35
POLL_33:
    buffer_load_dwordx4 v[208:211], v213, s[8:11], s43 offen sc1
    buffer_load_dwordx4 v[204:207], v214, s[8:11], s33 offen sc1
POLC_35:
    s_waitcnt vmcnt(0)
    v_xor_b32 v219, s23, v211
    v_xor_b32 v218, s23, v207
    v_or_b32 v219, v219, v218
    v_cmp_ne_u32 vcc, 0, v219
    s_nop 1
    s_cmp_eq_u64 vcc, 0
    s_cbranch_scc1 POLD_34
    s_sleep 4
    s_add_u32 s76, s76, 1
    s_cmp_lt_u32 s76, 0x40000
    s_cbranch_scc1 POLL_33
    s_mov_b32 s12, s66
    s_and_b32 s13, s67, 0xffff
    s_mov_b32 s14, 0x100
    s_mov_b32 s15, 0x20000
    v_mov_b32 v221, 15
    buffer_store_dword v221, off, s[12:15], 0
    s_waitcnt vmcnt(0)
POLD_34:
    s_cmp_eq_u32 s24, 0
    s_cbranch_scc1 FN1_36
    s_sub_u32 s3, s2, 8
    s_cmp_ge_u32 s3, 56
    s_cbranch_scc1 FN1_36
    s_lshl_b32 s25, s2, 7
    s_lshl_b32 s26, s22, 2
    s_add_u32 s25, s25, s26
    s_add_u32 s25, s25, 0x31000
    v_mov_b32 v220, s23
    s_mov_b64 exec, 1
    buffer_store_dword v220, off, s[8:11], s25 sc1
    s_mov_b64 exec, -1
FN1_36:
    v_mov_b32 v192, v204
    s_nop 1
    v_max_f32_dpp v192, v192, v192 quad_perm:[1,0,3,2] row_mask:0xf bank_mask:0xf
    s_nop 1
    v_max_f32_dpp v192, v192, v192 quad_perm:[2,3,0,1] row_mask:0xf bank_mask:0xf
    s_nop 1
    v_max_f32_dpp v192, v192, v192 row_half_mirror row_mask:0xf bank_mask:0xf
    s_nop 1
    v_max_f32_dpp v192, v192, v192 row_mirror row_mask:0xf bank_mask:0xf
    v_mov_b32 v194, v192
    s_nop 1
    v_permlane16_swap_b32 v192, v194
    v_max_f32 v192, v192, v194
    v_mov_b32 v194, v192
    s_nop 1
    v_permlane32_swap_b32 v192, v194
    v_max_f32 v192, v192, v194
    v_cmp_eq_f32 vcc, v192, v204
    s_nop 1
    s_ff1_i32_b64 s28, vcc
    s_nop 3
    v_readlane_b32 s41, v205, s28
    v_readlane_b32 s42, v204, s28
GP2_26:
    v_lshlrev_b32 v212, 3, v212
    v_add_u32 v212, 156416, v212
    v_mov_b32 v209, v210
    ds_write_b64 v212, v[208:209]
    s_waitcnt lgkmcnt(0)
    s_barrier
    s_mov_b32 s25, 0x3eb8aa3b
    s_lshl_b32 s26, s35, 9
    s_add_u32 s26, s26, 156416
    v_lshl_add_u32 v152, v13, 3, s26
    v_lshl_add_u32 v153, v25, 5, s26
    ds_read_b64 v[156:157], v152 offset:0
    ds_read_b128 v[164:167], v153 offset:0
    ds_read_b128 v[168:171], v153 offset:16
    ds_read_b64 v[158:159], v152 offset:128
    ds_read_b128 v[172:175], v153 offset:128
    ds_read_b128 v[176:179], v153 offset:144
    ds_read_b64 v[160:161], v152 offset:256
    ds_read_b128 v[180:183], v153 offset:256
    ds_read_b128 v[184:187], v153 offset:272
    ds_read_b64 v[162:163], v152 offset:384
    ds_read_b128 v[188:191], v153 offset:384
    ds_read_b128 v[192:195], v153 offset:400
    v_add_u32 v210, 8192, v11
    s_lshl_b32 s26, s34, 12
    v_add_u32 v210, s26, v210
    s_waitcnt lgkmcnt(9)
    v_mul_f32 v196, s25, v157
    v_pk_fma_f32 v[104:105], v[14:15], v[156:157], v[104:105] op_sel_hi:[1,0,1] neg_lo:[0,1,0] neg_hi:[0,1,0]
    v_pk_fma_f32 v[108:109], v[18:19], v[156:157], v[108:109] op_sel_hi:[1,0,1] neg_lo:[0,1,0] neg_hi:[0,1,0]
    v_pk_fma_f32 v[106:107], v[16:17], v[156:157], v[106:107] op_sel_hi:[1,0,1] neg_lo:[0,1,0] neg_hi:[0,1,0]
    v_pk_fma_f32 v[110:111], v[20:21], v[156:157], v[110:111] op_sel_hi:[1,0,1] neg_lo:[0,1,0] neg_hi:[0,1,0]
    v_fma_f32 v112, -v164, v22, v112
    v_fma_f32 v113, -v166, v22, v113
    v_fma_f32 v114, -v168, v22, v114
    v_fma_f32 v115, -v170, v22, v115
    v_pk_mul_f32 v[104:105], v[104:105], v[196:197] op_sel_hi:[1,0]
    v_pk_mul_f32 v[108:109], v[108:109], v[156:157] op_sel:[0,1] op_sel_hi:[1,1]
    v_pk_mul_f32 v[106:107], v[106:107], v[196:197] op_sel_hi:[1,0]
    v_pk_mul_f32 v[110:111], v[110:111], v[156:157] op_sel:[0,1] op_sel_hi:[1,1]
    v_mul_f32 v112, v165, v112
    v_mul_f32 v113, v167, v113
    v_mul_f32 v114, v169, v114
    v_mul_f32 v115, v171, v115
    v_cvt_pk_bf16_f32 v198, v104, v105
    v_cvt_pk_bf16_f32 v199, v106, v107
    v_cvt_pk_bf16_f32 v200, v108, v109
    v_cvt_pk_bf16_f32 v201, v110, v111
    v_cvt_pk_bf16_f32 v202, v112, v113
    v_cvt_pk_bf16_f32 v203, v114, v115
    ds_write_b64 v11, v[198:199] offset:0
    ds_write_b64 v210, v[200:201] offset:0
    v_xor_b32 v197, 0, v12
    ds_write_b64 v197, v[202:203]
    s_waitcnt lgkmcnt(9)
    v_mul_f32 v196, s25, v159
    v_pk_fma_f32 v[116:117], v[14:15], v[158:159], v[116:117] op_sel_hi:[1,0,1] neg_lo:[0,1,0] neg_hi:[0,1,0]
    v_pk_fma_f32 v[120:121], v[18:19], v[158:159], v[120:121] op_sel_hi:[1,0,1] neg_lo:[0,1,0] neg_hi:[0,1,0]
    v_pk_fma_f32 v[118:119], v[16:17], v[158:159], v[118:119] op_sel_hi:[1,0,1] neg_lo:[0,1,0] neg_hi:[0,1,0]
    v_pk_fma_f32 v[122:123], v[20:21], v[158:159], v[122:123] op_sel_hi:[1,0,1] neg_lo:[0,1,0] neg_hi:[0,1,0]
    v_fma_f32 v124, -v172, v22, v124
    v_fma_f32 v125, -v174, v22, v125
    v_fma_f32 v126, -v176, v22, v126
    v_fma_f32 v127, -v178, v22, v127
    v_pk_mul_f32 v[116:117], v[116:117], v[196:197] op_sel_hi:[1,0]
    v_pk_mul_f32 v[120:121], v[120:121], v[158:159] op_sel:[0,1] op_sel_hi:[1,1]
    v_pk_mul_f32 v[118:119], v[118:119], v[196:197] op_sel_hi:[1,0]
    v_pk_mul_f32 v[122:123], v[122:123], v[158:159] op_sel:[0,1] op_sel_hi:[1,1]
    v_mul_f32 v124, v173, v124
    v_mul_f32 v125, v175, v125
    v_mul_f32 v126, v177, v126
    v_mul_f32 v127, v179, v127
    v_cvt_pk_bf16_f32 v204, v116, v117
    v_cvt_pk_bf16_f32 v205, v118, v119
    v_cvt_pk_bf16_f32 v206, v120, v121
    v_cvt_pk_bf16_f32 v207, v122, v123
    v_cvt_pk_bf16_f32 v208, v124, v125
    v_cvt_pk_bf16_f32 v209, v126, v127
    ds_write_b64 v11, v[204:205] offset:256
    ds_write_b64 v210, v[206:207] offset:256
    v_xor_b32 v197, 32, v12
    ds_write_b64 v197, v[208:209]
    s_waitcnt lgkmcnt(9)
    v_mul_f32 v196, s25, v161
    v_pk_fma_f32 v[128:129], v[14:15], v[160:161], v[128:129] op_sel_hi:[1,0,1] neg_lo:[0,1,0] neg_hi:[0,1,0]
    v_pk_fma_f32 v[132:133], v[18:19], v[160:161], v[132:133] op_sel_hi:[1,0,1] neg_lo:[0,1,0] neg_hi:[0,1,0]
    v_pk_fma_f32 v[130:131], v[16:17], v[160:161], v[130:131] op_sel_hi:[1,0,1] neg_lo:[0,1,0] neg_hi:[0,1,0]
    v_pk_fma_f32 v[134:135], v[20:21], v[160:161], v[134:135] op_sel_hi:[1,0,1] neg_lo:[0,1,0] neg_hi:[0,1,0]
    v_fma_f32 v136, -v180, v22, v136
    v_fma_f32 v137, -v182, v22, v137
    v_fma_f32 v138, -v184, v22, v138
    v_fma_f32 v139, -v186, v22, v139
    v_pk_mul_f32 v[128:129], v[128:129], v[196:197] op_sel_hi:[1,0]
    v_pk_mul_f32 v[132:133], v[132:133], v[160:161] op_sel:[0,1] op_sel_hi:[1,1]
    v_pk_mul_f32 v[130:131], v[130:131], v[196:197] op_sel_hi:[1,0]
    v_pk_mul_f32 v[134:135], v[134:135], v[160:161] op_sel:[0,1] op_sel_hi:[1,1]
    v_mul_f32 v136, v181, v136
    v_mul_f32 v137, v183, v137
    v_mul_f32 v138, v185, v138
    v_mul_f32 v139, v187, v139
    v_cvt_pk_bf16_f32 v198, v128, v129
    v_cvt_pk_bf16_f32 v199, v130, v131
    v_cvt_pk_bf16_f32 v200, v132, v133
    v_cvt_pk_bf16_f32 v201, v134, v135
    v_cvt_pk_bf16_f32 v202, v136, v137
    v_cvt_pk_bf16_f32 v203, v138, v139
    ds_write_b64 v11, v[198:199] offset:512
    ds_write_b64 v210, v[200:201] offset:512
    v_xor_b32 v197, 64, v12
    ds_write_b64 v197, v[202:203]
    s_waitcnt lgkmcnt(9)
    v_mul_f32 v196, s25, v163
    v_pk_fma_f32 v[140:141], v[14:15], v[162:163], v[140:141] op_sel_hi:[1,0,1] neg_lo:[0,1,0] neg_hi:[0,1,0]
    v_pk_fma_f32 v[144:145], v[18:19], v[162:163], v[144:145] op_sel_hi:[1,0,1] neg_lo:[0,1,0] neg_hi:[0,1,0]
    v_pk_fma_f32 v[142:143], v[16:17], v[162:163], v[142:143] op_sel_hi:[1,0,1] neg_lo:[0,1,0] neg_hi:[0,1,0]
    v_pk_fma_f32 v[146:147], v[20:21], v[162:163], v[146:147] op_sel_hi:[1,0,1] neg_lo:[0,1,0] neg_hi:[0,1,0]
    v_fma_f32 v148, -v188, v22, v148
    v_fma_f32 v149, -v190, v22, v149
    v_fma_f32 v150, -v192, v22, v150
    v_fma_f32 v151, -v194, v22, v151
    v_pk_mul_f32 v[140:141], v[140:141], v[196:197] op_sel_hi:[1,0]
    v_pk_mul_f32 v[144:145], v[144:145], v[162:163] op_sel:[0,1] op_sel_hi:[1,1]
    v_pk_mul_f32 v[142:143], v[142:143], v[196:197] op_sel_hi:[1,0]
    v_pk_mul_f32 v[146:147], v[146:147], v[162:163] op_sel:[0,1] op_sel_hi:[1,1]
    v_mul_f32 v148, v189, v148
    v_mul_f32 v149, v191, v149
    v_mul_f32 v150, v193, v150
    v_mul_f32 v151, v195, v151
    v_cvt_pk_bf16_f32 v204, v140, v141
    v_cvt_pk_bf16_f32 v205, v142, v143
    v_cvt_pk_bf16_f32 v206, v144, v145
    v_cvt_pk_bf16_f32 v207, v146, v147
    v_cvt_pk_bf16_f32 v208, v148, v149
    v_cvt_pk_bf16_f32 v209, v150, v151
    ds_write_b64 v11, v[204:205] offset:768
    ds_write_b64 v210, v[206:207] offset:768
    v_xor_b32 v197, 96, v12
    ds_write_b64 v197, v[208:209]
    s_waitcnt lgkmcnt(0)
    s_barrier
    s_mov_b32 s47, 3
    s_cmp_eq_u32 s24, 0
    s_cbranch_scc1 ZZ_37
    s_lshr_b32 s25, s41, 7
    s_sub_u32 s25, s36, s25
    s_cmp_gt_u32 s25, 2
    s_cbranch_scc1 ZZ_37
    s_mov_b32 s47, s25
    s_cmp_eq_u32 s25, 0
    s_cbranch_scc0 ZZ_37
    s_cmp_lg_u32 s35, 0
    s_cbranch_scc1 ZZW_38
    v_mov_b32 v188, 0
    v_mov_b32 v189, 0
    s_and_b32 s29, s41, 127
    s_lshr_b32 s30, s29, 4
    s_lshl_b32 s30, s30, 1
    s_lshr_b32 s28, s29, 2
    s_and_b32 s28, s28, 1
    s_add_u32 s30, s30, s28
    s_lshr_b32 s31, s29, 3
    s_and_b32 s31, s31, 1
    s_lshl_b32 s31, s31, 2
    s_and_b32 s28, s29, 3
    s_add_u32 s31, s31, s28
    s_lshl_b32 s31, s31, 1
    s_mov_b32 s27, 139264
    s_cmp_eq_u32 s47, 1
    s_cselect_b32 s27, 16384, s27
    s_cmp_eq_u32 s47, 2
    s_cselect_b32 s27, 0, s27
    s_lshl_b32 s26, s34, 13
    s_add_u32 s27, s27, s26
    v_lshrrev_b32 v186, 1, v25
    v_lshlrev_b32 v186, 11, v186
    v_and_b32 v187, 1, v25
    v_lshl_add_u32 v186, v187, 3, v186
    s_lshl_b32 s26, s29, 4
    s_add_u32 s26, s26, s27
    v_add_u32 v187, s26, v186
    s_mov_b32 vcc_lo, 0x00010001
    s_mov_b32 vcc_hi, 0x00010001
    s_mov_b64 exec, vcc
    ds_write_b64 v187, v[188:189]
    s_mov_b64 exec, 0xffff
    v_xor_b32 v187, s30, v13
    v_lshlrev_b32 v187, 4, v187
    v_lshl_add_u32 v187, v13, 8, v187
    s_add_u32 s26, s27, 4096
    s_add_u32 s26, s26, s31
    v_add_u32 v187, s26, v187
    ds_write_b16 v187, v188
    s_mov_b32 s27, 155648
    s_cmp_eq_u32 s47, 1
    s_cselect_b32 s27, 156160, s27
    s_cmp_eq_u32 s47, 2
    s_cselect_b32 s27, 155904, s27
    s_lshl_b32 s26, s30, 4
    s_add_u32 s27, s27, s26
    s_add_u32 s27, s27, s31
    v_mov_b32 v187, s27
    v_mov_b32 v185, 0x0
    ds_write_b16 v187, v185
    s_mov_b64 exec, -1
    s_waitcnt lgkmcnt(0)
ZZW_38:
    s_barrier
ZZ_37:
    v_add_u32 v186, 139264, v8
    ds_read_b128 v[188:191], v186 offset:0
    ds_read_b128 v[192:195], v186 offset:4096
    ds_read_b128 v[196:199], v186 offset:8192
    ds_read_b128 v[200:203], v186 offset:12288
    s_lshl_b32 s25, s36, 4
    s_add_u32 s25, s25, s45
    s_lshl_b32 s25, s25, 14
    s_lshl_b32 s26, s24, 22
    s_add_u32 s25, s25, s26
    s_add_u32 s25, s25, 0x100000
    v_and_b32 v186, 31, v1
    v_lshrrev_b32 v187, 5, v1
    v_lshlrev_b32 v204, 11, v187
    v_lshl_add_u32 v204, v186, 4, v204
    s_lshl_b32 s26, s34, 12
    s_add_u32 s26, s26, 131072
    s_lshl_b32 s27, s35, 9
    s_add_u32 s28, s26, s27
    v_add_u32 v205, s28, v204
    s_sub_u32 s28, s26, s27
    s_add_u32 s28, s28, 1536
    v_add_u32 v206, s28, v204
    ds_read_b128 v[40:43], v205
    ds_read_b128 v[44:47], v206
    s_waitcnt lgkmcnt(2)
    s_add_u32 s26, s25, 0
    buffer_store_dwordx4 v[188:191], v8, s[8:11], s26 offen sc1
    s_add_u32 s26, s25, 4096
    buffer_store_dwordx4 v[192:195], v8, s[8:11], s26 offen sc1
    s_add_u32 s26, s25, 8192
    buffer_store_dwordx4 v[196:199], v8, s[8:11], s26 offen sc1
    s_add_u32 s26, s25, 12288
    buffer_store_dwordx4 v[200:203], v8, s[8:11], s26 offen sc1
    v_and_b32 v186, 31, v1
    v_lshrrev_b32 v187, 5, v1
    v_and_b32 v205, 15, v186
    v_xor_b32 v206, v187, v205
    v_lshlrev_b32 v206, 4, v206
    v_lshl_add_u32 v205, v205, 8, v206
    v_cmp_gt_u32 s[32:33], 16, v186
    v_lshlrev_b32 v209, 4, v187
    v_and_b32 v210, 31, v1
    v_lshrrev_b32 v206, 5, v1
    v_lshlrev_b32 v206, 2, v206
    v_sub_u32 v210, v210, v206
    v_mov_b32 v206, 0xf149f2ca
    v_mov_b32 v207, 0
    v_cmp_le_i32 s[28:29], 0, v210
    v_cmp_le_i32 s[30:31], 1, v210
    s_nop 0
    v_cndmask_b32 v144, v206, v207, s[28:29]
    v_cndmask_b32 v160, v207, v206, s[28:29]
    v_cndmask_b32 v145, v206, v207, s[30:31]
    v_cndmask_b32 v161, v207, v206, s[30:31]
    v_cmp_le_i32 s[28:29], 2, v210
    v_cmp_le_i32 s[30:31], 3, v210
    s_nop 0
    v_cndmask_b32 v146, v206, v207, s[28:29]
    v_cndmask_b32 v162, v207, v206, s[28:29]
    v_cndmask_b32 v147, v206, v207, s[30:31]
    v_cndmask_b32 v163, v207, v206, s[30:31]
    v_cmp_le_i32 s[28:29], 8, v210
    v_cmp_le_i32 s[30:31], 9, v210
    s_nop 0
    v_cndmask_b32 v148, v206, v207, s[28:29]
    v_cndmask_b32 v164, v207, v206, s[28:29]
    v_cndmask_b32 v149, v206, v207, s[30:31]
    v_cndmask_b32 v165, v207, v206, s[30:31]
    v_cmp_le_i32 s[28:29], 10, v210
    v_cmp_le_i32 s[30:31], 11, v210
    s_nop 0
    v_cndmask_b32 v150, v206, v207, s[28:29]
    v_cndmask_b32 v166, v207, v206, s[28:29]
    v_cndmask_b32 v151, v206, v207, s[30:31]
    v_cndmask_b32 v167, v207, v206, s[30:31]
    v_cmp_le_i32 s[28:29], 16, v210
    v_cmp_le_i32 s[30:31], 17, v210
    s_nop 0
    v_cndmask_b32 v152, v206, v207, s[28:29]
    v_cndmask_b32 v168, v207, v206, s[28:29]
    v_cndmask_b32 v153, v206, v207, s[30:31]
    v_cndmask_b32 v169, v207, v206, s[30:31]
    v_cmp_le_i32 s[28:29], 18, v210
    v_cmp_le_i32 s[30:31], 19, v210
    s_nop 0
    v_cndmask_b32 v154, v206, v207, s[28:29]
    v_cndmask_b32 v170, v207, v206, s[28:29]
    v_cndmask_b32 v155, v206, v207, s[30:31]
    v_cndmask_b32 v171, v207, v206, s[30:31]
    v_cmp_le_i32 s[28:29], 24, v210
    v_cmp_le_i32 s[30:31], 25, v210
    s_nop 0
    v_cndmask_b32 v156, v206, v207, s[28:29]
    v_cndmask_b32 v172, v207, v206, s[28:29]
    v_cndmask_b32 v157, v206, v207, s[30:31]
    v_cndmask_b32 v173, v207, v206, s[30:31]
    v_cmp_le_i32 s[28:29], 26, v210
    v_cmp_le_i32 s[30:31], 27, v210
    s_nop 0
    v_cndmask_b32 v158, v206, v207, s[28:29]
    v_cndmask_b32 v174, v207, v206, s[28:29]
    v_cndmask_b32 v159, v206, v207, s[30:31]
    v_cndmask_b32 v175, v207, v206, s[30:31]
    v_mov_b32 v112, 0
    v_mov_b32 v128, 0
    v_mov_b32 v113, 0
    v_mov_b32 v129, 0
    v_mov_b32 v114, 0
    v_mov_b32 v130, 0
    v_mov_b32 v115, 0
    v_mov_b32 v131, 0
    v_mov_b32 v116, 0
    v_mov_b32 v132, 0
    v_mov_b32 v117, 0
    v_mov_b32 v133, 0
    v_mov_b32 v118, 0
    v_mov_b32 v134, 0
    v_mov_b32 v119, 0
    v_mov_b32 v135, 0
    v_mov_b32 v120, 0
    v_mov_b32 v136, 0
    v_mov_b32 v121, 0
    v_mov_b32 v137, 0
    v_mov_b32 v122, 0
    v_mov_b32 v138, 0
    v_mov_b32 v123, 0
    v_mov_b32 v139, 0
    v_mov_b32 v124, 0
    v_mov_b32 v140, 0
    v_mov_b32 v125, 0
    v_mov_b32 v141, 0
    v_mov_b32 v126, 0
    v_mov_b32 v142, 0
    v_mov_b32 v127, 0
    v_mov_b32 v143, 0
    s_lshl_b32 s25, s34, 13
    s_add_u32 s25, s25, 139264
    v_add_u32 v184, s25, v204
    s_add_u32 s25, s25, 4096
    v_add_u32 v206, s25, v205
    v_add_u32 v208, 155648, v209
    v_cndmask_b32 v206, v208, v206, s[32:33]
    v_xor_b32 v207, 32, v206
    v_xor_b32 v176, 0, v206
    v_xor_b32 v180, 0, v207
    v_xor_b32 v177, 64, v206
    v_xor_b32 v181, 64, v207
    v_xor_b32 v178, 128, v206
    v_xor_b32 v182, 128, v207
    v_xor_b32 v179, 192, v206
    v_xor_b32 v183, 192, v207
    s_cmp_eq_u32 s35, 1
    s_cbranch_scc1 VAR1_39
    ds_read_b128 v[48:51], v184 offset:0
    ds_read_b128 v[56:59], v176
    ds_read_b128 v[60:63], v180
    ds_read_b128 v[52:55], v184 offset:0
    s_waitcnt lgkmcnt(3)
    v_mfma_f32_32x32x16_bf16 v[72:87], v[48:51], v[40:43], v[144:159]
    s_nop 11
    v_exp_f32 v72, v72
    v_exp_f32 v73, v73
    v_exp_f32 v74, v74
    v_exp_f32 v75, v75
    s_waitcnt lgkmcnt(0)
    v_mfma_f32_32x32x16_bf16 v[88:103], v[52:55], v[44:47], 0
    ds_read_b128 v[48:51], v184 offset:512
    v_exp_f32 v76, v76
    v_exp_f32 v77, v77
    v_exp_f32 v78, v78
    v_exp_f32 v79, v79
    v_cvt_pk_bf16_f32 v104, v72, v73
    v_cvt_pk_bf16_f32 v105, v74, v75
    v_cvt_pk_bf16_f32 v106, v76, v77
    v_cvt_pk_bf16_f32 v107, v78, v79
    v_exp_f32 v80, v80
    v_exp_f32 v81, v81
    v_mfma_f32_32x32x16_bf16 v[112:127], v[56:59], v[104:107], v[112:127]
    ds_read_b128 v[64:67], v176
    ds_read_b128 v[68:71], v180
    v_exp_f32 v82, v82
    v_exp_f32 v83, v83
    v_exp_f32 v84, v84
    v_exp_f32 v85, v85
    v_exp_f32 v86, v86
    v_exp_f32 v87, v87
    v_cvt_pk_bf16_f32 v108, v80, v81
    v_cvt_pk_bf16_f32 v109, v82, v83
    v_cvt_pk_bf16_f32 v110, v84, v85
    v_cvt_pk_bf16_f32 v111, v86, v87
    s_nop 1
    v_mfma_f32_32x32x16_bf16 v[112:127], v[60:63], v[108:111], v[112:127]
    s_mov_b32 s72, 0
    s_cmp_eq_u32 s47, 3
    s_cbranch_scc1 ZH0_41
    v_min_u32 v210, 55, v1
    v_add_u32 v210, 8, v210
    v_lshlrev_b32 v210, 7, v210
    s_mov_b32 s27, 0x31000
    buffer_load_dwordx4 v[212:215], v210, s[8:11], s27 offen sc1
ZH0_41:
    v_exp_f32 v88, v88
    v_exp_f32 v89, v89
    v_exp_f32 v90, v90
    v_exp_f32 v91, v91
    s_waitcnt lgkmcnt(0)
    v_mfma_f32_32x32x16_bf16 v[72:87], v[48:51], v[44:47], 0
    ds_read_b128 v[52:55], v184 offset:1024
    v_exp_f32 v92, v92
    v_exp_f32 v93, v93
    v_exp_f32 v94, v94
    v_exp_f32 v95, v95
    v_cvt_pk_bf16_f32 v104, v88, v89
    v_cvt_pk_bf16_f32 v105, v90, v91
    v_cvt_pk_bf16_f32 v106, v92, v93
    v_cvt_pk_bf16_f32 v107, v94, v95
    v_exp_f32 v96, v96
    v_exp_f32 v97, v97
    v_mfma_f32_32x32x16_bf16 v[128:143], v[64:67], v[104:107], v[128:143]
    ds_read_b128 v[56:59], v177
    ds_read_b128 v[60:63], v181
    v_exp_f32 v98, v98
    v_exp_f32 v99, v99
    v_exp_f32 v100, v100
    v_exp_f32 v101, v101
    v_exp_f32 v102, v102
    v_exp_f32 v103, v103
    v_cvt_pk_bf16_f32 v108, v96, v97
    v_cvt_pk_bf16_f32 v109, v98, v99
    v_cvt_pk_bf16_f32 v110, v100, v101
    v_cvt_pk_bf16_f32 v111, v102, v103
    s_nop 1
    v_mfma_f32_32x32x16_bf16 v[128:143], v[68:71], v[108:111], v[128:143]
    v_exp_f32 v72, v72
    v_exp_f32 v73, v73
    v_exp_f32 v74, v74
    v_exp_f32 v75, v75
    s_waitcnt lgkmcnt(0)
    v_mfma_f32_32x32x16_bf16 v[88:103], v[52:55], v[44:47], 0
    ds_read_b128 v[48:51], v184 offset:1536
    v_exp_f32 v76, v76
    v_exp_f32 v77, v77
    v_exp_f32 v78, v78
    v_exp_f32 v79, v79
    v_cvt_pk_bf16_f32 v104, v72, v73
    v_cvt_pk_bf16_f32 v105, v74, v75
    v_cvt_pk_bf16_f32 v106, v76, v77
    v_cvt_pk_bf16_f32 v107, v78, v79
    v_exp_f32 v80, v80
    v_exp_f32 v81, v81
    v_mfma_f32_32x32x16_bf16 v[128:143], v[56:59], v[104:107], v[128:143]
    ds_read_b128 v[64:67], v178
    ds_read_b128 v[68:71], v182
    v_exp_f32 v82, v82
    v_exp_f32 v83, v83
    v_exp_f32 v84, v84
    v_exp_f32 v85, v85
    v_exp_f32 v86, v86
    v_exp_f32 v87, v87
    v_cvt_pk_bf16_f32 v108, v80, v81
    v_cvt_pk_bf16_f32 v109, v82, v83
    v_cvt_pk_bf16_f32 v110, v84, v85
    v_cvt_pk_bf16_f32 v111, v86, v87
    s_nop 1
    v_mfma_f32_32x32x16_bf16 v[128:143], v[60:63], v[108:111], v[128:143]
    v_exp_f32 v88, v88
    v_exp_f32 v89, v89
    v_exp_f32 v90, v90
    v_exp_f32 v91, v91
    s_waitcnt lgkmcnt(0)
    v_mfma_f32_32x32x16_bf16 v[72:87], v[48:51], v[44:47], v[144:159]
    v_exp_f32 v92, v92
    v_exp_f32 v93, v93
    v_exp_f32 v94, v94
    v_exp_f32 v95, v95
    v_cvt_pk_bf16_f32 v104, v88, v89
    v_cvt_pk_bf16_f32 v105, v90, v91
    v_cvt_pk_bf16_f32 v106, v92, v93
    v_cvt_pk_bf16_f32 v107, v94, v95
    v_exp_f32 v96, v96
    v_exp_f32 v97, v97
    v_mfma_f32_32x32x16_bf16 v[128:143], v[64:67], v[104:107], v[128:143]
    ds_read_b128 v[56:59], v179
    ds_read_b128 v[60:63], v183
    v_exp_f32 v98, v98
    v_exp_f32 v99, v99
    v_exp_f32 v100, v100
    v_exp_f32 v101, v101
    v_exp_f32 v102, v102
    v_exp_f32 v103, v103
    v_cvt_pk_bf16_f32 v108, v96, v97
    v_cvt_pk_bf16_f32 v109, v98, v99
    v_cvt_pk_bf16_f32 v110, v100, v101
    v_cvt_pk_bf16_f32 v111, v102, v103
    s_nop 1
    v_mfma_f32_32x32x16_bf16 v[128:143], v[68:71], v[108:111], v[128:143]
    s_waitcnt vmcnt(0)
    s_lshl_b32 s25, s2, 7
    s_lshl_b32 s26, s22, 2
    s_add_u32 s25, s25, s26
    s_lshl_b32 s26, s24, 15
    s_add_u32 s25, s25, s26
    s_add_u32 s25, s25, 0x1000
    v_mov_b32 v220, s23
    s_mov_b64 exec, 1
    buffer_store_dword v220, off, s[8:11], s25 sc1
    s_mov_b64 exec, -1
    s_cmp_eq_u32 s47, 3
    s_cbranch_scc1 ZH3_42
    v_xor_b32 v212, s23, v212
    v_xor_b32 v213, s23, v213
    v_xor_b32 v214, s23, v214
    v_xor_b32 v215, s23, v215
    v_or_b32 v212, v212, v213
    v_or3_b32 v212, v212, v214, v215
    v_cmp_ne_u32 vcc, 0, v212
    s_nop 1
    s_cmp_eq_u64 vcc, 0
    s_cbranch_scc0 ZH3_42
    v_lshlrev_b32 v186, 5, v1
    s_mov_b32 s26, 0xe2000
    buffer_load_dwordx4 v[188:191], v186, s[8:11], s26 offen sc1
    buffer_load_dwordx4 v[192:195], v186, s[8:11], s26 offen offset:16 sc1
    s_mov_b32 s26, 0xe2800
    buffer_load_dwordx4 v[196:199], v186, s[8:11], s26 offen sc1
    buffer_load_dwordx4 v[200:203], v186, s[8:11], s26 offen offset:16 sc1
    s_lshr_b32 s25, s41, 8
    s_and_b32 s26, s41, 255
    s_lshl_b32 s27, s25, 18
    s_lshl_b32 s28, s26, 7
    s_add_u32 s27, s27, s28
    s_add_u32 s27, s27, 0xd00000
    s_and_b32 s26, s26, 15
    s_lshr_b32 s26, s26, 1
    v_and_b32 v186, 7, v1
    v_xor_b32 v186, s26, v186
    v_lshlrev_b32 v186, 4, v186
    v_lshrrev_b32 v187, 3, v1
    v_lshl_add_u32 v186, v187, 15, v186
    buffer_load_dwordx4 v[212:215], v186, s[8:11], s27 offen sc1
    s_lshl_b32 s26, s41, 4
    s_add_u32 s26, s26, 0x50000
    buffer_load_dwordx2 v[206:207], off, s[8:11], s26 sc1
    s_mov_b32 s72, 1
ZH3_42:
    v_exp_f32 v72, v72
    v_exp_f32 v73, v73
    v_exp_f32 v74, v74
    v_exp_f32 v75, v75
    s_waitcnt lgkmcnt(0)
    v_exp_f32 v76, v76
    v_exp_f32 v77, v77
    v_exp_f32 v78, v78
    v_exp_f32 v79, v79
    v_cvt_pk_bf16_f32 v104, v72, v73
    v_cvt_pk_bf16_f32 v105, v74, v75
    v_cvt_pk_bf16_f32 v106, v76, v77
    v_cvt_pk_bf16_f32 v107, v78, v79
    v_exp_f32 v80, v80
    v_exp_f32 v81, v81
    v_mfma_f32_32x32x16_bf16 v[128:143], v[56:59], v[104:107], v[128:143]
    v_exp_f32 v82, v82
    v_exp_f32 v83, v83
    v_exp_f32 v84, v84
    v_exp_f32 v85, v85
    v_exp_f32 v86, v86
    v_exp_f32 v87, v87
    v_cvt_pk_bf16_f32 v108, v80, v81
    v_cvt_pk_bf16_f32 v109, v82, v83
    v_cvt_pk_bf16_f32 v110, v84, v85
    v_cvt_pk_bf16_f32 v111, v86, v87
    s_nop 1
    v_mfma_f32_32x32x16_bf16 v[128:143], v[60:63], v[108:111], v[128:143]
    s_branch VARJ_40
VAR1_39:
    ds_read_b128 v[48:51], v184 offset:0
    ds_read_b128 v[56:59], v176
    ds_read_b128 v[60:63], v180
    ds_read_b128 v[52:55], v184 offset:512
    s_waitcnt lgkmcnt(3)
    v_mfma_f32_32x32x16_bf16 v[72:87], v[48:51], v[40:43], 0
    s_nop 11
    v_exp_f32 v72, v72
    v_exp_f32 v73, v73
    v_exp_f32 v74, v74
    v_exp_f32 v75, v75
    s_waitcnt lgkmcnt(0)
    v_mfma_f32_32x32x16_bf16 v[88:103], v[52:55], v[40:43], v[144:159]
    ds_read_b128 v[48:51], v184 offset:0
    v_exp_f32 v76, v76
    v_exp_f32 v77, v77
    v_exp_f32 v78, v78
    v_exp_f32 v79, v79
    v_cvt_pk_bf16_f32 v104, v72, v73
    v_cvt_pk_bf16_f32 v105, v74, v75
    v_cvt_pk_bf16_f32 v106, v76, v77
    v_cvt_pk_bf16_f32 v107, v78, v79
    v_exp_f32 v80, v80
    v_exp_f32 v81, v81
    v_mfma_f32_32x32x16_bf16 v[112:127], v[56:59], v[104:107], v[112:127]
    ds_read_b128 v[64:67], v177
    ds_read_b128 v[68:71], v181
    v_exp_f32 v82, v82
    v_exp_f32 v83, v83
    v_exp_f32 v84, v84
    v_exp_f32 v85, v85
    v_exp_f32 v86, v86
    v_exp_f32 v87, v87
    v_cvt_pk_bf16_f32 v108, v80, v81
    v_cvt_pk_bf16_f32 v109, v82, v83
    v_cvt_pk_bf16_f32 v110, v84, v85
    v_cvt_pk_bf16_f32 v111, v86, v87
    s_nop 1
    v_mfma_f32_32x32x16_bf16 v[112:127], v[60:63], v[108:111], v[112:127]
    s_mov_b32 s72, 0
    s_cmp_eq_u32 s47, 3
    s_cbranch_scc1 ZH0_43
    v_min_u32 v210, 55, v1
    v_add_u32 v210, 8, v210
    v_lshlrev_b32 v210, 7, v210
    s_mov_b32 s27, 0x31000
    buffer_load_dwordx4 v[212:215], v210, s[8:11], s27 offen sc1
ZH0_43:
    v_exp_f32 v88, v88
    v_exp_f32 v89, v89
    v_exp_f32 v90, v90
    v_exp_f32 v91, v91
    s_waitcnt lgkmcnt(0)
    v_mfma_f32_32x32x16_bf16 v[72:87], v[48:51], v[44:47], 0
    ds_read_b128 v[52:55], v184 offset:512
    v_exp_f32 v92, v92
    v_exp_f32 v93, v93
    v_exp_f32 v94, v94
    v_exp_f32 v95, v95
    v_cvt_pk_bf16_f32 v104, v88, v89
    v_cvt_pk_bf16_f32 v105, v90, v91
    v_cvt_pk_bf16_f32 v106, v92, v93
    v_cvt_pk_bf16_f32 v107, v94, v95
    v_exp_f32 v96, v96
    v_exp_f32 v97, v97
    v_mfma_f32_32x32x16_bf16 v[112:127], v[64:67], v[104:107], v[112:127]
    ds_read_b128 v[56:59], v176
    ds_read_b128 v[60:63], v180
    v_exp_f32 v98, v98
    v_exp_f32 v99, v99
    v_exp_f32 v100, v100
    v_exp_f32 v101, v101
    v_exp_f32 v102, v102
    v_exp_f32 v103, v103
    v_cvt_pk_bf16_f32 v108, v96, v97
    v_cvt_pk_bf16_f32 v109, v98, v99
    v_cvt_pk_bf16_f32 v110, v100, v101
    v_cvt_pk_bf16_f32 v111, v102, v103
    s_nop 1
    v_mfma_f32_32x32x16_bf16 v[112:127], v[68:71], v[108:111], v[112:127]
    v_exp_f32 v72, v72
    v_exp_f32 v73, v73
    v_exp_f32 v74, v74
    v_exp_f32 v75, v75
    s_waitcnt lgkmcnt(0)
    v_mfma_f32_32x32x16_bf16 v[88:103], v[52:55], v[44:47], 0
    ds_read_b128 v[48:51], v184 offset:1024
    v_exp_f32 v76, v76
    v_exp_f32 v77, v77
    v_exp_f32 v78, v78
    v_exp_f32 v79, v79
    v_cvt_pk_bf16_f32 v104, v72, v73
    v_cvt_pk_bf16_f32 v105, v74, v75
    v_cvt_pk_bf16_f32 v106, v76, v77
    v_cvt_pk_bf16_f32 v107, v78, v79
    v_exp_f32 v80, v80
    v_exp_f32 v81, v81
    v_mfma_f32_32x32x16_bf16 v[128:143], v[56:59], v[104:107], v[128:143]
    ds_read_b128 v[64:67], v177
    ds_read_b128 v[68:71], v181
    v_exp_f32 v82, v82
    v_exp_f32 v83, v83
    v_exp_f32 v84, v84
    v_exp_f32 v85, v85
    v_exp_f32 v86, v86
    v_exp_f32 v87, v87
    v_cvt_pk_bf16_f32 v108, v80, v81
    v_cvt_pk_bf16_f32 v109, v82, v83
    v_cvt_pk_bf16_f32 v110, v84, v85
    v_cvt_pk_bf16_f32 v111, v86, v87
    s_nop 1
    v_mfma_f32_32x32x16_bf16 v[128:143], v[60:63], v[108:111], v[128:143]
    v_exp_f32 v88, v88
    v_exp_f32 v89, v89
    v_exp_f32 v90, v90
    v_exp_f32 v91, v91
    s_waitcnt lgkmcnt(0)
    v_mfma_f32_32x32x16_bf16 v[72:87], v[48:51], v[44:47], v[144:159]
    v_exp_f32 v92, v92
    v_exp_f32 v93, v93
    v_exp_f32 v94, v94
    v_exp_f32 v95, v95
    v_cvt_pk_bf16_f32 v104, v88, v89
    v_cvt_pk_bf16_f32 v105, v90, v91
    v_cvt_pk_bf16_f32 v106, v92, v93
    v_cvt_pk_bf16_f32 v107, v94, v95
    v_exp_f32 v96, v96
    v_exp_f32 v97, v97
    v_mfma_f32_32x32x16_bf16 v[128:143], v[64:67], v[104:107], v[128:143]
    ds_read_b128 v[56:59], v178
    ds_read_b128 v[60:63], v182
    v_exp_f32 v98, v98
    v_exp_f32 v99, v99
    v_exp_f32 v100, v100
    v_exp_f32 v101, v101
    v_exp_f32 v102, v102
    v_exp_f32 v103, v103
    v_cvt_pk_bf16_f32 v108, v96, v97
    v_cvt_pk_bf16_f32 v109, v98, v99
    v_cvt_pk_bf16_f32 v110, v100, v101
    v_cvt_pk_bf16_f32 v111, v102, v103
    s_nop 1
    v_mfma_f32_32x32x16_bf16 v[128:143], v[68:71], v[108:111], v[128:143]
    s_waitcnt vmcnt(0)
    s_lshl_b32 s25, s2, 7
    s_lshl_b32 s26, s22, 2
    s_add_u32 s25, s25, s26
    s_lshl_b32 s26, s24, 15
    s_add_u32 s25, s25, s26
    s_add_u32 s25, s25, 0x1000
    v_mov_b32 v220, s23
    s_mov_b64 exec, 1
    buffer_store_dword v220, off, s[8:11], s25 sc1
    s_mov_b64 exec, -1
    s_cmp_eq_u32 s47, 3
    s_cbranch_scc1 ZH3_44
    v_xor_b32 v212, s23, v212
    v_xor_b32 v213, s23, v213
    v_xor_b32 v214, s23, v214
    v_xor_b32 v215, s23, v215
    v_or_b32 v212, v212, v213
    v_or3_b32 v212, v212, v214, v215
    v_cmp_ne_u32 vcc, 0, v212
    s_nop 1
    s_cmp_eq_u64 vcc, 0
    s_cbranch_scc0 ZH3_44
    v_lshlrev_b32 v186, 5, v1
    s_mov_b32 s26, 0xe2000
    buffer_load_dwordx4 v[188:191], v186, s[8:11], s26 offen sc1
    buffer_load_dwordx4 v[192:195], v186, s[8:11], s26 offen offset:16 sc1
    s_mov_b32 s26, 0xe2800
    buffer_load_dwordx4 v[196:199], v186, s[8:11], s26 offen sc1
    buffer_load_dwordx4 v[200:203], v186, s[8:11], s26 offen offset:16 sc1
    s_lshr_b32 s25, s41, 8
    s_and_b32 s26, s41, 255
    s_lshl_b32 s27, s25, 18
    s_lshl_b32 s28, s26, 7
    s_add_u32 s27, s27, s28
    s_add_u32 s27, s27, 0xd00000
    s_and_b32 s26, s26, 15
    s_lshr_b32 s26, s26, 1
    v_and_b32 v186, 7, v1
    v_xor_b32 v186, s26, v186
    v_lshlrev_b32 v186, 4, v186
    v_lshrrev_b32 v187, 3, v1
    v_lshl_add_u32 v186, v187, 15, v186
    buffer_load_dwordx4 v[212:215], v186, s[8:11], s27 offen sc1
    s_lshl_b32 s26, s41, 4
    s_add_u32 s26, s26, 0x50000
    buffer_load_dwordx2 v[206:207], off, s[8:11], s26 sc1
    s_mov_b32 s72, 1
ZH3_44:
    v_exp_f32 v72, v72
    v_exp_f32 v73, v73
    v_exp_f32 v74, v74
    v_exp_f32 v75, v75
    s_waitcnt lgkmcnt(0)
    v_exp_f32 v76, v76
    v_exp_f32 v77, v77
    v_exp_f32 v78, v78
    v_exp_f32 v79, v79
    v_cvt_pk_bf16_f32 v104, v72, v73
    v_cvt_pk_bf16_f32 v105, v74, v75
    v_cvt_pk_bf16_f32 v106, v76, v77
    v_cvt_pk_bf16_f32 v107, v78, v79
    v_exp_f32 v80, v80
    v_exp_f32 v81, v81
    v_mfma_f32_32x32x16_bf16 v[128:143], v[56:59], v[104:107], v[128:143]
    v_exp_f32 v82, v82
    v_exp_f32 v83, v83
    v_exp_f32 v84, v84
    v_exp_f32 v85, v85
    v_exp_f32 v86, v86
    v_exp_f32 v87, v87
    v_cvt_pk_bf16_f32 v108, v80, v81
    v_cvt_pk_bf16_f32 v109, v82, v83
    v_cvt_pk_bf16_f32 v110, v84, v85
    v_cvt_pk_bf16_f32 v111, v86, v87
    s_nop 1
    v_mfma_f32_32x32x16_bf16 v[128:143], v[60:63], v[108:111], v[128:143]
VARJ_40:
    s_cmp_lg_u32 s24, 0
    s_cbranch_scc1 NOGF_45
    s_sub_u32 s3, s2, 8
    s_cmp_ge_u32 s3, 56
    s_cbranch_scc1 NOGF_45
    s_waitcnt vmcnt(0)
    s_barrier
    v_lshlrev_b32 v210, 6, v6
    v_add_u32 v210, v210, v9
    v_and_b32 v211, 1, v25
    v_xor_b32 v211, s34, v211
    v_lshl_add_u32 v210, v211, 5, v210
    s_lshl_b32 s25, s35, 15
    v_add_u32 v210, s25, v210
    ds_read_b64_tr_b16 a[192:193], v210 offset:0
    ds_read_b64_tr_b16 a[194:195], v210 offset:256
    ds_read_b64_tr_b16 a[196:197], v210 offset:2048
    ds_read_b64_tr_b16 a[198:199], v210 offset:2304
    ds_read_b64_tr_b16 a[200:201], v210 offset:4096
    ds_read_b64_tr_b16 a[202:203], v210 offset:4352
    ds_read_b64_tr_b16 a[204:205], v210 offset:6144
    ds_read_b64_tr_b16 a[206:207], v210 offset:6400
    ds_read_b64_tr_b16 a[208:209], v210 offset:8192
    ds_read_b64_tr_b16 a[210:211], v210 offset:8448
    ds_read_b64_tr_b16 a[212:213], v210 offset:10240
    ds_read_b64_tr_b16 a[214:215], v210 offset:10496
    ds_read_b64_tr_b16 a[216:217], v210 offset:12288
    ds_read_b64_tr_b16 a[218:219], v210 offset:12544
    ds_read_b64_tr_b16 a[220:221], v210 offset:14336
    ds_read_b64_tr_b16 a[222:223], v210 offset:14592
    ds_read_b64_tr_b16 a[224:225], v210 offset:16384
    ds_read_b64_tr_b16 a[226:227], v210 offset:16640
    ds_read_b64_tr_b16 a[228:229], v210 offset:18432
    ds_read_b64_tr_b16 a[230:231], v210 offset:18688
    ds_read_b64_tr_b16 a[232:233], v210 offset:20480
    ds_read_b64_tr_b16 a[234:235], v210 offset:20736
    ds_read_b64_tr_b16 a[236:237], v210 offset:22528
    ds_read_b64_tr_b16 a[238:239], v210 offset:22784
    ds_read_b64_tr_b16 a[240:241], v210 offset:24576
    ds_read_b64_tr_b16 a[242:243], v210 offset:24832
    ds_read_b64_tr_b16 a[244:245], v210 offset:26624
    ds_read_b64_tr_b16 a[246:247], v210 offset:26880
    ds_read_b64_tr_b16 a[248:249], v210 offset:28672
    ds_read_b64_tr_b16 a[250:251], v210 offset:28928
    ds_read_b64_tr_b16 a[252:253], v210 offset:30720
    ds_read_b64_tr_b16 a[254:255], v210 offset:30976
    s_waitcnt lgkmcnt(0)
    s_barrier
NOGF_45:
    s_cmp_eq_u32 s47, 3
    s_cbranch_scc1 ZN_46
    s_cmp_eq_u32 s72, 1
    s_cbranch_scc1 ZNK_47
    s_mov_b32 s27, 0x31000
    v_min_u32 v206, 55, v1
    v_add_u32 v206, 8, v206
    v_lshlrev_b32 v206, 7, v206
    s_mov_b32 s76, 0
POLL_48:
    buffer_load_dwordx4 v[212:215], v206, s[8:11], s27 offen sc1
    s_waitcnt vmcnt(0)
    v_xor_b32 v219, s23, v212
    v_xor_b32 v218, s23, v213
    v_or_b32 v219, v219, v218
    v_xor_b32 v218, s23, v214
    v_or_b32 v219, v219, v218
    v_xor_b32 v218, s23, v215
    v_or_b32 v219, v219, v218
    v_cmp_ne_u32 vcc, 0, v219
    s_nop 1
    s_cmp_eq_u64 vcc, 0
    s_cbranch_scc1 POLD_49
    s_sleep 4
    s_add_u32 s76, s76, 1
    s_cmp_lt_u32 s76, 0x40000
    s_cbranch_scc1 POLL_48
    s_mov_b32 s12, s66
    s_and_b32 s13, s67, 0xffff
    s_mov_b32 s14, 0x100
    s_mov_b32 s15, 0x20000
    v_mov_b32 v221, 10
    buffer_store_dword v221, off, s[12:15], 0
    s_waitcnt vmcnt(0)
POLD_49:
    v_lshlrev_b32 v186, 5, v1
    s_mov_b32 s26, 0xe2000
    buffer_load_dwordx4 v[188:191], v186, s[8:11], s26 offen sc1
    buffer_load_dwordx4 v[192:195], v186, s[8:11], s26 offen offset:16 sc1
    s_mov_b32 s26, 0xe2800
    buffer_load_dwordx4 v[196:199], v186, s[8:11], s26 offen sc1
    buffer_load_dwordx4 v[200:203], v186, s[8:11], s26 offen offset:16 sc1
    s_lshr_b32 s25, s41, 8
    s_and_b32 s26, s41, 255
    s_lshl_b32 s27, s25, 18
    s_lshl_b32 s28, s26, 7
    s_add_u32 s27, s27, s28
    s_add_u32 s27, s27, 0xd00000
    s_and_b32 s26, s26, 15
    s_lshr_b32 s26, s26, 1
    v_and_b32 v186, 7, v1
    v_xor_b32 v186, s26, v186
    v_lshlrev_b32 v186, 4, v186
    v_lshrrev_b32 v187, 3, v1
    v_lshl_add_u32 v186, v187, 15, v186
    buffer_load_dwordx4 v[212:215], v186, s[8:11], s27 offen sc1
    s_lshl_b32 s26, s41, 4
    s_add_u32 s26, s26, 0x50000
    buffer_load_dwordx2 v[206:207], off, s[8:11], s26 sc1
ZNK_47:
    s_waitcnt vmcnt(0)
    v_mul_f32 v206, v206, v207
    v_add_f32 v207, 1.0, v207
    v_add_f32 v188, v188, v196
    v_add_f32 v189, v189, v197
    v_add_f32 v190, v190, v198
    v_add_f32 v191, v191, v199
    v_add_f32 v192, v192, v200
    v_add_f32 v193, v193, v201
    v_add_f32 v194, v194, v202
    v_add_f32 v195, v195, v203
    v_lshlrev_b32 v196, 16, v212
    v_and_b32 v197, 0xffff0000, v212
    v_lshlrev_b32 v198, 16, v213
    v_and_b32 v199, 0xffff0000, v213
    v_lshlrev_b32 v200, 16, v214
    v_and_b32 v201, 0xffff0000, v214
    v_lshlrev_b32 v202, 16, v215
    v_and_b32 v203, 0xffff0000, v215
    v_fma_f32 v196, v196, v207, -v206
    v_fma_f32 v197, v197, v207, -v206
    v_fma_f32 v198, v198, v207, -v206
    v_fma_f32 v199, v199, v207, -v206
    v_fma_f32 v200, v200, v207, -v206
    v_fma_f32 v201, v201, v207, -v206
    v_fma_f32 v202, v202, v207, -v206
    v_fma_f32 v203, v203, v207, -v206
    v_add_f32 v188, v188, v196
    v_add_f32 v189, v189, v197
    v_add_f32 v190, v190, v198
    v_add_f32 v191, v191, v199
    v_add_f32 v192, v192, v200
    v_add_f32 v193, v193, v201
    v_add_f32 v194, v194, v202
    v_add_f32 v195, v195, v203
    v_cvt_pk_bf16_f32 v200, v188, v189
    v_cvt_pk_bf16_f32 v201, v190, v191
    v_cvt_pk_bf16_f32 v202, v192, v193
    v_cvt_pk_bf16_f32 v203, v194, v195
    v_lshlrev_b32 v188, 16, v200
    v_and_b32 v189, 0xffff0000, v200
    v_lshlrev_b32 v190, 16, v201
    v_and_b32 v191, 0xffff0000, v201
    v_lshlrev_b32 v192, 16, v202
    v_and_b32 v193, 0xffff0000, v202
    v_lshlrev_b32 v194, 16, v203
    v_and_b32 v195, 0xffff0000, v203
    v_add_f32 v196, v188, v189
    v_mul_f32 v197, v188, v188
    v_fmac_f32 v197, v189, v189
    v_add_f32 v196, v196, v190
    v_fmac_f32 v197, v190, v190
    v_add_f32 v196, v196, v191
    v_fmac_f32 v197, v191, v191
    v_add_f32 v196, v196, v192
    v_fmac_f32 v197, v192, v192
    v_add_f32 v196, v196, v193
    v_fmac_f32 v197, v193, v193
    v_add_f32 v196, v196, v194
    v_fmac_f32 v197, v194, v194
    v_add_f32 v196, v196, v195
    v_fmac_f32 v197, v195, v195
    s_nop 0
    v_add_f32_dpp v196, v196, v196 quad_perm:[1,0,3,2] row_mask:0xf bank_mask:0xf
    v_add_f32_dpp v197, v197, v197 quad_perm:[1,0,3,2] row_mask:0xf bank_mask:0xf
    s_nop 0
    v_add_f32_dpp v196, v196, v196 quad_perm:[2,3,0,1] row_mask:0xf bank_mask:0xf
    v_add_f32_dpp v197, v197, v197 quad_perm:[2,3,0,1] row_mask:0xf bank_mask:0xf
    s_nop 0
    v_add_f32_dpp v196, v196, v196 row_half_mirror row_mask:0xf bank_mask:0xf
    v_add_f32_dpp v197, v197, v197 row_half_mirror row_mask:0xf bank_mask:0xf
    s_nop 0
    v_add_f32_dpp v196, v196, v196 row_mirror row_mask:0xf bank_mask:0xf
    v_add_f32_dpp v197, v197, v197 row_mirror row_mask:0xf bank_mask:0xf
    v_mov_b32 v198, v196
    v_mov_b32 v199, v197
    s_nop 0
    v_permlane16_swap_b32 v196, v198
    v_permlane16_swap_b32 v197, v199
    v_add_f32 v196, v196, v198
    v_add_f32 v197, v197, v199
    v_mov_b32 v198, v196
    v_mov_b32 v199, v197
    s_nop 0
    v_permlane32_swap_b32 v196, v198
    v_permlane32_swap_b32 v197, v199
    v_add_f32 v196, v196, v198
    v_add_f32 v197, v197, v199
    s_mov_b32 s25, 0x3b000000
    s_mov_b32 s26, 0x3727c5ac
    v_mul_f32 v196, s25, v196
    v_mul_f32 v197, s25, v197
    v_fma_f32 v197, -v196, v196, v197
    v_add_f32 v197, s26, v197
    v_rsq_f32 v197, v197
    v_sub_f32 v188, v188, v196
    v_mul_f32 v188, v188, v197
    v_sub_f32 v189, v189, v196
    v_mul_f32 v189, v189, v197
    v_sub_f32 v190, v190, v196
    v_mul_f32 v190, v190, v197
    v_sub_f32 v191, v191, v196
    v_mul_f32 v191, v191, v197
    v_sub_f32 v192, v192, v196
    v_mul_f32 v192, v192, v197
    v_sub_f32 v193, v193, v196
    v_mul_f32 v193, v193, v197
    v_sub_f32 v194, v194, v196
    v_mul_f32 v194, v194, v197
    v_sub_f32 v195, v195, v196
    v_mul_f32 v195, v195, v197
    v_cvt_pk_bf16_f32 v200, v188, v189
    v_cvt_pk_bf16_f32 v201, v190, v191
    v_cvt_pk_bf16_f32 v202, v192, v193
    v_cvt_pk_bf16_f32 v203, v194, v195
    s_lshl_b32 s25, s22, 10
    s_add_u32 s25, s25, 158720
    v_add_u32 v186, s25, v7
    ds_write_b128 v186, v[200:203]
    v_lshlrev_b32 v186, 4, v25
    v_add_u32 v186, s25, v186
    s_waitcnt lgkmcnt(0)
    ds_read_b128 v[72:75], v186 offset:0
    ds_read_b128 v[76:79], v186 offset:64
    ds_read_b128 v[80:83], v186 offset:128
    ds_read_b128 v[84:87], v186 offset:192
    ds_read_b128 v[88:91], v186 offset:256
    ds_read_b128 v[92:95], v186 offset:320
    ds_read_b128 v[96:99], v186 offset:384
    ds_read_b128 v[100:103], v186 offset:448
    s_waitcnt lgkmcnt(7)
    v_mfma_f32_16x16x32_bf16 v[104:107], a[0:3], v[72:75], 0
    v_mfma_f32_16x16x32_bf16 v[108:111], a[4:7], v[72:75], 0
    v_mfma_f32_16x16x32_bf16 v[48:51], v[72:75], a[8:11], 0
    s_waitcnt lgkmcnt(6)
    v_mfma_f32_16x16x32_bf16 v[104:107], a[12:15], v[76:79], v[104:107]
    v_mfma_f32_16x16x32_bf16 v[108:111], a[16:19], v[76:79], v[108:111]
    v_mfma_f32_16x16x32_bf16 v[48:51], v[76:79], a[20:23], v[48:51]
    s_waitcnt lgkmcnt(5)
    v_mfma_f32_16x16x32_bf16 v[104:107], a[24:27], v[80:83], v[104:107]
    v_mfma_f32_16x16x32_bf16 v[108:111], a[28:31], v[80:83], v[108:111]
    v_mfma_f32_16x16x32_bf16 v[48:51], v[80:83], a[32:35], v[48:51]
    s_waitcnt lgkmcnt(4)
    v_mfma_f32_16x16x32_bf16 v[104:107], a[36:39], v[84:87], v[104:107]
    v_mfma_f32_16x16x32_bf16 v[108:111], a[40:43], v[84:87], v[108:111]
    v_mfma_f32_16x16x32_bf16 v[48:51], v[84:87], a[44:47], v[48:51]
    s_waitcnt lgkmcnt(3)
    v_mfma_f32_16x16x32_bf16 v[104:107], a[48:51], v[88:91], v[104:107]
    v_mfma_f32_16x16x32_bf16 v[108:111], a[52:55], v[88:91], v[108:111]
    v_mfma_f32_16x16x32_bf16 v[48:51], v[88:91], a[56:59], v[48:51]
    s_waitcnt lgkmcnt(2)
    v_mfma_f32_16x16x32_bf16 v[104:107], a[60:63], v[92:95], v[104:107]
    v_mfma_f32_16x16x32_bf16 v[108:111], a[64:67], v[92:95], v[108:111]
    v_mfma_f32_16x16x32_bf16 v[48:51], v[92:95], a[68:71], v[48:51]
    s_waitcnt lgkmcnt(1)
    v_mfma_f32_16x16x32_bf16 v[104:107], a[72:75], v[96:99], v[104:107]
    v_mfma_f32_16x16x32_bf16 v[108:111], a[76:79], v[96:99], v[108:111]
    v_mfma_f32_16x16x32_bf16 v[48:51], v[96:99], a[80:83], v[48:51]
    s_waitcnt lgkmcnt(0)
    v_mfma_f32_16x16x32_bf16 v[104:107], a[84:87], v[100:103], v[104:107]
    v_mfma_f32_16x16x32_bf16 v[108:111], a[88:91], v[100:103], v[108:111]
    v_mfma_f32_16x16x32_bf16 v[48:51], v[100:103], a[92:95], v[48:51]
    ds_read_b128 v[72:75], v186 offset:512
    ds_read_b128 v[76:79], v186 offset:576
    ds_read_b128 v[80:83], v186 offset:640
    ds_read_b128 v[84:87], v186 offset:704
    ds_read_b128 v[88:91], v186 offset:768
    ds_read_b128 v[92:95], v186 offset:832
    ds_read_b128 v[96:99], v186 offset:896
    ds_read_b128 v[100:103], v186 offset:960
    s_waitcnt lgkmcnt(7)
    v_mfma_f32_16x16x32_bf16 v[104:107], a[96:99], v[72:75], v[104:107]
    v_mfma_f32_16x16x32_bf16 v[108:111], a[100:103], v[72:75], v[108:111]
    v_mfma_f32_16x16x32_bf16 v[48:51], v[72:75], a[104:107], v[48:51]
    s_waitcnt lgkmcnt(6)
    v_mfma_f32_16x16x32_bf16 v[104:107], a[108:111], v[76:79], v[104:107]
    v_mfma_f32_16x16x32_bf16 v[108:111], a[112:115], v[76:79], v[108:111]
    v_mfma_f32_16x16x32_bf16 v[48:51], v[76:79], a[116:119], v[48:51]
    s_waitcnt lgkmcnt(5)
    v_mfma_f32_16x16x32_bf16 v[104:107], a[120:123], v[80:83], v[104:107]
    v_mfma_f32_16x16x32_bf16 v[108:111], a[124:127], v[80:83], v[108:111]
    v_mfma_f32_16x16x32_bf16 v[48:51], v[80:83], a[128:131], v[48:51]
    s_waitcnt lgkmcnt(4)
    v_mfma_f32_16x16x32_bf16 v[104:107], a[132:135], v[84:87], v[104:107]
    v_mfma_f32_16x16x32_bf16 v[108:111], a[136:139], v[84:87], v[108:111]
    v_mfma_f32_16x16x32_bf16 v[48:51], v[84:87], a[140:143], v[48:51]
    s_waitcnt lgkmcnt(3)
    v_mfma_f32_16x16x32_bf16 v[104:107], a[144:147], v[88:91], v[104:107]
    v_mfma_f32_16x16x32_bf16 v[108:111], a[148:151], v[88:91], v[108:111]
    v_mfma_f32_16x16x32_bf16 v[48:51], v[88:91], a[152:155], v[48:51]
    s_waitcnt lgkmcnt(2)
    v_mfma_f32_16x16x32_bf16 v[104:107], a[156:159], v[92:95], v[104:107]
    v_mfma_f32_16x16x32_bf16 v[108:111], a[160:163], v[92:95], v[108:111]
    v_mfma_f32_16x16x32_bf16 v[48:51], v[92:95], a[164:167], v[48:51]
    s_waitcnt lgkmcnt(1)
    v_mfma_f32_16x16x32_bf16 v[104:107], a[168:171], v[96:99], v[104:107]
    v_mfma_f32_16x16x32_bf16 v[108:111], a[172:175], v[96:99], v[108:111]
    v_mfma_f32_16x16x32_bf16 v[48:51], v[96:99], a[176:179], v[48:51]
    s_waitcnt lgkmcnt(0)
    v_mfma_f32_16x16x32_bf16 v[104:107], a[180:183], v[100:103], v[104:107]
    v_mfma_f32_16x16x32_bf16 v[108:111], a[184:187], v[100:103], v[108:111]
    v_mfma_f32_16x16x32_bf16 v[48:51], v[100:103], a[188:191], v[48:51]
    s_mov_b32 s25, 0x3eb8aa3b
    s_nop 4
    v_mul_f32 v104, s25, v104
    v_mul_f32 v105, s25, v105
    v_mul_f32 v106, s25, v106
    v_mul_f32 v107, s25, v107
    v_cvt_pk_bf16_f32 v52, v104, v105
    v_cvt_pk_bf16_f32 v53, v106, v107
    v_cvt_pk_bf16_f32 v54, v108, v109
    v_cvt_pk_bf16_f32 v55, v110, v111
    v_cvt_pk_bf16_f32 v56, v48, v48
    v_lshlrev_b32 v57, 16, v56
    s_cmp_lg_u32 s47, 0
    s_cbranch_scc1 ZN_46
    s_barrier
    s_cmp_lg_u32 s35, 0
    s_cbranch_scc1 ZNP_51
    s_and_b32 s29, s41, 127
    s_lshr_b32 s30, s29, 4
    s_lshl_b32 s30, s30, 1
    s_lshr_b32 s28, s29, 2
    s_and_b32 s28, s28, 1
    s_add_u32 s30, s30, s28
    s_lshr_b32 s31, s29, 3
    s_and_b32 s31, s31, 1
    s_lshl_b32 s31, s31, 2
    s_and_b32 s28, s29, 3
    s_add_u32 s31, s31, s28
    s_lshl_b32 s31, s31, 1
    s_mov_b32 s27, 139264
    s_cmp_eq_u32 s47, 1
    s_cselect_b32 s27, 16384, s27
    s_cmp_eq_u32 s47, 2
    s_cselect_b32 s27, 0, s27
    s_lshl_b32 s26, s34, 13
    s_add_u32 s27, s27, s26
    v_lshrrev_b32 v186, 1, v25
    v_lshlrev_b32 v186, 11, v186
    v_and_b32 v187, 1, v25
    v_lshl_add_u32 v186, v187, 3, v186
    s_lshl_b32 s26, s29, 4
    s_add_u32 s26, s26, s27
    v_add_u32 v187, s26, v186
    s_mov_b32 vcc_lo, 0x00010001
    s_mov_b32 vcc_hi, 0x00010001
    s_mov_b64 exec, vcc
    ds_write_b64 v187, v[54:55]
    s_mov_b64 exec, 0xffff
    v_xor_b32 v187, s30, v13
    v_lshlrev_b32 v187, 4, v187
    v_lshl_add_u32 v187, v13, 8, v187
    s_add_u32 s26, s27, 4096
    s_add_u32 s26, s26, s31
    v_add_u32 v187, s26, v187
    ds_write_b16 v187, v56
    s_mov_b32 s27, 155648
    s_cmp_eq_u32 s47, 1
    s_cselect_b32 s27, 156160, s27
    s_cmp_eq_u32 s47, 2
    s_cselect_b32 s27, 155904, s27
    s_lshl_b32 s26, s30, 4
    s_add_u32 s27, s27, s26
    s_add_u32 s27, s27, s31
    v_mov_b32 v187, s27
    v_mov_b32 v185, 0x3f80
    ds_write_b16 v187, v185
    s_mov_b64 exec, -1
    s_lshl_b32 s25, s34, 6
    s_add_u32 s25, s25, 162816
    v_lshl_add_u32 v187, v13, 2, s25
    s_mov_b64 exec, 0xffff
    ds_write_b32 v187, v57
    s_mov_b64 exec, -1
    s_lshl_b32 s25, s34, 12
    s_lshl_b32 s26, s29, 4
    s_add_u32 s25, s25, s26
    s_add_u32 s25, s25, 131072
    v_add_u32 v187, s25, v186
    s_mov_b32 vcc_lo, 0x00010001
    s_mov_b32 vcc_hi, 0x00010001
    s_mov_b64 exec, vcc
    ds_write_b64 v187, v[52:53]
    s_mov_b64 exec, -1
    s_waitcnt lgkmcnt(0)
ZNP_51:
    s_barrier
    s_and_b32 s29, s41, 127
    s_lshr_b32 s30, s29, 4
    s_lshl_b32 s30, s30, 1
    s_lshr_b32 s28, s29, 2
    s_and_b32 s28, s28, 1
    s_add_u32 s30, s30, s28
    s_lshr_b32 s31, s29, 3
    s_and_b32 s31, s31, 1
    s_lshl_b32 s31, s31, 2
    s_and_b32 s28, s29, 3
    s_add_u32 s31, s31, s28
    s_lshl_b32 s31, s31, 1
    s_lshl_b32 s26, s34, 12
    s_add_u32 s26, s26, 131072
    s_lshl_b32 s27, s35, 9
    s_add_u32 s28, s26, s27
    v_add_u32 v186, s28, v204
    s_sub_u32 s28, s26, s27
    s_add_u32 s28, s28, 1536
    v_add_u32 v187, s28, v204
    ds_read_b128 v[40:43], v186
    ds_read_b128 v[44:47], v187
    s_lshl_b32 s27, s34, 13
    s_add_u32 s27, s27, 139264
    s_lshl_b32 s26, s29, 4
    s_add_u32 s27, s27, s26
    v_lshrrev_b32 v185, 5, v1
    v_lshlrev_b32 v186, 11, v185
    v_add_u32 v186, s27, v186
    ds_read_b128 v[52:55], v186
    s_lshl_b32 s25, s34, 6
    s_add_u32 s25, s25, 162816
    v_add_u32 v186, s25, v209
    ds_read_b128 v[56:59], v186
    ds_read_b128 v[60:63], v186 offset:32
    v_and_b32 v187, 27, v1
    v_cmp_eq_u32 s[70:71], 0, v187
    v_and_b32 v187, 31, v1
    v_subrev_u32 v187, s29, v187
    s_lshl_b32 s26, s35, 5
    v_add_u32 v210, s26, v187
    s_sub_u32 s26, 96, s26
    v_add_u32 v211, s26, v187
    s_mov_b32 s43, 0x100
    s_waitcnt lgkmcnt(0)
    v_cndmask_b32 v52, 0, v52, s[70:71]
    v_cndmask_b32 v53, 0, v53, s[70:71]
    v_cndmask_b32 v54, 0, v54, s[70:71]
    v_cndmask_b32 v55, 0, v55, s[70:71]
    s_nop 1
    v_mfma_f32_32x32x16_bf16 v[72:87], v[52:55], v[40:43], 0
    v_mfma_f32_32x32x16_bf16 v[88:103], v[52:55], v[44:47], 0
    s_lshl_b32 s25, s34, 12
    s_lshl_b32 s26, s29, 4
    s_add_u32 s25, s25, s26
    s_add_u32 s25, s25, 131072
    v_lshlrev_b32 v186, 11, v185
    v_add_u32 v186, s25, v186
    ds_read_b128 v[48:51], v186
    v_cmp_gt_u32 vcc, s43, v210
    s_nop 2
    v_exp_f32 v186, v72
    s_nop 1
    v_cndmask_b32 v186, 0, v186, vcc
    v_fmac_f32 v112, v186, v56
    v_fmac_f32 v113, v186, v57
    v_fmac_f32 v114, v186, v58
    v_fmac_f32 v115, v186, v59
    v_fmac_f32 v116, v186, v60
    v_fmac_f32 v117, v186, v61
    v_fmac_f32 v118, v186, v62
    v_fmac_f32 v119, v186, v63
    v_add_f32 v120, v120, v186
    v_cmp_gt_u32 vcc, s43, v211
    v_exp_f32 v186, v88
    s_nop 1
    v_cndmask_b32 v186, 0, v186, vcc
    v_fmac_f32 v128, v186, v56
    v_fmac_f32 v129, v186, v57
    v_fmac_f32 v130, v186, v58
    v_fmac_f32 v131, v186, v59
    v_fmac_f32 v132, v186, v60
    v_fmac_f32 v133, v186, v61
    v_fmac_f32 v134, v186, v62
    v_fmac_f32 v135, v186, v63
    v_add_f32 v136, v136, v186
    s_lshr_b32 s25, s29, 5
    s_sub_u32 s26, 3, s25
    s_min_u32 s26, s26, s25
    s_cmp_lg_u32 s26, s35
    s_cbranch_scc1 ZN_46
    v_and_b32 v187, 31, v1
    v_lshrrev_b32 v186, 4, v187
    v_lshlrev_b32 v188, 5, v186
    v_bfe_u32 v186, v187, 2, 1
    v_lshl_add_u32 v188, v186, 4, v188
    v_bfe_u32 v186, v187, 3, 1
    v_lshl_add_u32 v188, v186, 3, v188
    v_and_b32 v186, 3, v187
    v_lshl_add_u32 v188, v186, 1, v188
    s_lshl_b32 s25, s22, 10
    s_add_u32 s25, s25, 159232
    v_add_u32 v188, s25, v188
    v_add_u32 v189, s25, v209
    v_sub_u32 v190, s29, v187
    s_lshl_b32 s25, s34, 13
    s_add_u32 s25, s25, 139264
    v_add_u32 v184, s25, v204
    s_add_u32 s25, s25, 4096
    v_add_u32 v206, s25, v205
    v_add_u32 v208, 155648, v209
    v_cndmask_b32 v206, v208, v206, s[32:33]
    v_xor_b32 v207, 32, v206
    v_xor_b32 v176, 0, v206
    v_xor_b32 v180, 0, v207
    v_xor_b32 v177, 64, v206
    v_xor_b32 v181, 64, v207
    v_xor_b32 v178, 128, v206
    v_xor_b32 v182, 128, v207
    v_xor_b32 v179, 192, v206
    v_xor_b32 v183, 192, v207
    ds_read_b128 v[56:59], v184 offset:0
    ds_read_b128 v[60:63], v184 offset:512
    ds_read_b128 v[64:67], v184 offset:1024
    ds_read_b128 v[68:71], v184 offset:1536
    s_waitcnt lgkmcnt(0)
    v_cndmask_b32 v48, 0, v48, s[70:71]
    v_cndmask_b32 v49, 0, v49, s[70:71]
    v_cndmask_b32 v50, 0, v50, s[70:71]
    v_cndmask_b32 v51, 0, v51, s[70:71]
    s_nop 1
    v_mfma_f32_32x32x16_bf16 v[72:87], v[48:51], v[56:59], 0
    v_mfma_f32_32x32x16_bf16 v[88:103], v[48:51], v[60:63], 0
    s_nop 10
    v_exp_f32 v192, v72
    v_mfma_f32_32x32x16_bf16 v[72:87], v[48:51], v[64:67], 0
    v_exp_f32 v193, v88
    v_mfma_f32_32x32x16_bf16 v[88:103], v[48:51], v[68:71], 0
    s_nop 9
    v_exp_f32 v194, v72
    s_nop 0
    v_exp_f32 v195, v88
    v_subrev_u32 v191, 0, v190
    v_cmp_gt_u32 vcc, s43, v191
    s_nop 1
    v_cndmask_b32 v192, 0, v192, vcc
    v_cvt_pk_bf16_f32 v192, v192, v192
    v_subrev_u32 v191, 32, v190
    v_cmp_gt_u32 vcc, s43, v191
    s_nop 1
    v_cndmask_b32 v193, 0, v193, vcc
    v_cvt_pk_bf16_f32 v193, v193, v193
    v_subrev_u32 v191, 64, v190
    v_cmp_gt_u32 vcc, s43, v191
    s_nop 1
    v_cndmask_b32 v194, 0, v194, vcc
    v_cvt_pk_bf16_f32 v194, v194, v194
    v_subrev_u32 v191, 96, v190
    v_cmp_gt_u32 vcc, s43, v191
    s_nop 1
    v_cndmask_b32 v195, 0, v195, vcc
    v_cvt_pk_bf16_f32 v195, v195, v195
    s_mov_b32 exec_hi, 0
    ds_write_b16 v188, v192 offset:0
    ds_write_b16 v188, v193 offset:64
    ds_write_b16 v188, v194 offset:128
    ds_write_b16 v188, v195 offset:192
    s_mov_b64 exec, -1
    ds_read_b128 v[56:59], v176
    ds_read_b128 v[60:63], v177
    ds_read_b128 v[64:67], v178
    ds_read_b128 v[68:71], v179
    ds_read_b128 v[88:91], v180
    ds_read_b128 v[92:95], v181
    ds_read_b128 v[96:99], v182
    ds_read_b128 v[100:103], v183
    s_waitcnt lgkmcnt(8)
    ds_read_b128 v[144:147], v189 offset:0
    ds_read_b128 v[148:151], v189 offset:64
    ds_read_b128 v[152:155], v189 offset:128
    ds_read_b128 v[156:159], v189 offset:192
    s_waitcnt lgkmcnt(0)
    v_mfma_f32_32x32x16_bf16 v[72:87], v[56:59], v[144:147], 0
    v_mfma_f32_32x32x16_bf16 v[72:87], v[60:63], v[148:151], v[72:87]
    v_mfma_f32_32x32x16_bf16 v[72:87], v[64:67], v[152:155], v[72:87]
    v_mfma_f32_32x32x16_bf16 v[72:87], v[68:71], v[156:159], v[72:87]
    ds_read_b128 v[144:147], v189 offset:32
    ds_read_b128 v[148:151], v189 offset:96
    ds_read_b128 v[152:155], v189 offset:160
    ds_read_b128 v[156:159], v189 offset:224
    s_waitcnt lgkmcnt(0)
    v_mfma_f32_32x32x16_bf16 v[72:87], v[88:91], v[144:147], v[72:87]
    v_mfma_f32_32x32x16_bf16 v[72:87], v[92:95], v[148:151], v[72:87]
    v_mfma_f32_32x32x16_bf16 v[72:87], v[96:99], v[152:155], v[72:87]
    v_mfma_f32_32x32x16_bf16 v[72:87], v[100:103], v[156:159], v[72:87]
    s_and_b32 s26, s29, 31
    v_and_b32 v187, 31, v1
    v_cmp_eq_u32 vcc, s26, v187
    s_lshr_b32 s25, s29, 5
    s_cmp_eq_u32 s25, s35
    s_cbranch_scc0 ZRO_52
    s_nop 5
    v_cndmask_b32 v112, v112, v72, vcc
    v_cndmask_b32 v113, v113, v73, vcc
    v_cndmask_b32 v114, v114, v74, vcc
    v_cndmask_b32 v115, v115, v75, vcc
    v_cndmask_b32 v116, v116, v76, vcc
    v_cndmask_b32 v117, v117, v77, vcc
    v_cndmask_b32 v118, v118, v78, vcc
    v_cndmask_b32 v119, v119, v79, vcc
    v_cndmask_b32 v120, v120, v80, vcc
ZRO_52:
    s_sub_u32 s26, 3, s35
    s_cmp_eq_u32 s25, s26
    s_cbranch_scc0 ZRO_53
    s_nop 2
    v_cndmask_b32 v128, v128, v72, vcc
    v_cndmask_b32 v129, v129, v73, vcc
    v_cndmask_b32 v130, v130, v74, vcc
    v_cndmask_b32 v131, v131, v75, vcc
    v_cndmask_b32 v132, v132, v76, vcc
    v_cndmask_b32 v133, v133, v77, vcc
    v_cndmask_b32 v134, v134, v78, vcc
    v_cndmask_b32 v135, v135, v79, vcc
    v_cndmask_b32 v136, v136, v80, vcc
ZRO_53:
ZN_46:
    s_cmp_eq_u32 s36, 0
    s_cbranch_scc1 NOHALO_54
    s_sub_u32 s25, s36, 1
    s_max_i32 s25, s25, 0
    s_and_b32 s26, s25, 1
    s_lshl_b32 s27, s45, 1
    s_add_u32 s26, s26, s27
    s_lshl_b32 s26, s26, 3
    s_lshr_b32 s27, s25, 1
    s_add_u32 s29, s26, s27
    s_sub_u32 s25, s36, 2
    s_max_i32 s25, s25, 0
    s_and_b32 s26, s25, 1
    s_lshl_b32 s27, s45, 1
    s_add_u32 s26, s26, s27
    s_lshl_b32 s26, s26, 3
    s_lshr_b32 s27, s25, 1
    s_add_u32 s30, s26, s27
    s_lshl_b32 s29, s29, 7
    s_lshl_b32 s30, s30, 7
    v_and_b32 v206, 3, v1
    v_lshlrev_b32 v206, 2, v206
    v_and_b32 v207, 4, v1
    v_cmp_eq_u32 vcc, 0, v207
    v_mov_b32 v207, s30
    v_mov_b32 v210, s29
    v_cndmask_b32 v207, v207, v210, vcc
    v_add_u32 v206, v206, v207
    s_lshl_b32 s27, s24, 15
    s_add_u32 s27, s27, 0x1000
    s_cmp_lg_u32 s22, 0
    s_cbranch_scc1 PLD_57
    s_mov_b32 s76, 0
POLL_58:
    buffer_load_dword v216, v206, s[8:11], s27 offen sc1
    s_waitcnt vmcnt(0)
    v_xor_b32 v219, s23, v216
    v_cmp_ne_u32 vcc, 0, v219
    s_nop 1
    s_cmp_eq_u64 vcc, 0
    s_cbranch_scc1 POLD_59
    s_sleep 4
    s_add_u32 s76, s76, 1
    s_cmp_lt_u32 s76, 0x40000
    s_cbranch_scc1 POLL_58
    s_mov_b32 s12, s66
    s_and_b32 s13, s67, 0xffff
    s_mov_b32 s14, 0x100
    s_mov_b32 s15, 0x20000
    v_mov_b32 v221, 2
    buffer_store_dword v221, off, s[12:15], 0
    s_waitcnt vmcnt(0)
POLD_59:
PLD_57:
    s_barrier
    s_lshl_b32 s27, s36, 4
    s_add_u32 s27, s27, s45
    s_sub_u32 s27, s27, 16
    s_lshl_b32 s27, s27, 14
    s_lshl_b32 s26, s24, 22
    s_add_u32 s27, s27, s26
    s_lshl_b32 s26, s22, 12
    s_add_u32 s27, s27, s26
    s_add_u32 s27, s27, 0x100000
    s_add_u32 m0, s26, 16384
    s_nop 0
    buffer_load_dwordx4 v7, s[8:11], s27 offen offset:0 sc1 lds
    buffer_load_dwordx4 v7, s[8:11], s27 offen offset:1024 sc1 lds
    buffer_load_dwordx4 v7, s[8:11], s27 offen offset:2048 sc1 lds
    buffer_load_dwordx4 v7, s[8:11], s27 offen offset:3072 sc1 lds
    s_cmp_eq_u32 s36, 1
    s_cbranch_scc1 HALOB_55
    s_sub_u32 s27, s27, 262144
    s_add_u32 m0, s26, 0
    s_nop 0
    buffer_load_dwordx4 v7, s[8:11], s27 offen offset:0 sc1 lds
    buffer_load_dwordx4 v7, s[8:11], s27 offen offset:1024 sc1 lds
    buffer_load_dwordx4 v7, s[8:11], s27 offen offset:2048 sc1 lds
    buffer_load_dwordx4 v7, s[8:11], s27 offen offset:3072 sc1 lds
HALOB_55:
    s_mov_b32 s12, s52
    s_and_b32 s13, s53, 0xffff
    s_mov_b32 s14, 0x80000
    s_mov_b32 s15, 0x20000
    v_lshrrev_b32 v210, 3, v1
    v_lshlrev_b32 v210, 10, v210
    v_and_b32 v211, 7, v1
    v_bfe_u32 v212, v1, 4, 1
    v_lshlrev_b32 v212, 1, v212
    v_xor_b32 v211, v211, v212
    v_lshl_add_u32 v210, v211, 4, v210
    v_xor_b32 v211, 64, v210
    s_and_b32 s25, s21, 7
    s_lshl_b32 s25, s25, 7
    s_lshl_b32 s26, s22, 17
    s_add_u32 s25, s25, s26
    s_lshl_b32 s27, s22, 14
    s_add_u32 s27, s27, 65536
    s_add_u32 m0, s27, 0
    s_add_u32 s26, s25, 0
    buffer_load_dwordx4 v210, s[12:15], s26 offen lds
    s_add_u32 m0, s27, 1024
    s_add_u32 s26, s25, 8192
    buffer_load_dwordx4 v211, s[12:15], s26 offen lds
    s_add_u32 m0, s27, 2048
    s_add_u32 s26, s25, 16384
    buffer_load_dwordx4 v210, s[12:15], s26 offen lds
    s_add_u32 m0, s27, 3072
    s_add_u32 s26, s25, 24576
    buffer_load_dwordx4 v211, s[12:15], s26 offen lds
    s_add_u32 m0, s27, 4096
    s_add_u32 s26, s25, 32768
    buffer_load_dwordx4 v210, s[12:15], s26 offen lds
    s_add_u32 m0, s27, 5120
    s_add_u32 s26, s25, 40960
    buffer_load_dwordx4 v211, s[12:15], s26 offen lds
    s_add_u32 m0, s27, 6144
    s_add_u32 s26, s25, 49152
    buffer_load_dwordx4 v210, s[12:15], s26 offen lds
    s_add_u32 m0, s27, 7168
    s_add_u32 s26, s25, 57344
    buffer_load_dwordx4 v211, s[12:15], s26 offen lds
    s_add_u32 m0, s27, 8192
    s_add_u32 s26, s25, 65536
    buffer_load_dwordx4 v210, s[12:15], s26 offen lds
    s_add_u32 m0, s27, 9216
    s_add_u32 s26, s25, 73728
    buffer_load_dwordx4 v211, s[12:15], s26 offen lds
    s_add_u32 m0, s27, 10240
    s_add_u32 s26, s25, 81920
    buffer_load_dwordx4 v210, s[12:15], s26 offen lds
    s_add_u32 m0, s27, 11264
    s_add_u32 s26, s25, 90112
    buffer_load_dwordx4 v211, s[12:15], s26 offen lds
    s_add_u32 m0, s27, 12288
    s_add_u32 s26, s25, 98304
    buffer_load_dwordx4 v210, s[12:15], s26 offen lds
    s_add_u32 m0, s27, 13312
    s_add_u32 s26, s25, 106496
    buffer_load_dwordx4 v211, s[12:15], s26 offen lds
    s_add_u32 m0, s27, 14336
    s_add_u32 s26, s25, 114688
    buffer_load_dwordx4 v210, s[12:15], s26 offen lds
    s_add_u32 m0, s27, 15360
    s_add_u32 s26, s25, 122880
    buffer_load_dwordx4 v211, s[12:15], s26 offen lds
    s_lshl_b32 s25, s34, 13
    s_add_u32 s25, s25, 16384
    v_add_u32 v184, s25, v204
    s_add_u32 s25, s25, 4096
    v_add_u32 v206, s25, v205
    v_add_u32 v208, 156160, v209
    v_cndmask_b32 v206, v208, v206, s[32:33]
    v_xor_b32 v207, 32, v206
    v_xor_b32 v176, 0, v206
    v_xor_b32 v180, 0, v207
    v_xor_b32 v177, 64, v206
    v_xor_b32 v181, 64, v207
    v_xor_b32 v178, 128, v206
    v_xor_b32 v182, 128, v207
    v_xor_b32 v179, 192, v206
    v_xor_b32 v183, 192, v207
    s_waitcnt vmcnt(16)
    s_barrier
    s_cmp_eq_u32 s47, 3
    s_cbranch_scc1 ZHP_61
    s_cmp_eq_u32 s47, 0
    s_cbranch_scc1 ZHP_61
    s_cmp_lg_u32 s35, 0
    s_cbranch_scc1 ZHW_62
    s_and_b32 s29, s41, 127
    s_lshr_b32 s30, s29, 4
    s_lshl_b32 s30, s30, 1
    s_lshr_b32 s28, s29, 2
    s_and_b32 s28, s28, 1
    s_add_u32 s30, s30, s28
    s_lshr_b32 s31, s29, 3
    s_and_b32 s31, s31, 1
    s_lshl_b32 s31, s31, 2
    s_and_b32 s28, s29, 3
    s_add_u32 s31, s31, s28
    s_lshl_b32 s31, s31, 1
    s_mov_b32 s27, 139264
    s_cmp_eq_u32 s47, 1
    s_cselect_b32 s27, 16384, s27
    s_cmp_eq_u32 s47, 2
    s_cselect_b32 s27, 0, s27
    s_lshl_b32 s26, s34, 13
    s_add_u32 s27, s27, s26
    v_lshrrev_b32 v186, 1, v25
    v_lshlrev_b32 v186, 11, v186
    v_and_b32 v187, 1, v25
    v_lshl_add_u32 v186, v187, 3, v186
    s_lshl_b32 s26, s29, 4
    s_add_u32 s26, s26, s27
    v_add_u32 v187, s26, v186
    s_mov_b32 vcc_lo, 0x00010001
    s_mov_b32 vcc_hi, 0x00010001
    s_mov_b64 exec, vcc
    ds_write_b64 v187, v[54:55]
    s_mov_b64 exec, 0xffff
    v_xor_b32 v187, s30, v13
    v_lshlrev_b32 v187, 4, v187
    v_lshl_add_u32 v187, v13, 8, v187
    s_add_u32 s26, s27, 4096
    s_add_u32 s26, s26, s31
    v_add_u32 v187, s26, v187
    ds_write_b16 v187, v56
    s_mov_b32 s27, 155648
    s_cmp_eq_u32 s47, 1
    s_cselect_b32 s27, 156160, s27
    s_cmp_eq_u32 s47, 2
    s_cselect_b32 s27, 155904, s27
    s_lshl_b32 s26, s30, 4
    s_add_u32 s27, s27, s26
    s_add_u32 s27, s27, s31
    v_mov_b32 v187, s27
    v_mov_b32 v185, 0x3f80
    ds_write_b16 v187, v185
    s_mov_b64 exec, -1
    s_waitcnt lgkmcnt(0)
ZHW_62:
    s_barrier
ZHP_61:
    ds_read_b128 v[48:51], v184 offset:0
    ds_read_b128 v[56:59], v176
    ds_read_b128 v[60:63], v180
    ds_read_b128 v[52:55], v184 offset:0
    s_waitcnt lgkmcnt(3)
    v_mfma_f32_32x32x16_bf16 v[72:87], v[48:51], v[40:43], 0
    s_nop 11
    v_exp_f32 v72, v72
    v_exp_f32 v73, v73
    v_exp_f32 v74, v74
    v_exp_f32 v75, v75
    s_waitcnt lgkmcnt(0)
    v_mfma_f32_32x32x16_bf16 v[88:103], v[52:55], v[44:47], 0
    ds_read_b128 v[48:51], v184 offset:512
    v_exp_f32 v76, v76
    v_exp_f32 v77, v77
    v_exp_f32 v78, v78
    v_exp_f32 v79, v79
    v_cvt_pk_bf16_f32 v104, v72, v73
    v_cvt_pk_bf16_f32 v105, v74, v75
    v_cvt_pk_bf16_f32 v106, v76, v77
    v_cvt_pk_bf16_f32 v107, v78, v79
    v_exp_f32 v80, v80
    v_exp_f32 v81, v81
    v_mfma_f32_32x32x16_bf16 v[112:127], v[56:59], v[104:107], v[112:127]
    ds_read_b128 v[64:67], v176
    ds_read_b128 v[68:71], v180
    v_exp_f32 v82, v82
    v_exp_f32 v83, v83
    v_exp_f32 v84, v84
    v_exp_f32 v85, v85
    v_exp_f32 v86, v86
    v_exp_f32 v87, v87
    v_cvt_pk_bf16_f32 v108, v80, v81
    v_cvt_pk_bf16_f32 v109, v82, v83
    v_cvt_pk_bf16_f32 v110, v84, v85
    v_cvt_pk_bf16_f32 v111, v86, v87
    s_nop 1
    v_mfma_f32_32x32x16_bf16 v[112:127], v[60:63], v[108:111], v[112:127]
    v_exp_f32 v88, v88
    v_exp_f32 v89, v89
    v_exp_f32 v90, v90
    v_exp_f32 v91, v91
    s_waitcnt lgkmcnt(0)
    v_mfma_f32_32x32x16_bf16 v[72:87], v[48:51], v[40:43], 0
    ds_read_b128 v[52:55], v184 offset:512
    v_exp_f32 v92, v92
    v_exp_f32 v93, v93
    v_exp_f32 v94, v94
    v_exp_f32 v95, v95
    v_cvt_pk_bf16_f32 v104, v88, v89
    v_cvt_pk_bf16_f32 v105, v90, v91
    v_cvt_pk_bf16_f32 v106, v92, v93
    v_cvt_pk_bf16_f32 v107, v94, v95
    v_exp_f32 v96, v96
    v_exp_f32 v97, v97
    v_mfma_f32_32x32x16_bf16 v[128:143], v[64:67], v[104:107], v[128:143]
    ds_read_b128 v[56:59], v177
    ds_read_b128 v[60:63], v181
    v_exp_f32 v98, v98
    v_exp_f32 v99, v99
    v_exp_f32 v100, v100
    v_exp_f32 v101, v101
    v_exp_f32 v102, v102
    v_exp_f32 v103, v103
    v_cvt_pk_bf16_f32 v108, v96, v97
    v_cvt_pk_bf16_f32 v109, v98, v99
    v_cvt_pk_bf16_f32 v110, v100, v101
    v_cvt_pk_bf16_f32 v111, v102, v103
    s_nop 1
    v_mfma_f32_32x32x16_bf16 v[128:143], v[68:71], v[108:111], v[128:143]
    v_exp_f32 v72, v72
    v_exp_f32 v73, v73
    v_exp_f32 v74, v74
    v_exp_f32 v75, v75
    s_waitcnt lgkmcnt(0)
    v_mfma_f32_32x32x16_bf16 v[88:103], v[52:55], v[44:47], 0
    ds_read_b128 v[48:51], v184 offset:1024
    v_exp_f32 v76, v76
    v_exp_f32 v77, v77
    v_exp_f32 v78, v78
    v_exp_f32 v79, v79
    v_cvt_pk_bf16_f32 v104, v72, v73
    v_cvt_pk_bf16_f32 v105, v74, v75
    v_cvt_pk_bf16_f32 v106, v76, v77
    v_cvt_pk_bf16_f32 v107, v78, v79
    v_exp_f32 v80, v80
    v_exp_f32 v81, v81
    v_mfma_f32_32x32x16_bf16 v[112:127], v[56:59], v[104:107], v[112:127]
    ds_read_b128 v[64:67], v177
    ds_read_b128 v[68:71], v181
    v_exp_f32 v82, v82
    v_exp_f32 v83, v83
    v_exp_f32 v84, v84
    v_exp_f32 v85, v85
    v_exp_f32 v86, v86
    v_exp_f32 v87, v87
    v_cvt_pk_bf16_f32 v108, v80, v81
    v_cvt_pk_bf16_f32 v109, v82, v83
    v_cvt_pk_bf16_f32 v110, v84, v85
    v_cvt_pk_bf16_f32 v111, v86, v87
    s_nop 1
    v_mfma_f32_32x32x16_bf16 v[112:127], v[60:63], v[108:111], v[112:127]
    v_exp_f32 v88, v88
    v_exp_f32 v89, v89
    v_exp_f32 v90, v90
    v_exp_f32 v91, v91
    s_waitcnt lgkmcnt(0)
    v_mfma_f32_32x32x16_bf16 v[72:87], v[48:51], v[40:43], 0
    ds_read_b128 v[52:55], v184 offset:1024
    v_exp_f32 v92, v92
    v_exp_f32 v93, v93
    v_exp_f32 v94, v94
    v_exp_f32 v95, v95
    v_cvt_pk_bf16_f32 v104, v88, v89
    v_cvt_pk_bf16_f32 v105, v90, v91
    v_cvt_pk_bf16_f32 v106, v92, v93
    v_cvt_pk_bf16_f32 v107, v94, v95
    v_exp_f32 v96, v96
    v_exp_f32 v97, v97
    v_mfma_f32_32x32x16_bf16 v[128:143], v[64:67], v[104:107], v[128:143]
    ds_read_b128 v[56:59], v178
    ds_read_b128 v[60:63], v182
    v_exp_f32 v98, v98
    v_exp_f32 v99, v99
    v_exp_f32 v100, v100
    v_exp_f32 v101, v101
    v_exp_f32 v102, v102
    v_exp_f32 v103, v103
    v_cvt_pk_bf16_f32 v108, v96, v97
    v_cvt_pk_bf16_f32 v109, v98, v99
    v_cvt_pk_bf16_f32 v110, v100, v101
    v_cvt_pk_bf16_f32 v111, v102, v103
    s_nop 1
    v_mfma_f32_32x32x16_bf16 v[128:143], v[68:71], v[108:111], v[128:143]
    v_exp_f32 v72, v72
    v_exp_f32 v73, v73
    v_exp_f32 v74, v74
    v_exp_f32 v75, v75
    s_waitcnt lgkmcnt(0)
    v_mfma_f32_32x32x16_bf16 v[88:103], v[52:55], v[44:47], 0
    ds_read_b128 v[48:51], v184 offset:1536
    v_exp_f32 v76, v76
    v_exp_f32 v77, v77
    v_exp_f32 v78, v78
    v_exp_f32 v79, v79
    v_cvt_pk_bf16_f32 v104, v72, v73
    v_cvt_pk_bf16_f32 v105, v74, v75
    v_cvt_pk_bf16_f32 v106, v76, v77
    v_cvt_pk_bf16_f32 v107, v78, v79
    v_exp_f32 v80, v80
    v_exp_f32 v81, v81
    v_mfma_f32_32x32x16_bf16 v[112:127], v[56:59], v[104:107], v[112:127]
    ds_read_b128 v[64:67], v178
    ds_read_b128 v[68:71], v182
    v_exp_f32 v82, v82
    v_exp_f32 v83, v83
    v_exp_f32 v84, v84
    v_exp_f32 v85, v85
    v_exp_f32 v86, v86
    v_exp_f32 v87, v87
    v_cvt_pk_bf16_f32 v108, v80, v81
    v_cvt_pk_bf16_f32 v109, v82, v83
    v_cvt_pk_bf16_f32 v110, v84, v85
    v_cvt_pk_bf16_f32 v111, v86, v87
    s_nop 1
    v_mfma_f32_32x32x16_bf16 v[112:127], v[60:63], v[108:111], v[112:127]
    v_exp_f32 v88, v88
    v_exp_f32 v89, v89
    v_exp_f32 v90, v90
    v_exp_f32 v91, v91
    s_waitcnt lgkmcnt(0)
    v_mfma_f32_32x32x16_bf16 v[72:87], v[48:51], v[40:43], 0
    ds_read_b128 v[52:55], v184 offset:1536
    v_exp_f32 v92, v92
    v_exp_f32 v93, v93
    v_exp_f32 v94, v94
    v_exp_f32 v95, v95
    v_cvt_pk_bf16_f32 v104, v88, v89
    v_cvt_pk_bf16_f32 v105, v90, v91
    v_cvt_pk_bf16_f32 v106, v92, v93
    v_cvt_pk_bf16_f32 v107, v94, v95
    v_exp_f32 v96, v96
    v_exp_f32 v97, v97
    v_mfma_f32_32x32x16_bf16 v[128:143], v[64:67], v[104:107], v[128:143]
    ds_read_b128 v[56:59], v179
    ds_read_b128 v[60:63], v183
    v_exp_f32 v98, v98
    v_exp_f32 v99, v99
    v_exp_f32 v100, v100
    v_exp_f32 v101, v101
    v_exp_f32 v102, v102
    v_exp_f32 v103, v103
    v_cvt_pk_bf16_f32 v108, v96, v97
    v_cvt_pk_bf16_f32 v109, v98, v99
    v_cvt_pk_bf16_f32 v110, v100, v101
    v_cvt_pk_bf16_f32 v111, v102, v103
    s_nop 1
    v_mfma_f32_32x32x16_bf16 v[128:143], v[68:71], v[108:111], v[128:143]
    v_exp_f32 v72, v72
    v_exp_f32 v73, v73
    v_exp_f32 v74, v74
    v_exp_f32 v75, v75
    s_waitcnt lgkmcnt(0)
    v_mfma_f32_32x32x16_bf16 v[88:103], v[52:55], v[44:47], 0
    v_exp_f32 v76, v76
    v_exp_f32 v77, v77
    v_exp_f32 v78, v78
    v_exp_f32 v79, v79
    v_cvt_pk_bf16_f32 v104, v72, v73
    v_cvt_pk_bf16_f32 v105, v74, v75
    v_cvt_pk_bf16_f32 v106, v76, v77
    v_cvt_pk_bf16_f32 v107, v78, v79
    v_exp_f32 v80, v80
    v_exp_f32 v81, v81
    v_mfma_f32_32x32x16_bf16 v[112:127], v[56:59], v[104:107], v[112:127]
    ds_read_b128 v[64:67], v179
    ds_read_b128 v[68:71], v183
    v_exp_f32 v82, v82
    v_exp_f32 v83, v83
    v_exp_f32 v84, v84
    v_exp_f32 v85, v85
    v_exp_f32 v86, v86
    v_exp_f32 v87, v87
    v_cvt_pk_bf16_f32 v108, v80, v81
    v_cvt_pk_bf16_f32 v109, v82, v83
    v_cvt_pk_bf16_f32 v110, v84, v85
    v_cvt_pk_bf16_f32 v111, v86, v87
    s_nop 1
    v_mfma_f32_32x32x16_bf16 v[112:127], v[60:63], v[108:111], v[112:127]
    v_exp_f32 v88, v88
    v_exp_f32 v89, v89
    v_exp_f32 v90, v90
    v_exp_f32 v91, v91
    s_waitcnt lgkmcnt(0)
    v_exp_f32 v92, v92
    v_exp_f32 v93, v93
    v_exp_f32 v94, v94
    v_exp_f32 v95, v95
    v_cvt_pk_bf16_f32 v104, v88, v89
    v_cvt_pk_bf16_f32 v105, v90, v91
    v_cvt_pk_bf16_f32 v106, v92, v93
    v_cvt_pk_bf16_f32 v107, v94, v95
    v_exp_f32 v96, v96
    v_exp_f32 v97, v97
    v_mfma_f32_32x32x16_bf16 v[128:143], v[64:67], v[104:107], v[128:143]
    v_exp_f32 v98, v98
    v_exp_f32 v99, v99
    v_exp_f32 v100, v100
    v_exp_f32 v101, v101
    v_exp_f32 v102, v102
    v_exp_f32 v103, v103
    v_cvt_pk_bf16_f32 v108, v96, v97
    v_cvt_pk_bf16_f32 v109, v98, v99
    v_cvt_pk_bf16_f32 v110, v100, v101
    v_cvt_pk_bf16_f32 v111, v102, v103
    s_nop 1
    v_mfma_f32_32x32x16_bf16 v[128:143], v[68:71], v[108:111], v[128:143]
    s_cmp_eq_u32 s36, 1
    s_cbranch_scc1 HALOE_56
    s_lshl_b32 s25, s34, 13
    s_add_u32 s25, s25, 0
    v_add_u32 v184, s25, v204
    s_add_u32 s25, s25, 4096
    v_add_u32 v206, s25, v205
    v_add_u32 v208, 155904, v209
    v_cndmask_b32 v206, v208, v206, s[32:33]
    v_xor_b32 v207, 32, v206
    v_xor_b32 v176, 0, v206
    v_xor_b32 v180, 0, v207
    v_xor_b32 v177, 64, v206
    v_xor_b32 v181, 64, v207
    v_xor_b32 v178, 128, v206
    v_xor_b32 v182, 128, v207
    v_xor_b32 v179, 192, v206
    v_xor_b32 v183, 192, v207
    s_cmp_eq_u32 s35, 1
    s_cbranch_scc1 VAR1_63
    ds_read_b128 v[48:51], v184 offset:0
    ds_read_b128 v[56:59], v176
    ds_read_b128 v[60:63], v180
    ds_read_b128 v[52:55], v184 offset:512
    s_waitcnt lgkmcnt(3)
    v_mfma_f32_32x32x16_bf16 v[72:87], v[48:51], v[40:43], v[160:175]
    s_nop 11
    v_exp_f32 v72, v72
    v_exp_f32 v73, v73
    v_exp_f32 v74, v74
    v_exp_f32 v75, v75
    s_waitcnt lgkmcnt(0)
    v_mfma_f32_32x32x16_bf16 v[88:103], v[52:55], v[40:43], 0
    ds_read_b128 v[48:51], v184 offset:1024
    v_exp_f32 v76, v76
    v_exp_f32 v77, v77
    v_exp_f32 v78, v78
    v_exp_f32 v79, v79
    v_cvt_pk_bf16_f32 v104, v72, v73
    v_cvt_pk_bf16_f32 v105, v74, v75
    v_cvt_pk_bf16_f32 v106, v76, v77
    v_cvt_pk_bf16_f32 v107, v78, v79
    v_exp_f32 v80, v80
    v_exp_f32 v81, v81
    v_mfma_f32_32x32x16_bf16 v[112:127], v[56:59], v[104:107], v[112:127]
    ds_read_b128 v[64:67], v177
    ds_read_b128 v[68:71], v181
    v_exp_f32 v82, v82
    v_exp_f32 v83, v83
    v_exp_f32 v84, v84
    v_exp_f32 v85, v85
    v_exp_f32 v86, v86
    v_exp_f32 v87, v87
    v_cvt_pk_bf16_f32 v108, v80, v81
    v_cvt_pk_bf16_f32 v109, v82, v83
    v_cvt_pk_bf16_f32 v110, v84, v85
    v_cvt_pk_bf16_f32 v111, v86, v87
    s_nop 1
    v_mfma_f32_32x32x16_bf16 v[112:127], v[60:63], v[108:111], v[112:127]
    v_exp_f32 v88, v88
    v_exp_f32 v89, v89
    v_exp_f32 v90, v90
    v_exp_f32 v91, v91
    s_waitcnt lgkmcnt(0)
    v_mfma_f32_32x32x16_bf16 v[72:87], v[48:51], v[40:43], 0
    ds_read_b128 v[52:55], v184 offset:1536
    v_exp_f32 v92, v92
    v_exp_f32 v93, v93
    v_exp_f32 v94, v94
    v_exp_f32 v95, v95
    v_cvt_pk_bf16_f32 v104, v88, v89
    v_cvt_pk_bf16_f32 v105, v90, v91
    v_cvt_pk_bf16_f32 v106, v92, v93
    v_cvt_pk_bf16_f32 v107, v94, v95
    v_exp_f32 v96, v96
    v_exp_f32 v97, v97
    v_mfma_f32_32x32x16_bf16 v[112:127], v[64:67], v[104:107], v[112:127]
    ds_read_b128 v[56:59], v178
    ds_read_b128 v[60:63], v182
    v_exp_f32 v98, v98
    v_exp_f32 v99, v99
    v_exp_f32 v100, v100
    v_exp_f32 v101, v101
    v_exp_f32 v102, v102
    v_exp_f32 v103, v103
    v_cvt_pk_bf16_f32 v108, v96, v97
    v_cvt_pk_bf16_f32 v109, v98, v99
    v_cvt_pk_bf16_f32 v110, v100, v101
    v_cvt_pk_bf16_f32 v111, v102, v103
    s_nop 1
    v_mfma_f32_32x32x16_bf16 v[112:127], v[68:71], v[108:111], v[112:127]
    v_exp_f32 v72, v72
    v_exp_f32 v73, v73
    v_exp_f32 v74, v74
    v_exp_f32 v75, v75
    s_waitcnt lgkmcnt(0)
    v_mfma_f32_32x32x16_bf16 v[88:103], v[52:55], v[40:43], 0
    ds_read_b128 v[48:51], v184 offset:1536
    v_exp_f32 v76, v76
    v_exp_f32 v77, v77
    v_exp_f32 v78, v78
    v_exp_f32 v79, v79
    v_cvt_pk_bf16_f32 v104, v72, v73
    v_cvt_pk_bf16_f32 v105, v74, v75
    v_cvt_pk_bf16_f32 v106, v76, v77
    v_cvt_pk_bf16_f32 v107, v78, v79
    v_exp_f32 v80, v80
    v_exp_f32 v81, v81
    v_mfma_f32_32x32x16_bf16 v[112:127], v[56:59], v[104:107], v[112:127]
    ds_read_b128 v[64:67], v179
    ds_read_b128 v[68:71], v183
    v_exp_f32 v82, v82
    v_exp_f32 v83, v83
    v_exp_f32 v84, v84
    v_exp_f32 v85, v85
    v_exp_f32 v86, v86
    v_exp_f32 v87, v87
    v_cvt_pk_bf16_f32 v108, v80, v81
    v_cvt_pk_bf16_f32 v109, v82, v83
    v_cvt_pk_bf16_f32 v110, v84, v85
    v_cvt_pk_bf16_f32 v111, v86, v87
    s_nop 1
    v_mfma_f32_32x32x16_bf16 v[112:127], v[60:63], v[108:111], v[112:127]
    v_exp_f32 v88, v88
    v_exp_f32 v89, v89
    v_exp_f32 v90, v90
    v_exp_f32 v91, v91
    s_waitcnt lgkmcnt(0)
    v_mfma_f32_32x32x16_bf16 v[72:87], v[48:51], v[44:47], v[160:175]
    v_exp_f32 v92, v92
    v_exp_f32 v93, v93
    v_exp_f32 v94, v94
    v_exp_f32 v95, v95
    v_cvt_pk_bf16_f32 v104, v88, v89
    v_cvt_pk_bf16_f32 v105, v90, v91
    v_cvt_pk_bf16_f32 v106, v92, v93
    v_cvt_pk_bf16_f32 v107, v94, v95
    v_exp_f32 v96, v96
    v_exp_f32 v97, v97
    v_mfma_f32_32x32x16_bf16 v[112:127], v[64:67], v[104:107], v[112:127]
    ds_read_b128 v[56:59], v179
    ds_read_b128 v[60:63], v183
    v_exp_f32 v98, v98
    v_exp_f32 v99, v99
    v_exp_f32 v100, v100
    v_exp_f32 v101, v101
    v_exp_f32 v102, v102
    v_exp_f32 v103, v103
    v_cvt_pk_bf16_f32 v108, v96, v97
    v_cvt_pk_bf16_f32 v109, v98, v99
    v_cvt_pk_bf16_f32 v110, v100, v101
    v_cvt_pk_bf16_f32 v111, v102, v103
    s_nop 1
    v_mfma_f32_32x32x16_bf16 v[112:127], v[68:71], v[108:111], v[112:127]
    v_exp_f32 v72, v72
    v_exp_f32 v73, v73
    v_exp_f32 v74, v74
    v_exp_f32 v75, v75
    s_waitcnt lgkmcnt(0)
    v_exp_f32 v76, v76
    v_exp_f32 v77, v77
    v_exp_f32 v78, v78
    v_exp_f32 v79, v79
    v_cvt_pk_bf16_f32 v104, v72, v73
    v_cvt_pk_bf16_f32 v105, v74, v75
    v_cvt_pk_bf16_f32 v106, v76, v77
    v_cvt_pk_bf16_f32 v107, v78, v79
    v_exp_f32 v80, v80
    v_exp_f32 v81, v81
    v_mfma_f32_32x32x16_bf16 v[128:143], v[56:59], v[104:107], v[128:143]
    v_exp_f32 v82, v82
    v_exp_f32 v83, v83
    v_exp_f32 v84, v84
    v_exp_f32 v85, v85
    v_exp_f32 v86, v86
    v_exp_f32 v87, v87
    v_cvt_pk_bf16_f32 v108, v80, v81
    v_cvt_pk_bf16_f32 v109, v82, v83
    v_cvt_pk_bf16_f32 v110, v84, v85
    v_cvt_pk_bf16_f32 v111, v86, v87
    s_nop 1
    v_mfma_f32_32x32x16_bf16 v[128:143], v[60:63], v[108:111], v[128:143]
    s_branch VARJ_64
VAR1_63:
    ds_read_b128 v[48:51], v184 offset:512
    ds_read_b128 v[56:59], v177
    ds_read_b128 v[60:63], v181
    ds_read_b128 v[52:55], v184 offset:1024
    s_waitcnt lgkmcnt(3)
    v_mfma_f32_32x32x16_bf16 v[72:87], v[48:51], v[40:43], v[160:175]
    s_nop 11
    v_exp_f32 v72, v72
    v_exp_f32 v73, v73
    v_exp_f32 v74, v74
    v_exp_f32 v75, v75
    s_waitcnt lgkmcnt(0)
    v_mfma_f32_32x32x16_bf16 v[88:103], v[52:55], v[40:43], 0
    ds_read_b128 v[48:51], v184 offset:1536
    v_exp_f32 v76, v76
    v_exp_f32 v77, v77
    v_exp_f32 v78, v78
    v_exp_f32 v79, v79
    v_cvt_pk_bf16_f32 v104, v72, v73
    v_cvt_pk_bf16_f32 v105, v74, v75
    v_cvt_pk_bf16_f32 v106, v76, v77
    v_cvt_pk_bf16_f32 v107, v78, v79
    v_exp_f32 v80, v80
    v_exp_f32 v81, v81
    v_mfma_f32_32x32x16_bf16 v[112:127], v[56:59], v[104:107], v[112:127]
    ds_read_b128 v[64:67], v178
    ds_read_b128 v[68:71], v182
    v_exp_f32 v82, v82
    v_exp_f32 v83, v83
    v_exp_f32 v84, v84
    v_exp_f32 v85, v85
    v_exp_f32 v86, v86
    v_exp_f32 v87, v87
    v_cvt_pk_bf16_f32 v108, v80, v81
    v_cvt_pk_bf16_f32 v109, v82, v83
    v_cvt_pk_bf16_f32 v110, v84, v85
    v_cvt_pk_bf16_f32 v111, v86, v87
    s_nop 1
    v_mfma_f32_32x32x16_bf16 v[112:127], v[60:63], v[108:111], v[112:127]
    v_exp_f32 v88, v88
    v_exp_f32 v89, v89
    v_exp_f32 v90, v90
    v_exp_f32 v91, v91
    s_waitcnt lgkmcnt(0)
    v_mfma_f32_32x32x16_bf16 v[72:87], v[48:51], v[40:43], 0
    ds_read_b128 v[52:55], v184 offset:1024
    v_exp_f32 v92, v92
    v_exp_f32 v93, v93
    v_exp_f32 v94, v94
    v_exp_f32 v95, v95
    v_cvt_pk_bf16_f32 v104, v88, v89
    v_cvt_pk_bf16_f32 v105, v90, v91
    v_cvt_pk_bf16_f32 v106, v92, v93
    v_cvt_pk_bf16_f32 v107, v94, v95
    v_exp_f32 v96, v96
    v_exp_f32 v97, v97
    v_mfma_f32_32x32x16_bf16 v[112:127], v[64:67], v[104:107], v[112:127]
    ds_read_b128 v[56:59], v179
    ds_read_b128 v[60:63], v183
    v_exp_f32 v98, v98
    v_exp_f32 v99, v99
    v_exp_f32 v100, v100
    v_exp_f32 v101, v101
    v_exp_f32 v102, v102
    v_exp_f32 v103, v103
    v_cvt_pk_bf16_f32 v108, v96, v97
    v_cvt_pk_bf16_f32 v109, v98, v99
    v_cvt_pk_bf16_f32 v110, v100, v101
    v_cvt_pk_bf16_f32 v111, v102, v103
    s_nop 1
    v_mfma_f32_32x32x16_bf16 v[112:127], v[68:71], v[108:111], v[112:127]
    v_exp_f32 v72, v72
    v_exp_f32 v73, v73
    v_exp_f32 v74, v74
    v_exp_f32 v75, v75
    s_waitcnt lgkmcnt(0)
    v_mfma_f32_32x32x16_bf16 v[88:103], v[52:55], v[44:47], v[160:175]
    ds_read_b128 v[48:51], v184 offset:1536
    v_exp_f32 v76, v76
    v_exp_f32 v77, v77
    v_exp_f32 v78, v78
    v_exp_f32 v79, v79
    v_cvt_pk_bf16_f32 v104, v72, v73
    v_cvt_pk_bf16_f32 v105, v74, v75
    v_cvt_pk_bf16_f32 v106, v76, v77
    v_cvt_pk_bf16_f32 v107, v78, v79
    v_exp_f32 v80, v80
    v_exp_f32 v81, v81
    v_mfma_f32_32x32x16_bf16 v[112:127], v[56:59], v[104:107], v[112:127]
    ds_read_b128 v[64:67], v178
    ds_read_b128 v[68:71], v182
    v_exp_f32 v82, v82
    v_exp_f32 v83, v83
    v_exp_f32 v84, v84
    v_exp_f32 v85, v85
    v_exp_f32 v86, v86
    v_exp_f32 v87, v87
    v_cvt_pk_bf16_f32 v108, v80, v81
    v_cvt_pk_bf16_f32 v109, v82, v83
    v_cvt_pk_bf16_f32 v110, v84, v85
    v_cvt_pk_bf16_f32 v111, v86, v87
    s_nop 1
    v_mfma_f32_32x32x16_bf16 v[112:127], v[60:63], v[108:111], v[112:127]
    v_exp_f32 v88, v88
    v_exp_f32 v89, v89
    v_exp_f32 v90, v90
    v_exp_f32 v91, v91
    s_waitcnt lgkmcnt(0)
    v_mfma_f32_32x32x16_bf16 v[72:87], v[48:51], v[44:47], 0
    v_exp_f32 v92, v92
    v_exp_f32 v93, v93
    v_exp_f32 v94, v94
    v_exp_f32 v95, v95
    v_cvt_pk_bf16_f32 v104, v88, v89
    v_cvt_pk_bf16_f32 v105, v90, v91
    v_cvt_pk_bf16_f32 v106, v92, v93
    v_cvt_pk_bf16_f32 v107, v94, v95
    v_exp_f32 v96, v96
    v_exp_f32 v97, v97
    v_mfma_f32_32x32x16_bf16 v[128:143], v[64:67], v[104:107], v[128:143]
    ds_read_b128 v[56:59], v179
    ds_read_b128 v[60:63], v183
    v_exp_f32 v98, v98
    v_exp_f32 v99, v99
    v_exp_f32 v100, v100
    v_exp_f32 v101, v101
    v_exp_f32 v102, v102
    v_exp_f32 v103, v103
    v_cvt_pk_bf16_f32 v108, v96, v97
    v_cvt_pk_bf16_f32 v109, v98, v99
    v_cvt_pk_bf16_f32 v110, v100, v101
    v_cvt_pk_bf16_f32 v111, v102, v103
    s_nop 1
    v_mfma_f32_32x32x16_bf16 v[128:143], v[68:71], v[108:111], v[128:143]
    v_exp_f32 v72, v72
    v_exp_f32 v73, v73
    v_exp_f32 v74, v74
    v_exp_f32 v75, v75
    s_waitcnt lgkmcnt(0)
    v_exp_f32 v76, v76
    v_exp_f32 v77, v77
    v_exp_f32 v78, v78
    v_exp_f32 v79, v79
    v_cvt_pk_bf16_f32 v104, v72, v73
    v_cvt_pk_bf16_f32 v105, v74, v75
    v_cvt_pk_bf16_f32 v106, v76, v77
    v_cvt_pk_bf16_f32 v107, v78, v79
    v_exp_f32 v80, v80
    v_exp_f32 v81, v81
    v_mfma_f32_32x32x16_bf16 v[128:143], v[56:59], v[104:107], v[128:143]
    v_exp_f32 v82, v82
    v_exp_f32 v83, v83
    v_exp_f32 v84, v84
    v_exp_f32 v85, v85
    v_exp_f32 v86, v86
    v_exp_f32 v87, v87
    v_cvt_pk_bf16_f32 v108, v80, v81
    v_cvt_pk_bf16_f32 v109, v82, v83
    v_cvt_pk_bf16_f32 v110, v84, v85
    v_cvt_pk_bf16_f32 v111, v86, v87
    s_nop 1
    v_mfma_f32_32x32x16_bf16 v[128:143], v[60:63], v[108:111], v[128:143]
VARJ_64:
    s_branch HALOE_56
NOHALO_54:
    s_mov_b32 s12, s52
    s_and_b32 s13, s53, 0xffff
    s_mov_b32 s14, 0x80000
    s_mov_b32 s15, 0x20000
    v_lshrrev_b32 v210, 3, v1
    v_lshlrev_b32 v210, 10, v210
    v_and_b32 v211, 7, v1
    v_bfe_u32 v212, v1, 4, 1
    v_lshlrev_b32 v212, 1, v212
    v_xor_b32 v211, v211, v212
    v_lshl_add_u32 v210, v211, 4, v210
    v_xor_b32 v211, 64, v210
    s_and_b32 s25, s21, 7
    s_lshl_b32 s25, s25, 7
    s_lshl_b32 s26, s22, 17
    s_add_u32 s25, s25, s26
    s_lshl_b32 s27, s22, 14
    s_add_u32 s27, s27, 65536
    s_add_u32 m0, s27, 0
    s_add_u32 s26, s25, 0
    buffer_load_dwordx4 v210, s[12:15], s26 offen lds
    s_add_u32 m0, s27, 1024
    s_add_u32 s26, s25, 8192
    buffer_load_dwordx4 v211, s[12:15], s26 offen lds
    s_add_u32 m0, s27, 2048
    s_add_u32 s26, s25, 16384
    buffer_load_dwordx4 v210, s[12:15], s26 offen lds
    s_add_u32 m0, s27, 3072
    s_add_u32 s26, s25, 24576
    buffer_load_dwordx4 v211, s[12:15], s26 offen lds
    s_add_u32 m0, s27, 4096
    s_add_u32 s26, s25, 32768
    buffer_load_dwordx4 v210, s[12:15], s26 offen lds
    s_add_u32 m0, s27, 5120
    s_add_u32 s26, s25, 40960
    buffer_load_dwordx4 v211, s[12:15], s26 offen lds
    s_add_u32 m0, s27, 6144
    s_add_u32 s26, s25, 49152
    buffer_load_dwordx4 v210, s[12:15], s26 offen lds
    s_add_u32 m0, s27, 7168
    s_add_u32 s26, s25, 57344
    buffer_load_dwordx4 v211, s[12:15], s26 offen lds
    s_add_u32 m0, s27, 8192
    s_add_u32 s26, s25, 65536
    buffer_load_dwordx4 v210, s[12:15], s26 offen lds
    s_add_u32 m0, s27, 9216
    s_add_u32 s26, s25, 73728
    buffer_load_dwordx4 v211, s[12:15], s26 offen lds
    s_add_u32 m0, s27, 10240
    s_add_u32 s26, s25, 81920
    buffer_load_dwordx4 v210, s[12:15], s26 offen lds
    s_add_u32 m0, s27, 11264
    s_add_u32 s26, s25, 90112
    buffer_load_dwordx4 v211, s[12:15], s26 offen lds
    s_add_u32 m0, s27, 12288
    s_add_u32 s26, s25, 98304
    buffer_load_dwordx4 v210, s[12:15], s26 offen lds
    s_add_u32 m0, s27, 13312
    s_add_u32 s26, s25, 106496
    buffer_load_dwordx4 v211, s[12:15], s26 offen lds
    s_add_u32 m0, s27, 14336
    s_add_u32 s26, s25, 114688
    buffer_load_dwordx4 v210, s[12:15], s26 offen lds
    s_add_u32 m0, s27, 15360
    s_add_u32 s26, s25, 122880
    buffer_load_dwordx4 v211, s[12:15], s26 offen lds
HALOE_56:
    s_mov_b32 s25, 0x21800000
    s_mov_b32 s26, 0x5d800000
    v_cmp_nle_f32 vcc, s25, v120
    v_cmp_nge_f32 s[28:29], s26, v120
    s_nop 1
    s_or_b64 vcc, vcc, s[28:29]
    s_cmp_eq_u64 vcc, 0
    s_cbranch_scc1 SMOK_65
    v_and_b32 v210, 31, v1
    v_lshrrev_b32 v206, 5, v1
    v_lshlrev_b32 v206, 2, v206
    v_sub_u32 v210, v210, v206
    v_mov_b32 v206, 0xf149f2ca
    v_mov_b32 v207, 0
    v_cmp_le_i32 s[28:29], 0, v210
    v_cmp_le_i32 s[30:31], 1, v210
    s_nop 0
    v_cndmask_b32 v144, v206, v207, s[28:29]
    v_cndmask_b32 v160, v207, v206, s[28:29]
    v_cndmask_b32 v145, v206, v207, s[30:31]
    v_cndmask_b32 v161, v207, v206, s[30:31]
    v_cmp_le_i32 s[28:29], 2, v210
    v_cmp_le_i32 s[30:31], 3, v210
    s_nop 0
    v_cndmask_b32 v146, v206, v207, s[28:29]
    v_cndmask_b32 v162, v207, v206, s[28:29]
    v_cndmask_b32 v147, v206, v207, s[30:31]
    v_cndmask_b32 v163, v207, v206, s[30:31]
    v_cmp_le_i32 s[28:29], 8, v210
    v_cmp_le_i32 s[30:31], 9, v210
    s_nop 0
    v_cndmask_b32 v148, v206, v207, s[28:29]
    v_cndmask_b32 v164, v207, v206, s[28:29]
    v_cndmask_b32 v149, v206, v207, s[30:31]
    v_cndmask_b32 v165, v207, v206, s[30:31]
    v_cmp_le_i32 s[28:29], 10, v210
    v_cmp_le_i32 s[30:31], 11, v210
    s_nop 0
    v_cndmask_b32 v150, v206, v207, s[28:29]
    v_cndmask_b32 v166, v207, v206, s[28:29]
    v_cndmask_b32 v151, v206, v207, s[30:31]
    v_cndmask_b32 v167, v207, v206, s[30:31]
    v_cmp_le_i32 s[28:29], 16, v210
    v_cmp_le_i32 s[30:31], 17, v210
    s_nop 0
    v_cndmask_b32 v152, v206, v207, s[28:29]
    v_cndmask_b32 v168, v207, v206, s[28:29]
    v_cndmask_b32 v153, v206, v207, s[30:31]
    v_cndmask_b32 v169, v207, v206, s[30:31]
    v_cmp_le_i32 s[28:29], 18, v210
    v_cmp_le_i32 s[30:31], 19, v210
    s_nop 0
    v_cndmask_b32 v154, v206, v207, s[28:29]
    v_cndmask_b32 v170, v207, v206, s[28:29]
    v_cndmask_b32 v155, v206, v207, s[30:31]
    v_cndmask_b32 v171, v207, v206, s[30:31]
    v_cmp_le_i32 s[28:29], 24, v210
    v_cmp_le_i32 s[30:31], 25, v210
    s_nop 0
    v_cndmask_b32 v156, v206, v207, s[28:29]
    v_cndmask_b32 v172, v207, v206, s[28:29]
    v_cndmask_b32 v157, v206, v207, s[30:31]
    v_cndmask_b32 v173, v207, v206, s[30:31]
    v_cmp_le_i32 s[28:29], 26, v210
    v_cmp_le_i32 s[30:31], 27, v210
    s_nop 0
    v_cndmask_b32 v158, v206, v207, s[28:29]
    v_cndmask_b32 v174, v207, v206, s[28:29]
    v_cndmask_b32 v159, v206, v207, s[30:31]
    v_cndmask_b32 v175, v207, v206, s[30:31]
    s_mov_b32 s28, s35
    v_mov_b32 v211, 0xf149f2ca
    s_mov_b32 s30, 0
SLA_66:
    s_cmp_le_u32 s30, s28
    s_cbranch_scc1 SLO_68
    s_sub_u32 s31, s30, 1
    s_cmp_lt_u32 s31, 4
    s_cbranch_scc0 SLB_69
    s_cmp_lt_u32 s36, 2
    s_cbranch_scc1 SLK_67
    s_mov_b32 s29, 0
    s_mov_b32 s27, s31
    s_cmp_eq_u32 s31, s28
    s_cselect_b32 s33, 2, 0
    s_mov_b32 s43, 155904
    s_branch SLG_70
SLB_69:
    s_cmp_lt_u32 s36, 1
    s_cbranch_scc1 SLK_67
    s_mov_b32 s29, 16384
    s_sub_u32 s27, s31, 4
    s_mov_b32 s33, 0
    s_mov_b32 s43, 156160
    s_branch SLG_70
SLO_68:
    s_mov_b32 s29, 139264
    s_mov_b32 s27, s30
    s_cmp_eq_u32 s30, s28
    s_cselect_b32 s33, 1, 0
    s_mov_b32 s43, 155648
SLG_70:
    s_lshl_b32 s25, s34, 13
    s_add_u32 s29, s29, s25
    s_lshl_b32 s25, s27, 9
    s_add_u32 s25, s25, s29
    v_add_u32 v210, s25, v204
    ds_read_b128 v[48:51], v210
    s_cmp_eq_u32 s33, 0
    s_cbranch_scc1 SLZ_72
    s_cmp_eq_u32 s33, 1
    s_cbranch_scc0 SLM_71
    v_mov_b32 v88, v144
    v_mov_b32 v89, v145
    v_mov_b32 v90, v146
    v_mov_b32 v91, v147
    v_mov_b32 v92, v148
    v_mov_b32 v93, v149
    v_mov_b32 v94, v150
    v_mov_b32 v95, v151
    v_mov_b32 v96, v152
    v_mov_b32 v97, v153
    v_mov_b32 v98, v154
    v_mov_b32 v99, v155
    v_mov_b32 v100, v156
    v_mov_b32 v101, v157
    v_mov_b32 v102, v158
    v_mov_b32 v103, v159
    s_branch SLD_73
SLM_71:
    v_mov_b32 v88, v160
    v_mov_b32 v89, v161
    v_mov_b32 v90, v162
    v_mov_b32 v91, v163
    v_mov_b32 v92, v164
    v_mov_b32 v93, v165
    v_mov_b32 v94, v166
    v_mov_b32 v95, v167
    v_mov_b32 v96, v168
    v_mov_b32 v97, v169
    v_mov_b32 v98, v170
    v_mov_b32 v99, v171
    v_mov_b32 v100, v172
    v_mov_b32 v101, v173
    v_mov_b32 v102, v174
    v_mov_b32 v103, v175
    s_branch SLD_73
SLZ_72:
    v_mov_b32 v88, 0
    v_mov_b32 v89, 0
    v_mov_b32 v90, 0
    v_mov_b32 v91, 0
    v_mov_b32 v92, 0
    v_mov_b32 v93, 0
    v_mov_b32 v94, 0
    v_mov_b32 v95, 0
    v_mov_b32 v96, 0
    v_mov_b32 v97, 0
    v_mov_b32 v98, 0
    v_mov_b32 v99, 0
    v_mov_b32 v100, 0
    v_mov_b32 v101, 0
    v_mov_b32 v102, 0
    v_mov_b32 v103, 0
SLD_73:
    s_waitcnt lgkmcnt(0)
    s_nop 0
    v_mfma_f32_32x32x16_bf16 v[72:87], v[48:51], v[40:43], v[88:103]
    s_nop 15
    v_max3_f32 v211, v211, v72, v73
    v_max3_f32 v211, v211, v74, v75
    v_max3_f32 v211, v211, v76, v77
    v_max3_f32 v211, v211, v78, v79
    v_max3_f32 v211, v211, v80, v81
    v_max3_f32 v211, v211, v82, v83
    v_max3_f32 v211, v211, v84, v85
    v_max3_f32 v211, v211, v86, v87
SLK_67:
    s_add_u32 s30, s30, 1
    s_cmp_lt_u32 s30, 9
    s_cbranch_scc1 SLA_66
    v_mov_b32 v210, v211
    s_nop 1
    v_permlane32_swap_b32 v211, v210
    v_max_f32 v211, v211, v210
    v_mov_b32 v112, 0
    v_mov_b32 v113, 0
    v_mov_b32 v114, 0
    v_mov_b32 v115, 0
    v_mov_b32 v116, 0
    v_mov_b32 v117, 0
    v_mov_b32 v118, 0
    v_mov_b32 v119, 0
    v_mov_b32 v120, 0
    v_mov_b32 v121, 0
    v_mov_b32 v122, 0
    v_mov_b32 v123, 0
    v_mov_b32 v124, 0
    v_mov_b32 v125, 0
    v_mov_b32 v126, 0
    v_mov_b32 v127, 0
    v_and_b32 v210, 31, v1
    v_cmp_gt_u32 s[70:71], 16, v210
    s_mov_b32 s30, 0
SLB_74:
    s_cmp_le_u32 s30, s28
    s_cbranch_scc1 SLO_76
    s_sub_u32 s31, s30, 1
    s_cmp_lt_u32 s31, 4
    s_cbranch_scc0 SLB_77
    s_cmp_lt_u32 s36, 2
    s_cbranch_scc1 SLK_75
    s_mov_b32 s29, 0
    s_mov_b32 s27, s31
    s_cmp_eq_u32 s31, s28
    s_cselect_b32 s33, 2, 0
    s_mov_b32 s43, 155904
    s_branch SLG_78
SLB_77:
    s_cmp_lt_u32 s36, 1
    s_cbranch_scc1 SLK_75
    s_mov_b32 s29, 16384
    s_sub_u32 s27, s31, 4
    s_mov_b32 s33, 0
    s_mov_b32 s43, 156160
    s_branch SLG_78
SLO_76:
    s_mov_b32 s29, 139264
    s_mov_b32 s27, s30
    s_cmp_eq_u32 s30, s28
    s_cselect_b32 s33, 1, 0
    s_mov_b32 s43, 155648
SLG_78:
    s_lshl_b32 s25, s34, 13
    s_add_u32 s29, s29, s25
    s_lshl_b32 s25, s27, 9
    s_add_u32 s25, s25, s29
    v_add_u32 v210, s25, v204
    ds_read_b128 v[48:51], v210
    s_cmp_eq_u32 s33, 0
    s_cbranch_scc1 SLZ_80
    s_cmp_eq_u32 s33, 1
    s_cbranch_scc0 SLM_79
    v_mov_b32 v88, v144
    v_mov_b32 v89, v145
    v_mov_b32 v90, v146
    v_mov_b32 v91, v147
    v_mov_b32 v92, v148
    v_mov_b32 v93, v149
    v_mov_b32 v94, v150
    v_mov_b32 v95, v151
    v_mov_b32 v96, v152
    v_mov_b32 v97, v153
    v_mov_b32 v98, v154
    v_mov_b32 v99, v155
    v_mov_b32 v100, v156
    v_mov_b32 v101, v157
    v_mov_b32 v102, v158
    v_mov_b32 v103, v159
    s_branch SLD_81
SLM_79:
    v_mov_b32 v88, v160
    v_mov_b32 v89, v161
    v_mov_b32 v90, v162
    v_mov_b32 v91, v163
    v_mov_b32 v92, v164
    v_mov_b32 v93, v165
    v_mov_b32 v94, v166
    v_mov_b32 v95, v167
    v_mov_b32 v96, v168
    v_mov_b32 v97, v169
    v_mov_b32 v98, v170
    v_mov_b32 v99, v171
    v_mov_b32 v100, v172
    v_mov_b32 v101, v173
    v_mov_b32 v102, v174
    v_mov_b32 v103, v175
    s_branch SLD_81
SLZ_80:
    v_mov_b32 v88, 0
    v_mov_b32 v89, 0
    v_mov_b32 v90, 0
    v_mov_b32 v91, 0
    v_mov_b32 v92, 0
    v_mov_b32 v93, 0
    v_mov_b32 v94, 0
    v_mov_b32 v95, 0
    v_mov_b32 v96, 0
    v_mov_b32 v97, 0
    v_mov_b32 v98, 0
    v_mov_b32 v99, 0
    v_mov_b32 v100, 0
    v_mov_b32 v101, 0
    v_mov_b32 v102, 0
    v_mov_b32 v103, 0
SLD_81:
    v_sub_f32 v88, v88, v211
    v_sub_f32 v89, v89, v211
    v_sub_f32 v90, v90, v211
    v_sub_f32 v91, v91, v211
    v_sub_f32 v92, v92, v211
    v_sub_f32 v93, v93, v211
    v_sub_f32 v94, v94, v211
    v_sub_f32 v95, v95, v211
    v_sub_f32 v96, v96, v211
    v_sub_f32 v97, v97, v211
    v_sub_f32 v98, v98, v211
    v_sub_f32 v99, v99, v211
    v_sub_f32 v100, v100, v211
    v_sub_f32 v101, v101, v211
    v_sub_f32 v102, v102, v211
    v_sub_f32 v103, v103, v211
    s_add_u32 s29, s29, 4096
    s_lshl_b32 s25, s27, 6
    v_add_u32 v210, s29, v205
    v_add_u32 v208, s43, v209
    v_cndmask_b32 v210, v208, v210, s[70:71]
    v_xor_b32 v212, 32, v210
    v_xor_b32 v210, s25, v210
    v_xor_b32 v212, s25, v212
    ds_read_b128 v[56:59], v210
    ds_read_b128 v[60:63], v212
    s_waitcnt lgkmcnt(0)
    v_mfma_f32_32x32x16_bf16 v[72:87], v[48:51], v[40:43], v[88:103]
    s_nop 15
    v_exp_f32 v72, v72
    v_exp_f32 v73, v73
    v_exp_f32 v74, v74
    v_exp_f32 v75, v75
    v_exp_f32 v76, v76
    v_exp_f32 v77, v77
    v_exp_f32 v78, v78
    v_exp_f32 v79, v79
    v_exp_f32 v80, v80
    v_exp_f32 v81, v81
    v_exp_f32 v82, v82
    v_exp_f32 v83, v83
    v_exp_f32 v84, v84
    v_exp_f32 v85, v85
    v_exp_f32 v86, v86
    v_exp_f32 v87, v87
    s_nop 0
    v_cvt_pk_bf16_f32 v104, v72, v73
    v_cvt_pk_bf16_f32 v105, v74, v75
    v_cvt_pk_bf16_f32 v106, v76, v77
    v_cvt_pk_bf16_f32 v107, v78, v79
    v_cvt_pk_bf16_f32 v108, v80, v81
    v_cvt_pk_bf16_f32 v109, v82, v83
    v_cvt_pk_bf16_f32 v110, v84, v85
    v_cvt_pk_bf16_f32 v111, v86, v87
    s_nop 1
    v_mfma_f32_32x32x16_bf16 v[112:127], v[56:59], v[104:107], v[112:127]
    v_mfma_f32_32x32x16_bf16 v[112:127], v[60:63], v[108:111], v[112:127]
SLK_75:
    s_add_u32 s30, s30, 1
    s_cmp_lt_u32 s30, 9
    s_cbranch_scc1 SLB_74
    s_nop 15
SMOK_65:
    s_mov_b32 s25, 0x21800000
    s_mov_b32 s26, 0x5d800000
    s_nop 1
    v_cmp_nle_f32 vcc, s25, v136
    v_cmp_nge_f32 s[28:29], s26, v136
    s_nop 1
    s_or_b64 vcc, vcc, s[28:29]
    s_cmp_eq_u64 vcc, 0
    s_cbranch_scc1 SMOK_82
    v_and_b32 v210, 31, v1
    v_lshrrev_b32 v206, 5, v1
    v_lshlrev_b32 v206, 2, v206
    v_sub_u32 v210, v210, v206
    v_mov_b32 v206, 0xf149f2ca
    v_mov_b32 v207, 0
    v_cmp_le_i32 s[28:29], 0, v210
    v_cmp_le_i32 s[30:31], 1, v210
    s_nop 0
    v_cndmask_b32 v144, v206, v207, s[28:29]
    v_cndmask_b32 v160, v207, v206, s[28:29]
    v_cndmask_b32 v145, v206, v207, s[30:31]
    v_cndmask_b32 v161, v207, v206, s[30:31]
    v_cmp_le_i32 s[28:29], 2, v210
    v_cmp_le_i32 s[30:31], 3, v210
    s_nop 0
    v_cndmask_b32 v146, v206, v207, s[28:29]
    v_cndmask_b32 v162, v207, v206, s[28:29]
    v_cndmask_b32 v147, v206, v207, s[30:31]
    v_cndmask_b32 v163, v207, v206, s[30:31]
    v_cmp_le_i32 s[28:29], 8, v210
    v_cmp_le_i32 s[30:31], 9, v210
    s_nop 0
    v_cndmask_b32 v148, v206, v207, s[28:29]
    v_cndmask_b32 v164, v207, v206, s[28:29]
    v_cndmask_b32 v149, v206, v207, s[30:31]
    v_cndmask_b32 v165, v207, v206, s[30:31]
    v_cmp_le_i32 s[28:29], 10, v210
    v_cmp_le_i32 s[30:31], 11, v210
    s_nop 0
    v_cndmask_b32 v150, v206, v207, s[28:29]
    v_cndmask_b32 v166, v207, v206, s[28:29]
    v_cndmask_b32 v151, v206, v207, s[30:31]
    v_cndmask_b32 v167, v207, v206, s[30:31]
    v_cmp_le_i32 s[28:29], 16, v210
    v_cmp_le_i32 s[30:31], 17, v210
    s_nop 0
    v_cndmask_b32 v152, v206, v207, s[28:29]
    v_cndmask_b32 v168, v207, v206, s[28:29]
    v_cndmask_b32 v153, v206, v207, s[30:31]
    v_cndmask_b32 v169, v207, v206, s[30:31]
    v_cmp_le_i32 s[28:29], 18, v210
    v_cmp_le_i32 s[30:31], 19, v210
    s_nop 0
    v_cndmask_b32 v154, v206, v207, s[28:29]
    v_cndmask_b32 v170, v207, v206, s[28:29]
    v_cndmask_b32 v155, v206, v207, s[30:31]
    v_cndmask_b32 v171, v207, v206, s[30:31]
    v_cmp_le_i32 s[28:29], 24, v210
    v_cmp_le_i32 s[30:31], 25, v210
    s_nop 0
    v_cndmask_b32 v156, v206, v207, s[28:29]
    v_cndmask_b32 v172, v207, v206, s[28:29]
    v_cndmask_b32 v157, v206, v207, s[30:31]
    v_cndmask_b32 v173, v207, v206, s[30:31]
    v_cmp_le_i32 s[28:29], 26, v210
    v_cmp_le_i32 s[30:31], 27, v210
    s_nop 0
    v_cndmask_b32 v158, v206, v207, s[28:29]
    v_cndmask_b32 v174, v207, v206, s[28:29]
    v_cndmask_b32 v159, v206, v207, s[30:31]
    v_cndmask_b32 v175, v207, v206, s[30:31]
    s_sub_u32 s28, 3, s35
    v_mov_b32 v211, 0xf149f2ca
    s_mov_b32 s30, 0
SLA_83:
    s_cmp_le_u32 s30, s28
    s_cbranch_scc1 SLO_85
    s_sub_u32 s31, s30, 1
    s_cmp_lt_u32 s31, 4
    s_cbranch_scc0 SLB_86
    s_cmp_lt_u32 s36, 2
    s_cbranch_scc1 SLK_84
    s_mov_b32 s29, 0
    s_mov_b32 s27, s31
    s_cmp_eq_u32 s31, s28
    s_cselect_b32 s33, 2, 0
    s_mov_b32 s43, 155904
    s_branch SLG_87
SLB_86:
    s_cmp_lt_u32 s36, 1
    s_cbranch_scc1 SLK_84
    s_mov_b32 s29, 16384
    s_sub_u32 s27, s31, 4
    s_mov_b32 s33, 0
    s_mov_b32 s43, 156160
    s_branch SLG_87
SLO_85:
    s_mov_b32 s29, 139264
    s_mov_b32 s27, s30
    s_cmp_eq_u32 s30, s28
    s_cselect_b32 s33, 1, 0
    s_mov_b32 s43, 155648
SLG_87:
    s_lshl_b32 s25, s34, 13
    s_add_u32 s29, s29, s25
    s_lshl_b32 s25, s27, 9
    s_add_u32 s25, s25, s29
    v_add_u32 v210, s25, v204
    ds_read_b128 v[48:51], v210
    s_cmp_eq_u32 s33, 0
    s_cbranch_scc1 SLZ_89
    s_cmp_eq_u32 s33, 1
    s_cbranch_scc0 SLM_88
    v_mov_b32 v88, v144
    v_mov_b32 v89, v145
    v_mov_b32 v90, v146
    v_mov_b32 v91, v147
    v_mov_b32 v92, v148
    v_mov_b32 v93, v149
    v_mov_b32 v94, v150
    v_mov_b32 v95, v151
    v_mov_b32 v96, v152
    v_mov_b32 v97, v153
    v_mov_b32 v98, v154
    v_mov_b32 v99, v155
    v_mov_b32 v100, v156
    v_mov_b32 v101, v157
    v_mov_b32 v102, v158
    v_mov_b32 v103, v159
    s_branch SLD_90
SLM_88:
    v_mov_b32 v88, v160
    v_mov_b32 v89, v161
    v_mov_b32 v90, v162
    v_mov_b32 v91, v163
    v_mov_b32 v92, v164
    v_mov_b32 v93, v165
    v_mov_b32 v94, v166
    v_mov_b32 v95, v167
    v_mov_b32 v96, v168
    v_mov_b32 v97, v169
    v_mov_b32 v98, v170
    v_mov_b32 v99, v171
    v_mov_b32 v100, v172
    v_mov_b32 v101, v173
    v_mov_b32 v102, v174
    v_mov_b32 v103, v175
    s_branch SLD_90
SLZ_89:
    v_mov_b32 v88, 0
    v_mov_b32 v89, 0
    v_mov_b32 v90, 0
    v_mov_b32 v91, 0
    v_mov_b32 v92, 0
    v_mov_b32 v93, 0
    v_mov_b32 v94, 0
    v_mov_b32 v95, 0
    v_mov_b32 v96, 0
    v_mov_b32 v97, 0
    v_mov_b32 v98, 0
    v_mov_b32 v99, 0
    v_mov_b32 v100, 0
    v_mov_b32 v101, 0
    v_mov_b32 v102, 0
    v_mov_b32 v103, 0
SLD_90:
    s_waitcnt lgkmcnt(0)
    s_nop 0
    v_mfma_f32_32x32x16_bf16 v[72:87], v[48:51], v[44:47], v[88:103]
    s_nop 15
    v_max3_f32 v211, v211, v72, v73
    v_max3_f32 v211, v211, v74, v75
    v_max3_f32 v211, v211, v76, v77
    v_max3_f32 v211, v211, v78, v79
    v_max3_f32 v211, v211, v80, v81
    v_max3_f32 v211, v211, v82, v83
    v_max3_f32 v211, v211, v84, v85
    v_max3_f32 v211, v211, v86, v87
SLK_84:
    s_add_u32 s30, s30, 1
    s_cmp_lt_u32 s30, 9
    s_cbranch_scc1 SLA_83
    v_mov_b32 v210, v211
    s_nop 1
    v_permlane32_swap_b32 v211, v210
    v_max_f32 v211, v211, v210
    v_mov_b32 v128, 0
    v_mov_b32 v129, 0
    v_mov_b32 v130, 0
    v_mov_b32 v131, 0
    v_mov_b32 v132, 0
    v_mov_b32 v133, 0
    v_mov_b32 v134, 0
    v_mov_b32 v135, 0
    v_mov_b32 v136, 0
    v_mov_b32 v137, 0
    v_mov_b32 v138, 0
    v_mov_b32 v139, 0
    v_mov_b32 v140, 0
    v_mov_b32 v141, 0
    v_mov_b32 v142, 0
    v_mov_b32 v143, 0
    v_and_b32 v210, 31, v1
    v_cmp_gt_u32 s[70:71], 16, v210
    s_mov_b32 s30, 0
SLB_91:
    s_cmp_le_u32 s30, s28
    s_cbranch_scc1 SLO_93
    s_sub_u32 s31, s30, 1
    s_cmp_lt_u32 s31, 4
    s_cbranch_scc0 SLB_94
    s_cmp_lt_u32 s36, 2
    s_cbranch_scc1 SLK_92
    s_mov_b32 s29, 0
    s_mov_b32 s27, s31
    s_cmp_eq_u32 s31, s28
    s_cselect_b32 s33, 2, 0
    s_mov_b32 s43, 155904
    s_branch SLG_95
SLB_94:
    s_cmp_lt_u32 s36, 1
    s_cbranch_scc1 SLK_92
    s_mov_b32 s29, 16384
    s_sub_u32 s27, s31, 4
    s_mov_b32 s33, 0
    s_mov_b32 s43, 156160
    s_branch SLG_95
SLO_93:
    s_mov_b32 s29, 139264
    s_mov_b32 s27, s30
    s_cmp_eq_u32 s30, s28
    s_cselect_b32 s33, 1, 0
    s_mov_b32 s43, 155648
SLG_95:
    s_lshl_b32 s25, s34, 13
    s_add_u32 s29, s29, s25
    s_lshl_b32 s25, s27, 9
    s_add_u32 s25, s25, s29
    v_add_u32 v210, s25, v204
    ds_read_b128 v[48:51], v210
    s_cmp_eq_u32 s33, 0
    s_cbranch_scc1 SLZ_97
    s_cmp_eq_u32 s33, 1
    s_cbranch_scc0 SLM_96
    v_mov_b32 v88, v144
    v_mov_b32 v89, v145
    v_mov_b32 v90, v146
    v_mov_b32 v91, v147
    v_mov_b32 v92, v148
    v_mov_b32 v93, v149
    v_mov_b32 v94, v150
    v_mov_b32 v95, v151
    v_mov_b32 v96, v152
    v_mov_b32 v97, v153
    v_mov_b32 v98, v154
    v_mov_b32 v99, v155
    v_mov_b32 v100, v156
    v_mov_b32 v101, v157
    v_mov_b32 v102, v158
    v_mov_b32 v103, v159
    s_branch SLD_98
SLM_96:
    v_mov_b32 v88, v160
    v_mov_b32 v89, v161
    v_mov_b32 v90, v162
    v_mov_b32 v91, v163
    v_mov_b32 v92, v164
    v_mov_b32 v93, v165
    v_mov_b32 v94, v166
    v_mov_b32 v95, v167
    v_mov_b32 v96, v168
    v_mov_b32 v97, v169
    v_mov_b32 v98, v170
    v_mov_b32 v99, v171
    v_mov_b32 v100, v172
    v_mov_b32 v101, v173
    v_mov_b32 v102, v174
    v_mov_b32 v103, v175
    s_branch SLD_98
SLZ_97:
    v_mov_b32 v88, 0
    v_mov_b32 v89, 0
    v_mov_b32 v90, 0
    v_mov_b32 v91, 0
    v_mov_b32 v92, 0
    v_mov_b32 v93, 0
    v_mov_b32 v94, 0
    v_mov_b32 v95, 0
    v_mov_b32 v96, 0
    v_mov_b32 v97, 0
    v_mov_b32 v98, 0
    v_mov_b32 v99, 0
    v_mov_b32 v100, 0
    v_mov_b32 v101, 0
    v_mov_b32 v102, 0
    v_mov_b32 v103, 0
SLD_98:
    v_sub_f32 v88, v88, v211
    v_sub_f32 v89, v89, v211
    v_sub_f32 v90, v90, v211
    v_sub_f32 v91, v91, v211
    v_sub_f32 v92, v92, v211
    v_sub_f32 v93, v93, v211
    v_sub_f32 v94, v94, v211
    v_sub_f32 v95, v95, v211
    v_sub_f32 v96, v96, v211
    v_sub_f32 v97, v97, v211
    v_sub_f32 v98, v98, v211
    v_sub_f32 v99, v99, v211
    v_sub_f32 v100, v100, v211
    v_sub_f32 v101, v101, v211
    v_sub_f32 v102, v102, v211
    v_sub_f32 v103, v103, v211
    s_add_u32 s29, s29, 4096
    s_lshl_b32 s25, s27, 6
    v_add_u32 v210, s29, v205
    v_add_u32 v208, s43, v209
    v_cndmask_b32 v210, v208, v210, s[70:71]
    v_xor_b32 v212, 32, v210
    v_xor_b32 v210, s25, v210
    v_xor_b32 v212, s25, v212
    ds_read_b128 v[56:59], v210
    ds_read_b128 v[60:63], v212
    s_waitcnt lgkmcnt(0)
    v_mfma_f32_32x32x16_bf16 v[72:87], v[48:51], v[44:47], v[88:103]
    s_nop 15
    v_exp_f32 v72, v72
    v_exp_f32 v73, v73
    v_exp_f32 v74, v74
    v_exp_f32 v75, v75
    v_exp_f32 v76, v76
    v_exp_f32 v77, v77
    v_exp_f32 v78, v78
    v_exp_f32 v79, v79
    v_exp_f32 v80, v80
    v_exp_f32 v81, v81
    v_exp_f32 v82, v82
    v_exp_f32 v83, v83
    v_exp_f32 v84, v84
    v_exp_f32 v85, v85
    v_exp_f32 v86, v86
    v_exp_f32 v87, v87
    s_nop 0
    v_cvt_pk_bf16_f32 v104, v72, v73
    v_cvt_pk_bf16_f32 v105, v74, v75
    v_cvt_pk_bf16_f32 v106, v76, v77
    v_cvt_pk_bf16_f32 v107, v78, v79
    v_cvt_pk_bf16_f32 v108, v80, v81
    v_cvt_pk_bf16_f32 v109, v82, v83
    v_cvt_pk_bf16_f32 v110, v84, v85
    v_cvt_pk_bf16_f32 v111, v86, v87
    s_nop 1
    v_mfma_f32_32x32x16_bf16 v[128:143], v[56:59], v[104:107], v[128:143]
    v_mfma_f32_32x32x16_bf16 v[128:143], v[60:63], v[108:111], v[128:143]
SLK_92:
    s_add_u32 s30, s30, 1
    s_cmp_lt_u32 s30, 9
    s_cbranch_scc1 SLB_91
    s_nop 15
SMOK_82:
    s_lshl_b32 s25, s36, 5
    s_lshl_b32 s26, s45, 1
    s_add_u32 s25, s25, s26
    s_add_u32 s25, s25, s34
    s_lshl_b32 s25, s25, 12
    s_lshl_b32 s26, s24, 21
    s_add_u32 s25, s25, s26
    s_add_u32 s25, s25, 0x900000
    s_lshl_b32 s26, s35, 10
    s_add_u32 s27, s25, s26
    s_sub_u32 s28, s25, s26
    s_add_u32 s28, s28, 3072
    v_and_b32 v186, 31, v1
    v_lshrrev_b32 v187, 5, v1
    v_lshlrev_b32 v186, 5, v186
    v_lshl_add_u32 v186, v187, 4, v186
    v_rcp_f32 v187, v120
    s_nop 0
    v_mul_f32 v112, v187, v112
    v_mul_f32 v113, v187, v113
    v_mul_f32 v114, v187, v114
    v_mul_f32 v115, v187, v115
    v_mul_f32 v116, v187, v116
    v_mul_f32 v117, v187, v117
    v_mul_f32 v118, v187, v118
    v_mul_f32 v119, v187, v119
    v_cvt_pk_bf16_f32 v188, v112, v113
    v_cvt_pk_bf16_f32 v189, v114, v115
    v_cvt_pk_bf16_f32 v190, v116, v117
    v_cvt_pk_bf16_f32 v191, v118, v119
    s_nop 0
    v_permlane32_swap_b32 v188, v190
    v_permlane32_swap_b32 v189, v191
    buffer_store_dwordx4 v[188:191], v186, s[8:11], s27 offen sc1
    v_rcp_f32 v187, v136
    s_nop 0
    v_mul_f32 v128, v187, v128
    v_mul_f32 v129, v187, v129
    v_mul_f32 v130, v187, v130
    v_mul_f32 v131, v187, v131
    v_mul_f32 v132, v187, v132
    v_mul_f32 v133, v187, v133
    v_mul_f32 v134, v187, v134
    v_mul_f32 v135, v187, v135
    v_cvt_pk_bf16_f32 v192, v128, v129
    v_cvt_pk_bf16_f32 v193, v130, v131
    v_cvt_pk_bf16_f32 v194, v132, v133
    v_cvt_pk_bf16_f32 v195, v134, v135
    s_nop 0
    v_permlane32_swap_b32 v192, v194
    v_permlane32_swap_b32 v193, v195
    buffer_store_dwordx4 v[192:195], v186, s[8:11], s28 offen sc1
    s_waitcnt vmcnt(0)
    s_lshl_b32 s25, s2, 7
    s_lshl_b32 s26, s22, 2
    s_add_u32 s25, s25, s26
    s_lshl_b32 s26, s24, 15
    s_add_u32 s25, s25, s26
    s_add_u32 s25, s25, 0x11000
    v_mov_b32 v220, s23
    s_mov_b64 exec, 1
    buffer_store_dword v220, off, s[8:11], s25 sc1
    s_mov_b64 exec, -1
    s_barrier
    v_lshlrev_b32 v205, 7, v6
    v_add_u32 v205, v205, v9
    v_bfe_u32 v206, v13, 3, 1
    v_and_b32 v207, 1, v25
    v_lshl_or_b32 v206, v207, 1, v206
    v_xor_b32 v206, s22, v206
    v_lshl_add_u32 v205, v206, 5, v205
    v_add_u32 v205, 65536, v205
    ds_read_b64_tr_b16 v[40:41], v205 offset:0
    ds_read_b64_tr_b16 v[42:43], v205 offset:512
    ds_read_b64_tr_b16 v[44:45], v205 offset:4096
    ds_read_b64_tr_b16 v[46:47], v205 offset:4608
    ds_read_b64_tr_b16 v[48:49], v205 offset:8192
    ds_read_b64_tr_b16 v[50:51], v205 offset:8704
    ds_read_b64_tr_b16 v[52:53], v205 offset:12288
    ds_read_b64_tr_b16 v[54:55], v205 offset:12800
    ds_read_b64_tr_b16 v[56:57], v205 offset:16384
    ds_read_b64_tr_b16 v[58:59], v205 offset:16896
    ds_read_b64_tr_b16 v[60:61], v205 offset:20480
    ds_read_b64_tr_b16 v[62:63], v205 offset:20992
    ds_read_b64_tr_b16 v[64:65], v205 offset:24576
    ds_read_b64_tr_b16 v[66:67], v205 offset:25088
    ds_read_b64_tr_b16 v[68:69], v205 offset:28672
    ds_read_b64_tr_b16 v[70:71], v205 offset:29184
    ds_read_b64_tr_b16 v[72:73], v205 offset:32768
    ds_read_b64_tr_b16 v[74:75], v205 offset:33280
    ds_read_b64_tr_b16 v[76:77], v205 offset:36864
    ds_read_b64_tr_b16 v[78:79], v205 offset:37376
    ds_read_b64_tr_b16 v[80:81], v205 offset:40960
    ds_read_b64_tr_b16 v[82:83], v205 offset:41472
    ds_read_b64_tr_b16 v[84:85], v205 offset:45056
    ds_read_b64_tr_b16 v[86:87], v205 offset:45568
    ds_read_b64_tr_b16 v[88:89], v205 offset:49152
    ds_read_b64_tr_b16 v[90:91], v205 offset:49664
    ds_read_b64_tr_b16 v[92:93], v205 offset:53248
    ds_read_b64_tr_b16 v[94:95], v205 offset:53760
    ds_read_b64_tr_b16 v[96:97], v205 offset:57344
    ds_read_b64_tr_b16 v[98:99], v205 offset:57856
    ds_read_b64_tr_b16 v[100:101], v205 offset:61440
    ds_read_b64_tr_b16 v[102:103], v205 offset:61952
    s_cmp_lg_u32 s24, 0
    s_cbranch_scc1 OPL0_99
    s_lshl_b32 s25, s20, 8
    s_lshr_b32 s26, s21, 3
    s_lshl_b32 s26, s26, 6
    s_add_u32 s25, s25, s26
    s_lshl_b32 s25, s25, 10
    s_and_b32 s26, s21, 7
    s_lshl_b32 s26, s26, 7
    s_lshl_b32 s27, s22, 5
    s_add_u32 s26, s26, s27
    s_add_u32 s25, s25, s26
    v_lshlrev_b32 v186, 3, v25
    v_lshl_add_u32 v187, v13, 10, v186
    s_add_u32 s27, s25, 0
    buffer_load_dwordx2 v[26:27], v187, s[4:7], s27 offen
    s_add_u32 s27, s25, 16384
    buffer_load_dwordx2 v[28:29], v187, s[4:7], s27 offen
    s_add_u32 s27, s25, 32768
    buffer_load_dwordx2 v[30:31], v187, s[4:7], s27 offen
    s_add_u32 s27, s25, 49152
    buffer_load_dwordx2 v[32:33], v187, s[4:7], s27 offen
    s_mov_b32 s12, s56
    s_and_b32 s13, s57, 0xffff
    s_mov_b32 s14, 0x400
    s_mov_b32 s15, 0x20000
    buffer_load_dwordx2 v[188:189], v186, s[12:15], s26 offen
    buffer_load_dwordx4 v[192:195], v7, s[12:15], 0 offen
    s_waitcnt vmcnt(0)
    v_lshlrev_b32 v34, 16, v188
    v_and_b32 v35, 0xffff0000, v188
    v_lshlrev_b32 v36, 16, v189
    v_and_b32 v37, 0xffff0000, v189
    v_lshlrev_b32 v196, 16, v192
    v_and_b32 v197, 0xffff0000, v192
    v_lshlrev_b32 v198, 16, v193
    v_and_b32 v199, 0xffff0000, v193
    v_lshlrev_b32 v200, 16, v194
    v_and_b32 v201, 0xffff0000, v194
    v_lshlrev_b32 v202, 16, v195
    v_and_b32 v203, 0xffff0000, v195
    v_add_f32 v196, v196, v197
    v_add_f32 v196, v196, v198
    v_add_f32 v196, v196, v199
    v_add_f32 v196, v196, v200
    v_add_f32 v196, v196, v201
    v_add_f32 v196, v196, v202
    v_add_f32 v196, v196, v203
    s_nop 1
    v_add_f32_dpp v196, v196, v196 quad_perm:[1,0,3,2] row_mask:0xf bank_mask:0xf
    s_nop 1
    v_add_f32_dpp v196, v196, v196 quad_perm:[2,3,0,1] row_mask:0xf bank_mask:0xf
    s_nop 1
    v_add_f32_dpp v196, v196, v196 row_half_mirror row_mask:0xf bank_mask:0xf
    s_nop 1
    v_add_f32_dpp v196, v196, v196 row_mirror row_mask:0xf bank_mask:0xf
    v_mov_b32 v197, v196
    s_nop 1
    v_permlane16_swap_b32 v196, v197
    v_add_f32 v196, v196, v197
    v_mov_b32 v197, v196
    s_nop 1
    v_permlane32_swap_b32 v196, v197
    v_add_f32 v196, v196, v197
    s_nop 0
    v_readfirstlane_b32 s44, v196
OPL0_99:
    s_waitcnt lgkmcnt(0)
    s_barrier
    s_cmp_eq_u32 s24, 0
    s_cbranch_scc1 OPY_100
    s_lshr_b32 s25, s41, 8
    s_cmp_lg_u32 s25, s20
    s_cbranch_scc1 OPY_100
    s_lshr_b32 s25, s41, 6
    s_and_b32 s25, s25, 3
    s_lshr_b32 s26, s21, 3
    s_cmp_lg_u32 s25, s26
    s_cbranch_scc1 OPY_100
    s_mov_b32 s27, 0x31000
    v_min_u32 v206, 55, v1
    v_add_u32 v206, 8, v206
    v_lshlrev_b32 v206, 7, v206
    s_mov_b32 s76, 0
POLL_101:
    buffer_load_dwordx4 v[212:215], v206, s[8:11], s27 offen sc1
    s_waitcnt vmcnt(0)
    v_xor_b32 v219, s23, v212
    v_xor_b32 v218, s23, v213
    v_or_b32 v219, v219, v218
    v_xor_b32 v218, s23, v214
    v_or_b32 v219, v219, v218
    v_xor_b32 v218, s23, v215
    v_or_b32 v219, v219, v218
    v_cmp_ne_u32 vcc, 0, v219
    s_nop 1
    s_cmp_eq_u64 vcc, 0
    s_cbranch_scc1 POLD_102
    s_sleep 4
    s_add_u32 s76, s76, 1
    s_cmp_lt_u32 s76, 0x40000
    s_cbranch_scc1 POLL_101
    s_mov_b32 s12, s66
    s_and_b32 s13, s67, 0xffff
    s_mov_b32 s14, 0x100
    s_mov_b32 s15, 0x20000
    v_mov_b32 v221, 4
    buffer_store_dword v221, off, s[12:15], 0
    s_waitcnt vmcnt(0)
POLD_102:
    s_and_b32 s25, s21, 7
    s_lshl_b32 s25, s25, 8
    s_lshl_b32 s26, s22, 6
    s_add_u32 s25, s25, s26
    s_add_u32 s25, s25, 0xe2000
    v_lshlrev_b32 v186, 4, v25
    s_add_u32 s26, s25, 0
    buffer_load_dwordx4 v[196:199], v186, s[8:11], s26 offen sc1
    s_add_u32 s26, s25, 2048
    buffer_load_dwordx4 v[200:203], v186, s[8:11], s26 offen sc1
    s_waitcnt vmcnt(0)
    v_add_f32 v196, v196, v200
    v_add_f32 v197, v197, v201
    v_add_f32 v198, v198, v202
    v_add_f32 v199, v199, v203
    v_mov_b32 v38, v196
    v_mov_b32 v39, v197
    v_mov_b32 v23, v198
    v_mov_b32 v24, v199
OPY_100:
    s_lshr_b32 s25, s21, 3
    s_lshr_b32 s26, s25, 1
    s_lshl_b32 s26, s26, 10
    s_lshl_b32 s27, s20, 7
    s_add_u32 s27, s27, s26
    s_lshl_b32 s26, s24, 15
    s_add_u32 s27, s27, s26
    s_add_u32 s27, s27, 0x11000
    v_and_b32 v186, 3, v1
    v_lshlrev_b32 v186, 2, v186
    v_lshrrev_b32 v187, 2, v1
    v_lshl_add_u32 v186, v187, 11, v186
    s_cmp_lg_u32 s22, 0
    s_cbranch_scc1 PLD_104
    s_mov_b32 s76, 0
POLL_105:
    buffer_load_dword v216, v186, s[8:11], s27 offen sc1
    s_waitcnt vmcnt(0)
    v_xor_b32 v219, s23, v216
    v_cmp_ne_u32 vcc, 0, v219
    s_nop 1
    s_cmp_eq_u64 vcc, 0
    s_cbranch_scc1 POLD_106
    s_sleep 4
    s_add_u32 s76, s76, 1
    s_cmp_lt_u32 s76, 0x40000
    s_cbranch_scc1 POLL_105
    s_mov_b32 s12, s66
    s_and_b32 s13, s67, 0xffff
    s_mov_b32 s14, 0x100
    s_mov_b32 s15, 0x20000
    v_mov_b32 v221, 3
    buffer_store_dword v221, off, s[12:15], 0
    s_waitcnt vmcnt(0)
POLD_106:
PLD_104:
    s_barrier
    s_lshl_b32 s26, s20, 1
    s_lshr_b32 s27, s25, 1
    s_add_u32 s26, s26, s27
    s_lshl_b32 s26, s26, 17
    s_lshl_b32 s27, s24, 21
    s_add_u32 s26, s26, s27
    s_and_b32 s27, s25, 1
    s_lshl_b32 s27, s27, 11
    s_add_u32 s26, s26, s27
    s_lshl_b32 s28, s35, 12
    s_add_u32 s26, s26, s28
    s_lshl_b32 s28, s34, 10
    s_add_u32 s26, s26, s28
    s_add_u32 s26, s26, 0x900000
    s_lshl_b32 s27, s35, 11
    s_add_u32 s27, s27, s28
    s_add_u32 m0, s27, 0
    s_add_u32 s28, s26, 0
    buffer_load_dwordx4 v7, s[8:11], s28 offen sc1 lds
    s_add_u32 m0, s27, 4096
    s_add_u32 s28, s26, 8192
    buffer_load_dwordx4 v7, s[8:11], s28 offen sc1 lds
    s_add_u32 m0, s27, 8192
    s_add_u32 s28, s26, 16384
    buffer_load_dwordx4 v7, s[8:11], s28 offen sc1 lds
    s_add_u32 m0, s27, 12288
    s_add_u32 s28, s26, 24576
    buffer_load_dwordx4 v7, s[8:11], s28 offen sc1 lds
    s_add_u32 m0, s27, 16384
    s_add_u32 s28, s26, 32768
    buffer_load_dwordx4 v7, s[8:11], s28 offen sc1 lds
    s_add_u32 m0, s27, 20480
    s_add_u32 s28, s26, 40960
    buffer_load_dwordx4 v7, s[8:11], s28 offen sc1 lds
    s_add_u32 m0, s27, 24576
    s_add_u32 s28, s26, 49152
    buffer_load_dwordx4 v7, s[8:11], s28 offen sc1 lds
    s_add_u32 m0, s27, 28672
    s_add_u32 s28, s26, 57344
    buffer_load_dwordx4 v7, s[8:11], s28 offen sc1 lds
    s_add_u32 m0, s27, 32768
    s_add_u32 s28, s26, 65536
    buffer_load_dwordx4 v7, s[8:11], s28 offen sc1 lds
    s_add_u32 m0, s27, 36864
    s_add_u32 s28, s26, 73728
    buffer_load_dwordx4 v7, s[8:11], s28 offen sc1 lds
    s_add_u32 m0, s27, 40960
    s_add_u32 s28, s26, 81920
    buffer_load_dwordx4 v7, s[8:11], s28 offen sc1 lds
    s_add_u32 m0, s27, 45056
    s_add_u32 s28, s26, 90112
    buffer_load_dwordx4 v7, s[8:11], s28 offen sc1 lds
    s_add_u32 m0, s27, 49152
    s_add_u32 s28, s26, 98304
    buffer_load_dwordx4 v7, s[8:11], s28 offen sc1 lds
    s_add_u32 m0, s27, 53248
    s_add_u32 s28, s26, 106496
    buffer_load_dwordx4 v7, s[8:11], s28 offen sc1 lds
    s_add_u32 m0, s27, 57344
    s_add_u32 s28, s26, 114688
    buffer_load_dwordx4 v7, s[8:11], s28 offen sc1 lds
    s_add_u32 m0, s27, 61440
    s_add_u32 s28, s26, 122880
    buffer_load_dwordx4 v7, s[8:11], s28 offen sc1 lds
    v_lshrrev_b32 v186, 1, v25
    v_lshlrev_b32 v186, 11, v186
    v_lshl_add_u32 v186, v13, 5, v186
    v_and_b32 v187, 1, v25
    v_lshl_add_u32 v186, v187, 4, v186
    s_waitcnt vmcnt(12)
    s_barrier
    ds_read_b128 v[104:107], v186 offset:0
    ds_read_b128 v[108:111], v186 offset:512
    ds_read_b128 v[112:115], v186 offset:1024
    ds_read_b128 v[116:119], v186 offset:1536
    ds_read_b128 v[120:123], v186 offset:4096
    ds_read_b128 v[124:127], v186 offset:4608
    ds_read_b128 v[128:131], v186 offset:5120
    s_waitcnt lgkmcnt(6)
    v_mfma_f32_16x16x32_bf16 v[136:139], v[40:43], v[104:107], 0
    ds_read_b128 v[132:135], v186 offset:5632
    s_waitcnt lgkmcnt(6)
    v_mfma_f32_16x16x32_bf16 v[140:143], v[40:43], v[108:111], 0
    ds_read_b128 v[104:107], v186 offset:8192
    s_waitcnt lgkmcnt(6)
    v_mfma_f32_16x16x32_bf16 v[144:147], v[40:43], v[112:115], 0
    ds_read_b128 v[108:111], v186 offset:8704
    s_waitcnt lgkmcnt(6)
    v_mfma_f32_16x16x32_bf16 v[148:151], v[40:43], v[116:119], 0
    ds_read_b128 v[112:115], v186 offset:9216
    s_waitcnt lgkmcnt(6)
    v_mfma_f32_16x16x32_bf16 v[136:139], v[44:47], v[120:123], v[136:139]
    ds_read_b128 v[116:119], v186 offset:9728
    s_waitcnt lgkmcnt(6)
    v_mfma_f32_16x16x32_bf16 v[140:143], v[44:47], v[124:127], v[140:143]
    ds_read_b128 v[120:123], v186 offset:12288
    s_waitcnt lgkmcnt(6)
    v_mfma_f32_16x16x32_bf16 v[144:147], v[44:47], v[128:131], v[144:147]
    ds_read_b128 v[124:127], v186 offset:12800
    s_waitcnt lgkmcnt(6)
    v_mfma_f32_16x16x32_bf16 v[148:151], v[44:47], v[132:135], v[148:151]
    ds_read_b128 v[128:131], v186 offset:13312
    s_waitcnt lgkmcnt(6)
    v_mfma_f32_16x16x32_bf16 v[136:139], v[48:51], v[104:107], v[136:139]
    ds_read_b128 v[132:135], v186 offset:13824
    s_waitcnt lgkmcnt(6)
    v_mfma_f32_16x16x32_bf16 v[140:143], v[48:51], v[108:111], v[140:143]
    s_waitcnt vmcnt(8)
    s_barrier
    ds_read_b128 v[104:107], v186 offset:16384
    s_waitcnt lgkmcnt(6)
    v_mfma_f32_16x16x32_bf16 v[144:147], v[48:51], v[112:115], v[144:147]
    ds_read_b128 v[108:111], v186 offset:16896
    s_waitcnt lgkmcnt(6)
    v_mfma_f32_16x16x32_bf16 v[148:151], v[48:51], v[116:119], v[148:151]
    ds_read_b128 v[112:115], v186 offset:17408
    s_waitcnt lgkmcnt(6)
    v_mfma_f32_16x16x32_bf16 v[136:139], v[52:55], v[120:123], v[136:139]
    ds_read_b128 v[116:119], v186 offset:17920
    s_waitcnt lgkmcnt(6)
    v_mfma_f32_16x16x32_bf16 v[140:143], v[52:55], v[124:127], v[140:143]
    ds_read_b128 v[120:123], v186 offset:20480
    s_waitcnt lgkmcnt(6)
    v_mfma_f32_16x16x32_bf16 v[144:147], v[52:55], v[128:131], v[144:147]
    ds_read_b128 v[124:127], v186 offset:20992
    s_waitcnt lgkmcnt(6)
    v_mfma_f32_16x16x32_bf16 v[148:151], v[52:55], v[132:135], v[148:151]
    ds_read_b128 v[128:131], v186 offset:21504
    s_waitcnt lgkmcnt(6)
    v_mfma_f32_16x16x32_bf16 v[136:139], v[56:59], v[104:107], v[136:139]
    ds_read_b128 v[132:135], v186 offset:22016
    s_waitcnt lgkmcnt(6)
    v_mfma_f32_16x16x32_bf16 v[140:143], v[56:59], v[108:111], v[140:143]
    ds_read_b128 v[104:107], v186 offset:24576
    s_waitcnt lgkmcnt(6)
    v_mfma_f32_16x16x32_bf16 v[144:147], v[56:59], v[112:115], v[144:147]
    ds_read_b128 v[108:111], v186 offset:25088
    s_waitcnt lgkmcnt(6)
    v_mfma_f32_16x16x32_bf16 v[148:151], v[56:59], v[116:119], v[148:151]
    ds_read_b128 v[112:115], v186 offset:25600
    s_waitcnt lgkmcnt(6)
    v_mfma_f32_16x16x32_bf16 v[136:139], v[60:63], v[120:123], v[136:139]
    ds_read_b128 v[116:119], v186 offset:26112
    s_waitcnt lgkmcnt(6)
    v_mfma_f32_16x16x32_bf16 v[140:143], v[60:63], v[124:127], v[140:143]
    ds_read_b128 v[120:123], v186 offset:28672
    s_waitcnt lgkmcnt(6)
    v_mfma_f32_16x16x32_bf16 v[144:147], v[60:63], v[128:131], v[144:147]
    ds_read_b128 v[124:127], v186 offset:29184
    s_waitcnt lgkmcnt(6)
    v_mfma_f32_16x16x32_bf16 v[148:151], v[60:63], v[132:135], v[148:151]
    ds_read_b128 v[128:131], v186 offset:29696
    s_waitcnt lgkmcnt(6)
    v_mfma_f32_16x16x32_bf16 v[136:139], v[64:67], v[104:107], v[136:139]
    ds_read_b128 v[132:135], v186 offset:30208
    s_waitcnt lgkmcnt(6)
    v_mfma_f32_16x16x32_bf16 v[140:143], v[64:67], v[108:111], v[140:143]
    s_waitcnt vmcnt(4)
    s_barrier
    ds_read_b128 v[104:107], v186 offset:32768
    s_waitcnt lgkmcnt(6)
    v_mfma_f32_16x16x32_bf16 v[144:147], v[64:67], v[112:115], v[144:147]
    ds_read_b128 v[108:111], v186 offset:33280
    s_waitcnt lgkmcnt(6)
    v_mfma_f32_16x16x32_bf16 v[148:151], v[64:67], v[116:119], v[148:151]
    ds_read_b128 v[112:115], v186 offset:33792
    s_waitcnt lgkmcnt(6)
    v_mfma_f32_16x16x32_bf16 v[136:139], v[68:71], v[120:123], v[136:139]
    ds_read_b128 v[116:119], v186 offset:34304
    s_waitcnt lgkmcnt(6)
    v_mfma_f32_16x16x32_bf16 v[140:143], v[68:71], v[124:127], v[140:143]
    ds_read_b128 v[120:123], v186 offset:36864
    s_waitcnt lgkmcnt(6)
    v_mfma_f32_16x16x32_bf16 v[144:147], v[68:71], v[128:131], v[144:147]
    ds_read_b128 v[124:127], v186 offset:37376
    s_waitcnt lgkmcnt(6)
    v_mfma_f32_16x16x32_bf16 v[148:151], v[68:71], v[132:135], v[148:151]
    ds_read_b128 v[128:131], v186 offset:37888
    s_waitcnt lgkmcnt(6)
    v_mfma_f32_16x16x32_bf16 v[136:139], v[72:75], v[104:107], v[136:139]
    ds_read_b128 v[132:135], v186 offset:38400
    s_waitcnt lgkmcnt(6)
    v_mfma_f32_16x16x32_bf16 v[140:143], v[72:75], v[108:111], v[140:143]
    ds_read_b128 v[104:107], v186 offset:40960
    s_waitcnt lgkmcnt(6)
    v_mfma_f32_16x16x32_bf16 v[144:147], v[72:75], v[112:115], v[144:147]
    ds_read_b128 v[108:111], v186 offset:41472
    s_waitcnt lgkmcnt(6)
    v_mfma_f32_16x16x32_bf16 v[148:151], v[72:75], v[116:119], v[148:151]
    ds_read_b128 v[112:115], v186 offset:41984
    s_waitcnt lgkmcnt(6)
    v_mfma_f32_16x16x32_bf16 v[136:139], v[76:79], v[120:123], v[136:139]
    ds_read_b128 v[116:119], v186 offset:42496
    s_waitcnt lgkmcnt(6)
    v_mfma_f32_16x16x32_bf16 v[140:143], v[76:79], v[124:127], v[140:143]
    ds_read_b128 v[120:123], v186 offset:45056
    s_waitcnt lgkmcnt(6)
    v_mfma_f32_16x16x32_bf16 v[144:147], v[76:79], v[128:131], v[144:147]
    ds_read_b128 v[124:127], v186 offset:45568
    s_waitcnt lgkmcnt(6)
    v_mfma_f32_16x16x32_bf16 v[148:151], v[76:79], v[132:135], v[148:151]
    ds_read_b128 v[128:131], v186 offset:46080
    s_waitcnt lgkmcnt(6)
    v_mfma_f32_16x16x32_bf16 v[136:139], v[80:83], v[104:107], v[136:139]
    ds_read_b128 v[132:135], v186 offset:46592
    s_waitcnt lgkmcnt(6)
    v_mfma_f32_16x16x32_bf16 v[140:143], v[80:83], v[108:111], v[140:143]
    s_waitcnt vmcnt(0)
    s_barrier
    ds_read_b128 v[104:107], v186 offset:49152
    s_waitcnt lgkmcnt(6)
    v_mfma_f32_16x16x32_bf16 v[144:147], v[80:83], v[112:115], v[144:147]
    ds_read_b128 v[108:111], v186 offset:49664
    s_waitcnt lgkmcnt(6)
    v_mfma_f32_16x16x32_bf16 v[148:151], v[80:83], v[116:119], v[148:151]
    ds_read_b128 v[112:115], v186 offset:50176
    s_waitcnt lgkmcnt(6)
    v_mfma_f32_16x16x32_bf16 v[136:139], v[84:87], v[120:123], v[136:139]
    ds_read_b128 v[116:119], v186 offset:50688
    s_waitcnt lgkmcnt(6)
    v_mfma_f32_16x16x32_bf16 v[140:143], v[84:87], v[124:127], v[140:143]
    ds_read_b128 v[120:123], v186 offset:53248
    s_waitcnt lgkmcnt(6)
    v_mfma_f32_16x16x32_bf16 v[144:147], v[84:87], v[128:131], v[144:147]
    ds_read_b128 v[124:127], v186 offset:53760
    s_waitcnt lgkmcnt(6)
    v_mfma_f32_16x16x32_bf16 v[148:151], v[84:87], v[132:135], v[148:151]
    ds_read_b128 v[128:131], v186 offset:54272
    s_waitcnt lgkmcnt(6)
    v_mfma_f32_16x16x32_bf16 v[136:139], v[88:91], v[104:107], v[136:139]
    ds_read_b128 v[132:135], v186 offset:54784
    s_waitcnt lgkmcnt(6)
    v_mfma_f32_16x16x32_bf16 v[140:143], v[88:91], v[108:111], v[140:143]
    ds_read_b128 v[104:107], v186 offset:57344
    s_waitcnt lgkmcnt(6)
    v_mfma_f32_16x16x32_bf16 v[144:147], v[88:91], v[112:115], v[144:147]
    ds_read_b128 v[108:111], v186 offset:57856
    s_waitcnt lgkmcnt(6)
    v_mfma_f32_16x16x32_bf16 v[148:151], v[88:91], v[116:119], v[148:151]
    ds_read_b128 v[112:115], v186 offset:58368
    s_waitcnt lgkmcnt(6)
    v_mfma_f32_16x16x32_bf16 v[136:139], v[92:95], v[120:123], v[136:139]
    ds_read_b128 v[116:119], v186 offset:58880
    s_waitcnt lgkmcnt(6)
    v_mfma_f32_16x16x32_bf16 v[140:143], v[92:95], v[124:127], v[140:143]
    ds_read_b128 v[120:123], v186 offset:61440
    s_waitcnt lgkmcnt(6)
    v_mfma_f32_16x16x32_bf16 v[144:147], v[92:95], v[128:131], v[144:147]
    ds_read_b128 v[124:127], v186 offset:61952
    s_waitcnt lgkmcnt(6)
    v_mfma_f32_16x16x32_bf16 v[148:151], v[92:95], v[132:135], v[148:151]
    ds_read_b128 v[128:131], v186 offset:62464
    s_waitcnt lgkmcnt(6)
    v_mfma_f32_16x16x32_bf16 v[136:139], v[96:99], v[104:107], v[136:139]
    ds_read_b128 v[132:135], v186 offset:62976
    s_waitcnt lgkmcnt(6)
    v_mfma_f32_16x16x32_bf16 v[140:143], v[96:99], v[108:111], v[140:143]
    s_waitcnt lgkmcnt(5)
    v_mfma_f32_16x16x32_bf16 v[144:147], v[96:99], v[112:115], v[144:147]
    s_waitcnt lgkmcnt(4)
    v_mfma_f32_16x16x32_bf16 v[148:151], v[96:99], v[116:119], v[148:151]
    s_waitcnt lgkmcnt(3)
    v_mfma_f32_16x16x32_bf16 v[136:139], v[100:103], v[120:123], v[136:139]
    s_waitcnt lgkmcnt(2)
    v_mfma_f32_16x16x32_bf16 v[140:143], v[100:103], v[124:127], v[140:143]
    s_waitcnt lgkmcnt(1)
    v_mfma_f32_16x16x32_bf16 v[144:147], v[100:103], v[128:131], v[144:147]
    s_waitcnt lgkmcnt(0)
    v_mfma_f32_16x16x32_bf16 v[148:151], v[100:103], v[132:135], v[148:151]
    s_cmp_lg_u32 s24, 0
    s_cbranch_scc1 OPB1_108
    v_lshlrev_b32 v152, 16, v26
    v_and_b32 v153, 0xffff0000, v26
    v_lshlrev_b32 v154, 16, v27
    v_and_b32 v155, 0xffff0000, v27
    v_lshlrev_b32 v156, 16, v28
    v_and_b32 v157, 0xffff0000, v28
    v_lshlrev_b32 v158, 16, v29
    v_and_b32 v159, 0xffff0000, v29
    v_lshlrev_b32 v160, 16, v30
    v_and_b32 v161, 0xffff0000, v30
    v_lshlrev_b32 v162, 16, v31
    v_and_b32 v163, 0xffff0000, v31
    v_lshlrev_b32 v164, 16, v32
    v_and_b32 v165, 0xffff0000, v32
    v_lshlrev_b32 v166, 16, v33
    v_and_b32 v167, 0xffff0000, v33
    s_branch OPB2_109
OPB1_108:
    v_lshlrev_b32 v186, 4, v13
    v_add_u32 v186, 157440, v186
    ds_read_b64 v[188:189], v186 offset:0
    ds_read_b64 v[190:191], v186 offset:256
    ds_read_b64 v[192:193], v186 offset:512
    ds_read_b64 v[194:195], v186 offset:768
    v_lshlrev_b32 v152, 16, v26
    v_and_b32 v153, 0xffff0000, v26
    v_lshlrev_b32 v154, 16, v27
    v_and_b32 v155, 0xffff0000, v27
    v_lshlrev_b32 v156, 16, v28
    v_and_b32 v157, 0xffff0000, v28
    v_lshlrev_b32 v158, 16, v29
    v_and_b32 v159, 0xffff0000, v29
    v_lshlrev_b32 v160, 16, v30
    v_and_b32 v161, 0xffff0000, v30
    v_lshlrev_b32 v162, 16, v31
    v_and_b32 v163, 0xffff0000, v31
    v_lshlrev_b32 v164, 16, v32
    v_and_b32 v165, 0xffff0000, v32
    v_lshlrev_b32 v166, 16, v33
    v_and_b32 v167, 0xffff0000, v33
    s_waitcnt lgkmcnt(0)
    v_mul_f32 v188, v188, v189
    v_add_f32 v189, 1.0, v189
    v_fma_f32 v152, v152, v189, -v188
    v_fma_f32 v153, v153, v189, -v188
    v_fma_f32 v154, v154, v189, -v188
    v_fma_f32 v155, v155, v189, -v188
    v_mul_f32 v190, v190, v191
    v_add_f32 v191, 1.0, v191
    v_fma_f32 v156, v156, v191, -v190
    v_fma_f32 v157, v157, v191, -v190
    v_fma_f32 v158, v158, v191, -v190
    v_fma_f32 v159, v159, v191, -v190
    v_mul_f32 v192, v192, v193
    v_add_f32 v193, 1.0, v193
    v_fma_f32 v160, v160, v193, -v192
    v_fma_f32 v161, v161, v193, -v192
    v_fma_f32 v162, v162, v193, -v192
    v_fma_f32 v163, v163, v193, -v192
    v_mul_f32 v194, v194, v195
    v_add_f32 v195, 1.0, v195
    v_fma_f32 v164, v164, v195, -v194
    v_fma_f32 v165, v165, v195, -v194
    v_fma_f32 v166, v166, v195, -v194
    v_fma_f32 v167, v167, v195, -v194
    s_lshr_b32 s25, s41, 8
    s_cmp_lg_u32 s25, s20
    s_cbranch_scc1 NOY_110
    s_lshr_b32 s25, s41, 6
    s_and_b32 s25, s25, 3
    s_lshr_b32 s26, s21, 3
    s_cmp_lg_u32 s25, s26
    s_cbranch_scc1 NOY_110
    v_mov_b32 v196, v38
    v_mov_b32 v197, v39
    v_mov_b32 v198, v23
    v_mov_b32 v199, v24
    s_and_b32 s25, s41, 63
    v_add_u32 v186, 0, v13
    v_cmp_eq_u32 vcc, s25, v186
    s_nop 1
    v_cndmask_b32 v187, 0, 1.0, vcc
    v_fmac_f32 v152, v187, v196
    v_fmac_f32 v153, v187, v197
    v_fmac_f32 v154, v187, v198
    v_fmac_f32 v155, v187, v199
    v_add_u32 v186, 16, v13
    v_cmp_eq_u32 vcc, s25, v186
    s_nop 1
    v_cndmask_b32 v187, 0, 1.0, vcc
    v_fmac_f32 v156, v187, v196
    v_fmac_f32 v157, v187, v197
    v_fmac_f32 v158, v187, v198
    v_fmac_f32 v159, v187, v199
    v_add_u32 v186, 32, v13
    v_cmp_eq_u32 vcc, s25, v186
    s_nop 1
    v_cndmask_b32 v187, 0, 1.0, vcc
    v_fmac_f32 v160, v187, v196
    v_fmac_f32 v161, v187, v197
    v_fmac_f32 v162, v187, v198
    v_fmac_f32 v163, v187, v199
    v_add_u32 v186, 48, v13
    v_cmp_eq_u32 vcc, s25, v186
    s_nop 1
    v_cndmask_b32 v187, 0, 1.0, vcc
    v_fmac_f32 v164, v187, v196
    v_fmac_f32 v165, v187, v197
    v_fmac_f32 v166, v187, v198
    v_fmac_f32 v167, v187, v199
NOY_110:
OPB2_109:
    v_add_f32 v152, v152, v136
    v_add_f32 v153, v153, v137
    v_add_f32 v154, v154, v138
    v_add_f32 v155, v155, v139
    v_add_f32 v156, v156, v140
    v_add_f32 v157, v157, v141
    v_add_f32 v158, v158, v142
    v_add_f32 v159, v159, v143
    v_add_f32 v160, v160, v144
    v_add_f32 v161, v161, v145
    v_add_f32 v162, v162, v146
    v_add_f32 v163, v163, v147
    v_add_f32 v164, v164, v148
    v_add_f32 v165, v165, v149
    v_add_f32 v166, v166, v150
    v_add_f32 v167, v167, v151
    v_cvt_pk_bf16_f32 v26, v152, v153
    v_cvt_pk_bf16_f32 v27, v154, v155
    v_cvt_pk_bf16_f32 v28, v156, v157
    v_cvt_pk_bf16_f32 v29, v158, v159
    v_cvt_pk_bf16_f32 v30, v160, v161
    v_cvt_pk_bf16_f32 v31, v162, v163
    v_cvt_pk_bf16_f32 v32, v164, v165
    v_cvt_pk_bf16_f32 v33, v166, v167
    v_lshrrev_b32 v186, 1, v25
    s_lshl_b32 s25, s22, 1
    v_add_u32 v186, s25, v186
    v_lshrrev_b32 v187, 1, v13
    v_xor_b32 v186, v186, v187
    v_lshlrev_b32 v186, 4, v186
    v_lshl_add_u32 v186, v13, 7, v186
    v_and_b32 v187, 1, v25
    v_lshl_add_u32 v186, v187, 3, v186
    v_add_u32 v186, 131072, v186
    ds_write_b64 v186, v[26:27] offset:0
    ds_write_b64 v186, v[28:29] offset:2048
    ds_write_b64 v186, v[30:31] offset:4096
    ds_write_b64 v186, v[32:33] offset:6144
    v_lshlrev_b32 v152, 16, v26
    v_and_b32 v153, 0xffff0000, v26
    v_lshlrev_b32 v154, 16, v27
    v_and_b32 v155, 0xffff0000, v27
    v_lshlrev_b32 v156, 16, v28
    v_and_b32 v157, 0xffff0000, v28
    v_lshlrev_b32 v158, 16, v29
    v_and_b32 v159, 0xffff0000, v29
    v_lshlrev_b32 v160, 16, v30
    v_and_b32 v161, 0xffff0000, v30
    v_lshlrev_b32 v162, 16, v31
    v_and_b32 v163, 0xffff0000, v31
    v_lshlrev_b32 v164, 16, v32
    v_and_b32 v165, 0xffff0000, v32
    v_lshlrev_b32 v166, 16, v33
    v_and_b32 v167, 0xffff0000, v33
    v_add_f32 v168, v152, v153
    v_mul_f32 v172, v152, v152
    v_mul_f32 v176, v152, v34
    v_add_f32 v168, v168, v154
    v_fmac_f32 v172, v153, v153
    v_fmac_f32 v176, v153, v35
    v_add_f32 v168, v168, v155
    v_fmac_f32 v172, v154, v154
    v_fmac_f32 v176, v154, v36
    v_fmac_f32 v172, v155, v155
    v_fmac_f32 v176, v155, v37
    v_add_f32 v169, v156, v157
    v_mul_f32 v173, v156, v156
    v_mul_f32 v177, v156, v34
    v_add_f32 v169, v169, v158
    v_fmac_f32 v173, v157, v157
    v_fmac_f32 v177, v157, v35
    v_add_f32 v169, v169, v159
    v_fmac_f32 v173, v158, v158
    v_fmac_f32 v177, v158, v36
    v_fmac_f32 v173, v159, v159
    v_fmac_f32 v177, v159, v37
    v_add_f32 v170, v160, v161
    v_mul_f32 v174, v160, v160
    v_mul_f32 v178, v160, v34
    v_add_f32 v170, v170, v162
    v_fmac_f32 v174, v161, v161
    v_fmac_f32 v178, v161, v35
    v_add_f32 v170, v170, v163
    v_fmac_f32 v174, v162, v162
    v_fmac_f32 v178, v162, v36
    v_fmac_f32 v174, v163, v163
    v_fmac_f32 v178, v163, v37
    v_add_f32 v171, v164, v165
    v_mul_f32 v175, v164, v164
    v_mul_f32 v179, v164, v34
    v_add_f32 v171, v171, v166
    v_fmac_f32 v175, v165, v165
    v_fmac_f32 v179, v165, v35
    v_add_f32 v171, v171, v167
    v_fmac_f32 v175, v166, v166
    v_fmac_f32 v179, v166, v36
    v_fmac_f32 v175, v167, v167
    v_fmac_f32 v179, v167, v37
    v_permlane32_swap_b32 v168, v170
    v_permlane32_swap_b32 v169, v171
    v_permlane32_swap_b32 v172, v174
    v_permlane32_swap_b32 v173, v175
    v_permlane32_swap_b32 v176, v178
    v_permlane32_swap_b32 v177, v179
    v_add_f32 v168, v168, v170
    v_add_f32 v169, v169, v171
    v_add_f32 v172, v172, v174
    v_add_f32 v173, v173, v175
    v_add_f32 v176, v176, v178
    v_add_f32 v177, v177, v179
    v_permlane16_swap_b32 v168, v169
    v_permlane16_swap_b32 v172, v173
    v_permlane16_swap_b32 v176, v177
    v_add_f32 v180, v168, v169
    v_add_f32 v181, v172, v173
    v_add_f32 v182, v176, v177
    v_mov_b32 v183, s23
    s_lshl_b32 s25, s22, 10
    s_add_u32 s25, s25, 139264
    v_add_u32 v186, s25, v7
    ds_write_b128 v186, v[180:183]
    s_waitcnt lgkmcnt(0)
    s_barrier
    s_cmp_ge_u32 s22, 2
    s_cbranch_scc1 OPW23_111
    v_add_u32 v186, 131072, v8
    ds_read_b128 v[152:155], v186 offset:0
    ds_read_b128 v[156:159], v186 offset:2048
    ds_read_b128 v[160:163], v186 offset:4096
    ds_read_b128 v[164:167], v186 offset:6144
    s_lshl_b32 s25, s20, 3
    s_and_b32 s26, s21, 7
    s_add_u32 s25, s25, s26
    s_lshl_b32 s25, s25, 15
    s_lshr_b32 s27, s21, 3
    s_lshl_b32 s27, s27, 13
    s_add_u32 s25, s25, s27
    s_lshl_b32 s27, s24, 21
    s_add_u32 s25, s25, s27
    s_add_u32 s25, s25, 0xd00000
    s_lshl_b32 s27, s22, 9
    s_add_u32 s27, s27, 139264
    v_add_u32 v187, s27, v7
    ds_read_b128 v[196:199], v187 offset:0
    ds_read_b128 v[200:203], v187 offset:1024
    ds_read_b128 v[204:207], v187 offset:2048
    ds_read_b128 v[208:211], v187 offset:3072
    s_lshl_b32 s29, s20, 8
    s_lshr_b32 s27, s21, 3
    s_lshl_b32 s27, s27, 6
    s_add_u32 s29, s29, s27
    s_lshl_b32 s29, s29, 7
    s_lshl_b32 s27, s24, 18
    s_add_u32 s29, s29, s27
    s_add_u32 s29, s29, 0x60000
    s_lshl_b32 s27, s26, 4
    s_add_u32 s30, s29, s27
    s_lshl_b32 s27, s22, 12
    s_add_u32 s30, s30, s27
    s_waitcnt lgkmcnt(0)
    v_add_f32 v196, v196, v200
    v_add_f32 v197, v197, v201
    v_add_f32 v198, v198, v202
    v_add_f32 v196, v196, v204
    v_add_f32 v197, v197, v205
    v_add_f32 v198, v198, v206
    v_add_f32 v196, v196, v208
    v_add_f32 v197, v197, v209
    v_add_f32 v198, v198, v210
    v_lshlrev_b32 v187, 7, v1
    s_mov_b32 exec_hi, 0
    buffer_store_dwordx4 v[196:199], v187, s[8:11], s30 offen sc1
    s_mov_b64 exec, -1
    s_add_u32 s28, s25, 0
    buffer_store_dwordx4 v[152:155], v8, s[8:11], s28 offen sc1
    s_add_u32 s28, s25, 2048
    buffer_store_dwordx4 v[156:159], v8, s[8:11], s28 offen sc1
    s_add_u32 s28, s25, 4096
    buffer_store_dwordx4 v[160:163], v8, s[8:11], s28 offen sc1
    s_add_u32 s28, s25, 6144
    buffer_store_dwordx4 v[164:167], v8, s[8:11], s28 offen sc1
    s_waitcnt vmcnt(0)
    s_lshl_b32 s25, s2, 7
    s_lshl_b32 s26, s22, 2
    s_add_u32 s25, s25, s26
    s_lshl_b32 s26, s24, 15
    s_add_u32 s25, s25, s26
    s_add_u32 s25, s25, 0x21000
    v_mov_b32 v220, s23
    s_mov_b64 exec, 1
    buffer_store_dword v220, off, s[8:11], s25 sc1
    s_mov_b64 exec, -1
    s_mov_b32 s33, s29
    s_cmp_lg_u32 s24, 0
    s_cbranch_scc1 NODW_113
    s_sub_u32 s3, s2, 8
    s_cmp_ge_u32 s3, 56
    s_cbranch_scc1 NODW_113
    s_mov_b32 s12, s62
    s_and_b32 s13, s63, 0xffff
    s_mov_b32 s14, 0x1c0000
    s_mov_b32 s15, 0x20000
    s_lshl_b32 s25, s46, 15
    s_lshl_b32 s26, s22, 14
    s_add_u32 s25, s25, s26
    s_add_u32 s27, s26, 65536
    s_add_u32 m0, s27, 0
    s_add_u32 s26, s25, 0
    v_xor_b32 v210, 0, v7
    buffer_load_dwordx4 v210, s[12:15], s26 offen lds
    s_add_u32 m0, s27, 1024
    s_add_u32 s26, s25, 1024
    v_xor_b32 v210, 32, v7
    buffer_load_dwordx4 v210, s[12:15], s26 offen lds
    s_add_u32 m0, s27, 2048
    s_add_u32 s26, s25, 2048
    v_xor_b32 v210, 64, v7
    buffer_load_dwordx4 v210, s[12:15], s26 offen lds
    s_add_u32 m0, s27, 3072
    s_add_u32 s26, s25, 3072
    v_xor_b32 v210, 96, v7
    buffer_load_dwordx4 v210, s[12:15], s26 offen lds
    s_add_u32 m0, s27, 4096
    s_add_u32 s26, s25, 4096
    v_xor_b32 v210, 0, v7
    buffer_load_dwordx4 v210, s[12:15], s26 offen lds
    s_add_u32 m0, s27, 5120
    s_add_u32 s26, s25, 5120
    v_xor_b32 v210, 32, v7
    buffer_load_dwordx4 v210, s[12:15], s26 offen lds
    s_add_u32 m0, s27, 6144
    s_add_u32 s26, s25, 6144
    v_xor_b32 v210, 64, v7
    buffer_load_dwordx4 v210, s[12:15], s26 offen lds
    s_add_u32 m0, s27, 7168
    s_add_u32 s26, s25, 7168
    v_xor_b32 v210, 96, v7
    buffer_load_dwordx4 v210, s[12:15], s26 offen lds
    s_add_u32 m0, s27, 8192
    s_add_u32 s26, s25, 8192
    v_xor_b32 v210, 128, v7
    buffer_load_dwordx4 v210, s[12:15], s26 offen lds
    s_add_u32 m0, s27, 9216
    s_add_u32 s26, s25, 9216
    v_xor_b32 v210, 160, v7
    buffer_load_dwordx4 v210, s[12:15], s26 offen lds
    s_add_u32 m0, s27, 10240
    s_add_u32 s26, s25, 10240
    v_xor_b32 v210, 192, v7
    buffer_load_dwordx4 v210, s[12:15], s26 offen lds
    s_add_u32 m0, s27, 11264
    s_add_u32 s26, s25, 11264
    v_xor_b32 v210, 224, v7
    buffer_load_dwordx4 v210, s[12:15], s26 offen lds
    s_add_u32 m0, s27, 12288
    s_add_u32 s26, s25, 12288
    v_xor_b32 v210, 128, v7
    buffer_load_dwordx4 v210, s[12:15], s26 offen lds
    s_add_u32 m0, s27, 13312
    s_add_u32 s26, s25, 13312
    v_xor_b32 v210, 160, v7
    buffer_load_dwordx4 v210, s[12:15], s26 offen lds
    s_add_u32 m0, s27, 14336
    s_add_u32 s26, s25, 14336
    v_xor_b32 v210, 192, v7
    buffer_load_dwordx4 v210, s[12:15], s26 offen lds
    s_add_u32 m0, s27, 15360
    s_add_u32 s26, s25, 15360
    v_xor_b32 v210, 224, v7
    buffer_load_dwordx4 v210, s[12:15], s26 offen lds
NODW_113:
    s_mov_b32 s29, s33
    s_add_u32 s30, s29, 2048
    s_add_u32 s31, s29, 4096
    s_add_u32 s32, s29, 6144
    s_mov_b32 s76, 0
POLL_114:
    buffer_load_dwordx4 v[188:191], v8, s[8:11], s29 offen sc1
    buffer_load_dwordx4 v[192:195], v8, s[8:11], s30 offen sc1
    buffer_load_dwordx4 v[196:199], v8, s[8:11], s31 offen sc1
    buffer_load_dwordx4 v[200:203], v8, s[8:11], s32 offen sc1
    s_waitcnt vmcnt(0)
    v_xor_b32 v219, s23, v191
    v_xor_b32 v218, s23, v195
    v_or_b32 v219, v219, v218
    v_xor_b32 v218, s23, v199
    v_or_b32 v219, v219, v218
    v_xor_b32 v218, s23, v203
    v_or_b32 v219, v219, v218
    v_cmp_ne_u32 vcc, 0, v219
    s_nop 1
    s_cmp_eq_u64 vcc, 0
    s_cbranch_scc1 POLD_115
    s_sleep 4
    s_add_u32 s76, s76, 1
    s_cmp_lt_u32 s76, 0x40000
    s_cbranch_scc1 POLL_114
    s_mov_b32 s12, s66
    s_and_b32 s13, s67, 0xffff
    s_mov_b32 s14, 0x100
    s_mov_b32 s15, 0x20000
    v_mov_b32 v221, 5
    buffer_store_dword v221, off, s[12:15], 0
    s_waitcnt vmcnt(0)
POLD_115:
    v_add_f32_dpp v188, v188, v188 quad_perm:[1,0,3,2] row_mask:0xf bank_mask:0xf
    v_add_f32_dpp v189, v189, v189 quad_perm:[1,0,3,2] row_mask:0xf bank_mask:0xf
    v_add_f32_dpp v190, v190, v190 quad_perm:[1,0,3,2] row_mask:0xf bank_mask:0xf
    v_add_f32_dpp v192, v192, v192 quad_perm:[1,0,3,2] row_mask:0xf bank_mask:0xf
    v_add_f32_dpp v193, v193, v193 quad_perm:[1,0,3,2] row_mask:0xf bank_mask:0xf
    v_add_f32_dpp v194, v194, v194 quad_perm:[1,0,3,2] row_mask:0xf bank_mask:0xf
    v_add_f32_dpp v196, v196, v196 quad_perm:[1,0,3,2] row_mask:0xf bank_mask:0xf
    v_add_f32_dpp v197, v197, v197 quad_perm:[1,0,3,2] row_mask:0xf bank_mask:0xf
    v_add_f32_dpp v198, v198, v198 quad_perm:[1,0,3,2] row_mask:0xf bank_mask:0xf
    v_add_f32_dpp v200, v200, v200 quad_perm:[1,0,3,2] row_mask:0xf bank_mask:0xf
    v_add_f32_dpp v201, v201, v201 quad_perm:[1,0,3,2] row_mask:0xf bank_mask:0xf
    v_add_f32_dpp v202, v202, v202 quad_perm:[1,0,3,2] row_mask:0xf bank_mask:0xf
    v_add_f32_dpp v188, v188, v188 quad_perm:[2,3,0,1] row_mask:0xf bank_mask:0xf
    v_add_f32_dpp v189, v189, v189 quad_perm:[2,3,0,1] row_mask:0xf bank_mask:0xf
    v_add_f32_dpp v190, v190, v190 quad_perm:[2,3,0,1] row_mask:0xf bank_mask:0xf
    v_add_f32_dpp v192, v192, v192 quad_perm:[2,3,0,1] row_mask:0xf bank_mask:0xf
    v_add_f32_dpp v193, v193, v193 quad_perm:[2,3,0,1] row_mask:0xf bank_mask:0xf
    v_add_f32_dpp v194, v194, v194 quad_perm:[2,3,0,1] row_mask:0xf bank_mask:0xf
    v_add_f32_dpp v196, v196, v196 quad_perm:[2,3,0,1] row_mask:0xf bank_mask:0xf
    v_add_f32_dpp v197, v197, v197 quad_perm:[2,3,0,1] row_mask:0xf bank_mask:0xf
    v_add_f32_dpp v198, v198, v198 quad_perm:[2,3,0,1] row_mask:0xf bank_mask:0xf
    v_add_f32_dpp v200, v200, v200 quad_perm:[2,3,0,1] row_mask:0xf bank_mask:0xf
    v_add_f32_dpp v201, v201, v201 quad_perm:[2,3,0,1] row_mask:0xf bank_mask:0xf
    v_add_f32_dpp v202, v202, v202 quad_perm:[2,3,0,1] row_mask:0xf bank_mask:0xf
    v_add_f32_dpp v188, v188, v188 row_half_mirror row_mask:0xf bank_mask:0xf
    v_add_f32_dpp v189, v189, v189 row_half_mirror row_mask:0xf bank_mask:0xf
    v_add_f32_dpp v190, v190, v190 row_half_mirror row_mask:0xf bank_mask:0xf
    v_add_f32_dpp v192, v192, v192 row_half_mirror row_mask:0xf bank_mask:0xf
    v_add_f32_dpp v193, v193, v193 row_half_mirror row_mask:0xf bank_mask:0xf
    v_add_f32_dpp v194, v194, v194 row_half_mirror row_mask:0xf bank_mask:0xf
    v_add_f32_dpp v196, v196, v196 row_half_mirror row_mask:0xf bank_mask:0xf
    v_add_f32_dpp v197, v197, v197 row_half_mirror row_mask:0xf bank_mask:0xf
    v_add_f32_dpp v198, v198, v198 row_half_mirror row_mask:0xf bank_mask:0xf
    v_add_f32_dpp v200, v200, v200 row_half_mirror row_mask:0xf bank_mask:0xf
    v_add_f32_dpp v201, v201, v201 row_half_mirror row_mask:0xf bank_mask:0xf
    v_add_f32_dpp v202, v202, v202 row_half_mirror row_mask:0xf bank_mask:0xf
    s_mov_b32 s25, 0x3b000000
    s_mov_b32 s26, 0x3727c5ac
    v_mul_f32 v188, s25, v188
    v_mul_f32 v189, s25, v189
    v_mul_f32 v192, s25, v192
    v_mul_f32 v193, s25, v193
    v_mul_f32 v196, s25, v196
    v_mul_f32 v197, s25, v197
    v_mul_f32 v200, s25, v200
    v_mul_f32 v201, s25, v201
    v_fma_f32 v189, -v188, v188, v189
    v_fma_f32 v191, -v188, s44, v190
    v_fma_f32 v193, -v192, v192, v193
    v_fma_f32 v195, -v192, s44, v194
    v_fma_f32 v197, -v196, v196, v197
    v_fma_f32 v199, -v196, s44, v198
    v_fma_f32 v201, -v200, v200, v201
    v_fma_f32 v203, -v200, s44, v202
    v_add_f32 v152, s26, v189
    v_add_f32 v156, s26, v193
    v_add_f32 v160, s26, v197
    v_add_f32 v164, s26, v201
    v_rsq_f32 v153, v152
    v_rsq_f32 v157, v156
    v_rsq_f32 v161, v160
    v_rsq_f32 v165, v164
    v_add_f32 v154, 1.0, v153
    v_add_f32 v158, 1.0, v157
    v_add_f32 v162, 1.0, v161
    v_add_f32 v166, 1.0, v165
    v_mul_f32 v191, v153, v191
    v_mul_f32 v155, v154, v154
    v_mul_f32 v195, v157, v195
    v_mul_f32 v159, v158, v158
    v_mul_f32 v199, v161, v199
    v_mul_f32 v163, v162, v162
    v_mul_f32 v203, v165, v203
    v_mul_f32 v167, v166, v166
    v_fma_f32 v155, v155, v189, s26
    v_fma_f32 v159, v159, v193, s26
    v_fma_f32 v163, v163, v197, s26
    v_fma_f32 v167, v167, v201, s26
    v_rsq_f32 v155, v155
    v_rsq_f32 v159, v159
    v_rsq_f32 v163, v163
    v_rsq_f32 v167, v167
    v_mov_b32 v189, v153
    v_mov_b32 v193, v157
    v_mov_b32 v197, v161
    v_mov_b32 v201, v165
    v_mul_f32 v190, v154, v155
    v_mul_f32 v194, v158, v159
    v_mul_f32 v198, v162, v163
    v_mul_f32 v202, v166, v167
    v_lshrrev_b32 v186, 3, v0
    v_lshlrev_b32 v186, 4, v186
    v_add_u32 v186, 157440, v186
    s_mov_b32 s28, 0x01010101
    s_mov_b32 s29, 0x01010101
    s_mov_b64 exec, s[28:29]
    ds_write_b128 v186, v[188:191] offset:0
    ds_write_b128 v186, v[192:195] offset:256
    ds_write_b128 v186, v[196:199] offset:512
    ds_write_b128 v186, v[200:203] offset:768
    s_mov_b64 exec, -1
    s_waitcnt lgkmcnt(0)
    s_branch OPPE_112
OPW23_111:
OPPE_112:
    s_barrier
    s_and_b32 s25, s21, 7
    s_cmp_lg_u32 s25, 0
    s_cbranch_scc1 OPFS_117
    s_barrier
    s_cmp_lg_u32 s22, 0
    s_cbranch_scc1 OPFS_117
    v_add_u32 v186, 157440, v7
    ds_read_b128 v[188:191], v186
    s_waitcnt lgkmcnt(0)
    v_mov_b32 v192, v191
    v_mov_b32 v193, v191
    v_mov_b32 v191, s23
    s_lshl_b32 s29, s20, 8
    s_lshr_b32 s27, s21, 3
    s_lshl_b32 s27, s27, 6
    s_add_u32 s29, s29, s27
    v_max_f32_dpp v192, v192, v192 quad_perm:[1,0,3,2] row_mask:0xf bank_mask:0xf
    s_nop 1
    v_max_f32_dpp v192, v192, v192 quad_perm:[2,3,0,1] row_mask:0xf bank_mask:0xf
    s_nop 1
    v_max_f32_dpp v192, v192, v192 row_half_mirror row_mask:0xf bank_mask:0xf
    s_nop 1
    v_max_f32_dpp v192, v192, v192 row_mirror row_mask:0xf bank_mask:0xf
    v_mov_b32 v194, v192
    s_nop 1
    v_permlane16_swap_b32 v192, v194
    v_max_f32 v192, v192, v194
    v_mov_b32 v194, v192
    s_nop 1
    v_permlane32_swap_b32 v192, v194
    v_max_f32 v192, v192, v194
    v_cmp_eq_f32 vcc, v192, v193
    s_nop 1
    s_ff1_i32_b64 s28, vcc
    s_add_u32 s28, s28, s29
    v_mov_b32 v193, s28
    v_mov_b32 v194, s23
    v_mov_b32 v195, s23
    s_lshl_b32 s28, s20, 2
    s_lshr_b32 s27, s21, 3
    s_add_u32 s28, s28, s27
    s_lshl_b32 s28, s28, 4
    s_lshl_b32 s27, s24, 12
    s_add_u32 s28, s28, s27
    s_add_u32 s28, s28, 0xe0000
    s_mov_b64 exec, 1
    buffer_store_dwordx4 v[192:195], off, s[8:11], s28 sc1
    s_mov_b64 exec, -1
    s_cmp_lg_u32 s24, 0
    s_cbranch_scc1 OPFS1_118
    s_lshl_b32 s28, s29, 4
    s_add_u32 s28, s28, 0x50000
    buffer_store_dwordx4 v[188:191], v7, s[8:11], s28 offen sc1
OPFS1_118:
OPFS_117:
    s_cmp_lg_u32 s24, 0
    s_cbranch_scc1 FINAL_119
    s_and_b32 s25, s21, 1
    s_lshl_b32 s27, s25, 14
    s_lshl_b32 s28, s20, 7
    s_add_u32 s27, s27, s28
    s_add_u32 s27, s27, 0x21000
    v_and_b32 v186, 31, v1
    v_lshrrev_b32 v187, 1, v186
    v_and_b32 v186, 1, v186
    v_lshlrev_b32 v186, 2, v186
    v_lshl_add_u32 v186, v187, 10, v186
    s_cmp_lg_u32 s22, 0
    s_cbranch_scc1 PLD_120
    s_mov_b32 s76, 0
POLL_121:
    buffer_load_dword v216, v186, s[8:11], s27 offen sc1
    s_waitcnt vmcnt(0)
    v_xor_b32 v219, s23, v216
    v_cmp_ne_u32 vcc, 0, v219
    s_nop 1
    s_cmp_eq_u64 vcc, 0
    s_cbranch_scc1 POLD_122
    s_sleep 4
    s_add_u32 s76, s76, 1
    s_cmp_lt_u32 s76, 0x40000
    s_cbranch_scc1 POLL_121
    s_mov_b32 s12, s66
    s_and_b32 s13, s67, 0xffff
    s_mov_b32 s14, 0x100
    s_mov_b32 s15, 0x20000
    v_mov_b32 v221, 14
    buffer_store_dword v221, off, s[12:15], 0
    s_waitcnt vmcnt(0)
POLD_122:
PLD_120:
    s_barrier
    s_mov_b32 s16, s8
    s_mov_b32 s17, s9
    s_mov_b32 s18, s10
    s_mov_b32 s19, 0x20000
    s_lshl_b32 s25, s20, 18
    s_and_b32 s26, s21, 1
    s_lshl_b32 s26, s26, 14
    s_add_u32 s25, s25, s26
    s_lshl_b32 s26, s35, 13
    s_add_u32 s25, s25, s26
    s_lshl_b32 s26, s34, 17
    s_add_u32 s25, s25, s26
    s_add_u32 s37, s25, 0xd00000
    s_mov_b32 s39, 32768
    s_mov_b32 s38, 0xfffe0800
    v_mov_b32 v2, v7
    v_mov_b32 v3, v7
    s_mov_b32 s40, s37
    s_lshl_b32 s47, s35, 14
    s_lshl_b32 s25, s34, 13
    s_add_u32 s47, s47, s25
    s_add_u32 m0, s47, 0
    s_nop 0
    buffer_load_dwordx4 v2, s[16:19], s40 offen sc1 lds
    buffer_load_dwordx4 v3, s[16:19], s40 offen offset:1024 sc1 lds
    s_add_u32 s40, s40, s39
    s_add_u32 m0, s47, 2048
    s_nop 0
    buffer_load_dwordx4 v2, s[16:19], s40 offen sc1 lds
    buffer_load_dwordx4 v3, s[16:19], s40 offen offset:1024 sc1 lds
    s_add_u32 s40, s40, s39
    s_add_u32 m0, s47, 4096
    s_nop 0
    buffer_load_dwordx4 v2, s[16:19], s40 offen sc1 lds
    buffer_load_dwordx4 v3, s[16:19], s40 offen offset:1024 sc1 lds
    s_add_u32 s40, s40, s39
    s_add_u32 m0, s47, 6144
    s_nop 0
    buffer_load_dwordx4 v2, s[16:19], s40 offen sc1 lds
    buffer_load_dwordx4 v3, s[16:19], s40 offen offset:1024 sc1 lds
    s_add_u32 s40, s40, s39
    s_add_u32 s40, s40, s38
    s_mov_b32 s24, 1
    s_branch LAYER
FINAL_119:
    s_barrier
    v_lshlrev_b32 v186, 4, v13
    v_add_u32 v186, 157440, v186
    ds_read_b64 v[188:189], v186 offset:0
    ds_read_b64 v[190:191], v186 offset:256
    ds_read_b64 v[192:193], v186 offset:512
    ds_read_b64 v[194:195], v186 offset:768
    v_lshlrev_b32 v152, 16, v26
    v_and_b32 v153, 0xffff0000, v26
    v_lshlrev_b32 v154, 16, v27
    v_and_b32 v155, 0xffff0000, v27
    v_lshlrev_b32 v156, 16, v28
    v_and_b32 v157, 0xffff0000, v28
    v_lshlrev_b32 v158, 16, v29
    v_and_b32 v159, 0xffff0000, v29
    v_lshlrev_b32 v160, 16, v30
    v_and_b32 v161, 0xffff0000, v30
    v_lshlrev_b32 v162, 16, v31
    v_and_b32 v163, 0xffff0000, v31
    v_lshlrev_b32 v164, 16, v32
    v_and_b32 v165, 0xffff0000, v32
    v_lshlrev_b32 v166, 16, v33
    v_and_b32 v167, 0xffff0000, v33
    s_waitcnt lgkmcnt(0)
    v_mul_f32 v188, v188, v189
    v_add_f32 v189, 1.0, v189
    v_fma_f32 v152, v152, v189, -v188
    v_fma_f32 v153, v153, v189, -v188
    v_fma_f32 v154, v154, v189, -v188
    v_fma_f32 v155, v155, v189, -v188
    v_mul_f32 v190, v190, v191
    v_add_f32 v191, 1.0, v191
    v_fma_f32 v156, v156, v191, -v190
    v_fma_f32 v157, v157, v191, -v190
    v_fma_f32 v158, v158, v191, -v190
    v_fma_f32 v159, v159, v191, -v190
    v_mul_f32 v192, v192, v193
    v_add_f32 v193, 1.0, v193
    v_fma_f32 v160, v160, v193, -v192
    v_fma_f32 v161, v161, v193, -v192
    v_fma_f32 v162, v162, v193, -v192
    v_fma_f32 v163, v163, v193, -v192
    v_mul_f32 v194, v194, v195
    v_add_f32 v195, 1.0, v195
    v_fma_f32 v164, v164, v195, -v194
    v_fma_f32 v165, v165, v195, -v194
    v_fma_f32 v166, v166, v195, -v194
    v_fma_f32 v167, v167, v195, -v194
    v_cvt_pk_bf16_f32 v168, v152, v153
    v_cvt_pk_bf16_f32 v169, v154, v155
    v_cvt_pk_bf16_f32 v170, v156, v157
    v_cvt_pk_bf16_f32 v171, v158, v159
    v_cvt_pk_bf16_f32 v172, v160, v161
    v_cvt_pk_bf16_f32 v173, v162, v163
    v_cvt_pk_bf16_f32 v174, v164, v165
    v_cvt_pk_bf16_f32 v175, v166, v167
    v_lshrrev_b32 v186, 1, v25
    s_lshl_b32 s25, s22, 1
    v_add_u32 v186, s25, v186
    v_lshrrev_b32 v187, 1, v13
    v_xor_b32 v186, v186, v187
    v_lshlrev_b32 v186, 4, v186
    v_lshl_add_u32 v186, v13, 7, v186
    v_and_b32 v187, 1, v25
    v_lshl_add_u32 v186, v187, 3, v186
    v_add_u32 v186, 131072, v186
    ds_write_b64 v186, v[168:169] offset:0
    ds_write_b64 v186, v[170:171] offset:2048
    ds_write_b64 v186, v[172:173] offset:4096
    ds_write_b64 v186, v[174:175] offset:6144
    s_waitcnt lgkmcnt(0)
    s_barrier
    v_lshrrev_b32 v186, 3, v0
    v_and_b32 v187, 7, v0
    v_and_b32 v188, 15, v186
    v_lshrrev_b32 v188, 1, v188
    v_xor_b32 v188, v187, v188
    v_lshlrev_b32 v188, 4, v188
    v_lshl_add_u32 v188, v186, 7, v188
    v_add_u32 v188, 131072, v188
    ds_read_b128 v[192:195], v188
    ds_read_b128 v[196:199], v188 offset:4096
    v_lshlrev_b32 v187, 4, v187
    v_lshl_add_u32 v187, v186, 10, v187
    s_mov_b32 s16, s64
    s_and_b32 s17, s65, 0xffff
    s_mov_b32 s18, 0x200000
    s_mov_b32 s19, 0x20000
    s_lshl_b32 s25, s20, 8
    s_lshr_b32 s26, s21, 3
    s_lshl_b32 s26, s26, 6
    s_add_u32 s25, s25, s26
    s_lshl_b32 s25, s25, 10
    s_and_b32 s26, s21, 7
    s_lshl_b32 s26, s26, 7
    s_add_u32 s37, s25, s26
    s_add_u32 s26, s37, 32768
    s_waitcnt lgkmcnt(0)
    buffer_store_dwordx4 v[192:195], v187, s[16:19], s37 offen sc1
    buffer_store_dwordx4 v[196:199], v187, s[16:19], s26 offen sc1
    s_cmp_lg_u32 s22, 0
    s_cbranch_scc1 FSEL_124
    s_mov_b32 s33, 0xe1000
    v_and_b32 v214, 31, v1
    v_lshlrev_b32 v214, 4, v214
    s_mov_b32 s76, 0
POLL_125:
    buffer_load_dwordx4 v[204:207], v214, s[8:11], s33 offen sc1
    s_waitcnt vmcnt(0)
    v_xor_b32 v219, s23, v207
    v_cmp_ne_u32 vcc, 0, v219
    s_nop 1
    s_cmp_eq_u64 vcc, 0
    s_cbranch_scc1 POLD_126
    s_sleep 4
    s_add_u32 s76, s76, 1
    s_cmp_lt_u32 s76, 0x40000
    s_cbranch_scc1 POLL_125
    s_mov_b32 s12, s66
    s_and_b32 s13, s67, 0xffff
    s_mov_b32 s14, 0x100
    s_mov_b32 s15, 0x20000
    v_mov_b32 v221, 7
    buffer_store_dword v221, off, s[12:15], 0
    s_waitcnt vmcnt(0)
POLD_126:
    v_mov_b32 v192, v204
    s_nop 1
    v_max_f32_dpp v192, v192, v192 quad_perm:[1,0,3,2] row_mask:0xf bank_mask:0xf
    s_nop 1
    v_max_f32_dpp v192, v192, v192 quad_perm:[2,3,0,1] row_mask:0xf bank_mask:0xf
    s_nop 1
    v_max_f32_dpp v192, v192, v192 row_half_mirror row_mask:0xf bank_mask:0xf
    s_nop 1
    v_max_f32_dpp v192, v192, v192 row_mirror row_mask:0xf bank_mask:0xf
    v_mov_b32 v194, v192
    s_nop 1
    v_permlane16_swap_b32 v192, v194
    v_max_f32 v192, v192, v194
    v_mov_b32 v194, v192
    s_nop 1
    v_permlane32_swap_b32 v192, v194
    v_max_f32 v192, v192, v194
    v_cmp_eq_f32 vcc, v192, v204
    s_nop 1
    s_ff1_i32_b64 s28, vcc
    s_nop 3
    v_readlane_b32 s41, v205, s28
    v_readlane_b32 s42, v204, s28
    v_mov_b32 v186, 158464
    v_mov_b32 v188, s41
    v_mov_b32 v189, s42
    ds_write_b64 v186, v[188:189]
    s_sub_u32 s3, s2, 8
    s_cmp_ge_u32 s3, 56
    s_cbranch_scc1 FROW_128
    s_lshr_b32 s25, s41, 8
    s_lshr_b32 s26, s41, 6
    s_and_b32 s26, s26, 3
    s_lshl_b32 s27, s26, 13
    s_lshl_b32 s28, s25, 7
    s_add_u32 s27, s27, s28
    s_add_u32 s31, s27, 0x29000
    v_and_b32 v186, 15, v1
    v_lshrrev_b32 v187, 1, v186
    v_and_b32 v186, 1, v186
    v_lshlrev_b32 v186, 2, v186
    v_lshl_add_u32 v215, v187, 10, v186
    buffer_load_dword v216, v215, s[8:11], s31 offen sc1
    s_waitcnt vmcnt(0)
    s_lshr_b32 s25, s41, 8
    s_lshr_b32 s26, s41, 6
    s_and_b32 s26, s26, 3
    s_lshl_b32 s27, s26, 13
    s_lshl_b32 s28, s25, 7
    s_add_u32 s27, s27, s28
    s_add_u32 s31, s27, 0x29000
    v_cmp_ne_u32 vcc, s23, v216
    s_nop 1
    s_cmp_eq_u64 vcc, 0
    s_cbranch_scc1 PND_129
    s_mov_b32 s76, 0
POLL_130:
    buffer_load_dword v216, v215, s[8:11], s31 offen sc1
    s_waitcnt vmcnt(0)
    v_xor_b32 v219, s23, v216
    v_cmp_ne_u32 vcc, 0, v219
    s_nop 1
    s_cmp_eq_u64 vcc, 0
    s_cbranch_scc1 POLD_131
    s_sleep 4
    s_add_u32 s76, s76, 1
    s_cmp_lt_u32 s76, 0x40000
    s_cbranch_scc1 POLL_130
    s_mov_b32 s12, s66
    s_and_b32 s13, s67, 0xffff
    s_mov_b32 s14, 0x100
    s_mov_b32 s15, 0x20000
    v_mov_b32 v221, 8
    buffer_store_dword v221, off, s[12:15], 0
    s_waitcnt vmcnt(0)
POLD_131:
PND_129:
    s_lshr_b32 s25, s41, 8
    s_and_b32 s26, s41, 255
    s_lshl_b32 s27, s25, 18
    s_lshl_b32 s28, s26, 7
    s_add_u32 s27, s27, s28
    s_add_u32 s27, s27, 0xf00000
    s_and_b32 s26, s26, 15
    s_lshr_b32 s26, s26, 1
    v_and_b32 v186, 7, v1
    v_xor_b32 v186, s26, v186
    v_lshlrev_b32 v186, 4, v186
    v_lshrrev_b32 v187, 3, v1
    v_lshl_add_u32 v186, v187, 15, v186
    buffer_load_dwordx4 v[200:203], v186, s[8:11], s27 offen sc1
    s_waitcnt vmcnt(0)
    v_lshlrev_b32 v188, 16, v200
    v_and_b32 v189, 0xffff0000, v200
    v_lshlrev_b32 v190, 16, v201
    v_and_b32 v191, 0xffff0000, v201
    v_lshlrev_b32 v192, 16, v202
    v_and_b32 v193, 0xffff0000, v202
    v_lshlrev_b32 v194, 16, v203
    v_and_b32 v195, 0xffff0000, v203
    v_add_f32 v196, v188, v189
    v_mul_f32 v197, v188, v188
    v_fmac_f32 v197, v189, v189
    v_add_f32 v196, v196, v190
    v_fmac_f32 v197, v190, v190
    v_add_f32 v196, v196, v191
    v_fmac_f32 v197, v191, v191
    v_add_f32 v196, v196, v192
    v_fmac_f32 v197, v192, v192
    v_add_f32 v196, v196, v193
    v_fmac_f32 v197, v193, v193
    v_add_f32 v196, v196, v194
    v_fmac_f32 v197, v194, v194
    v_add_f32 v196, v196, v195
    v_fmac_f32 v197, v195, v195
    s_nop 0
    v_add_f32_dpp v196, v196, v196 quad_perm:[1,0,3,2] row_mask:0xf bank_mask:0xf
    v_add_f32_dpp v197, v197, v197 quad_perm:[1,0,3,2] row_mask:0xf bank_mask:0xf
    s_nop 0
    v_add_f32_dpp v196, v196, v196 quad_perm:[2,3,0,1] row_mask:0xf bank_mask:0xf
    v_add_f32_dpp v197, v197, v197 quad_perm:[2,3,0,1] row_mask:0xf bank_mask:0xf
    s_nop 0
    v_add_f32_dpp v196, v196, v196 row_half_mirror row_mask:0xf bank_mask:0xf
    v_add_f32_dpp v197, v197, v197 row_half_mirror row_mask:0xf bank_mask:0xf
    s_nop 0
    v_add_f32_dpp v196, v196, v196 row_mirror row_mask:0xf bank_mask:0xf
    v_add_f32_dpp v197, v197, v197 row_mirror row_mask:0xf bank_mask:0xf
    v_mov_b32 v198, v196
    v_mov_b32 v199, v197
    s_nop 0
    v_permlane16_swap_b32 v196, v198
    v_permlane16_swap_b32 v197, v199
    v_add_f32 v196, v196, v198
    v_add_f32 v197, v197, v199
    v_mov_b32 v198, v196
    v_mov_b32 v199, v197
    s_nop 0
    v_permlane32_swap_b32 v196, v198
    v_permlane32_swap_b32 v197, v199
    v_add_f32 v196, v196, v198
    v_add_f32 v197, v197, v199
    s_mov_b32 s25, 0x3b000000
    s_mov_b32 s26, 0x3727c5ac
    v_mul_f32 v196, s25, v196
    v_mul_f32 v197, s25, v197
    v_fma_f32 v197, -v196, v196, v197
    v_add_f32 v197, s26, v197
    v_rsq_f32 v197, v197
    v_sub_f32 v188, v188, v196
    v_mul_f32 v188, v188, v197
    v_sub_f32 v189, v189, v196
    v_mul_f32 v189, v189, v197
    v_sub_f32 v190, v190, v196
    v_mul_f32 v190, v190, v197
    v_sub_f32 v191, v191, v196
    v_mul_f32 v191, v191, v197
    v_sub_f32 v192, v192, v196
    v_mul_f32 v192, v192, v197
    v_sub_f32 v193, v193, v196
    v_mul_f32 v193, v193, v197
    v_sub_f32 v194, v194, v196
    v_mul_f32 v194, v194, v197
    v_sub_f32 v195, v195, v196
    v_mul_f32 v195, v195, v197
    v_cvt_pk_bf16_f32 v200, v188, v189
    v_cvt_pk_bf16_f32 v201, v190, v191
    v_cvt_pk_bf16_f32 v202, v192, v193
    v_cvt_pk_bf16_f32 v203, v194, v195
    s_lshl_b32 s25, s22, 10
    s_add_u32 s25, s25, 158720
    v_add_u32 v186, s25, v7
    ds_write_b128 v186, v[200:203]
    v_lshlrev_b32 v186, 4, v25
    v_add_u32 v186, s25, v186
    s_waitcnt lgkmcnt(0)
FROW_128:
    s_cmp_lg_u32 s2, 0
    s_cbranch_scc1 NOE_133
    v_mov_b32 v220, s23
    s_mov_b64 exec, 1
    buffer_store_dword v220, off, s[8:11], 0 sc1
    s_mov_b64 exec, -1
NOE_133:
    s_waitcnt lgkmcnt(0)
FSEL_124:
    s_waitcnt vmcnt(0)
    s_barrier
    v_mov_b32 v186, 158464
    ds_read_b64 v[188:189], v186
    s_waitcnt lgkmcnt(0)
    v_readfirstlane_b32 s41, v188
    v_readfirstlane_b32 s42, v189
    s_sub_u32 s3, s2, 8
    s_cmp_ge_u32 s3, 56
    s_cbranch_scc1 NOFFN_134
    v_lshlrev_b32 v186, 4, v25
    v_add_u32 v186, 158720, v186
    ds_read_b128 v[40:43], v186 offset:0
    ds_read_b128 v[44:47], v186 offset:64
    ds_read_b128 v[48:51], v186 offset:128
    ds_read_b128 v[52:55], v186 offset:192
    ds_read_b128 v[56:59], v186 offset:256
    ds_read_b128 v[60:63], v186 offset:320
    ds_read_b128 v[64:67], v186 offset:384
    ds_read_b128 v[68:71], v186 offset:448
    ds_read_b128 v[72:75], v186 offset:512
    ds_read_b128 v[76:79], v186 offset:576
    ds_read_b128 v[80:83], v186 offset:640
    ds_read_b128 v[84:87], v186 offset:704
    ds_read_b128 v[88:91], v186 offset:768
    ds_read_b128 v[92:95], v186 offset:832
    ds_read_b128 v[96:99], v186 offset:896
    ds_read_b128 v[100:103], v186 offset:960
    s_waitcnt lgkmcnt(15)
    v_mfma_f32_16x16x32_bf16 v[188:191], a[192:195], v[40:43], 0
    s_waitcnt lgkmcnt(14)
    v_mfma_f32_16x16x32_bf16 v[188:191], a[196:199], v[44:47], v[188:191]
    s_waitcnt lgkmcnt(13)
    v_mfma_f32_16x16x32_bf16 v[188:191], a[200:203], v[48:51], v[188:191]
    s_waitcnt lgkmcnt(12)
    v_mfma_f32_16x16x32_bf16 v[188:191], a[204:207], v[52:55], v[188:191]
    s_waitcnt lgkmcnt(11)
    v_mfma_f32_16x16x32_bf16 v[188:191], a[208:211], v[56:59], v[188:191]
    s_waitcnt lgkmcnt(10)
    v_mfma_f32_16x16x32_bf16 v[188:191], a[212:215], v[60:63], v[188:191]
    s_waitcnt lgkmcnt(9)
    v_mfma_f32_16x16x32_bf16 v[188:191], a[216:219], v[64:67], v[188:191]
    s_waitcnt lgkmcnt(8)
    v_mfma_f32_16x16x32_bf16 v[188:191], a[220:223], v[68:71], v[188:191]
    s_waitcnt lgkmcnt(7)
    v_mfma_f32_16x16x32_bf16 v[188:191], a[224:227], v[72:75], v[188:191]
    s_waitcnt lgkmcnt(6)
    v_mfma_f32_16x16x32_bf16 v[188:191], a[228:231], v[76:79], v[188:191]
    s_waitcnt lgkmcnt(5)
    v_mfma_f32_16x16x32_bf16 v[188:191], a[232:235], v[80:83], v[188:191]
    s_waitcnt lgkmcnt(4)
    v_mfma_f32_16x16x32_bf16 v[188:191], a[236:239], v[84:87], v[188:191]
    s_waitcnt lgkmcnt(3)
    v_mfma_f32_16x16x32_bf16 v[188:191], a[240:243], v[88:91], v[188:191]
    s_waitcnt lgkmcnt(2)
    v_mfma_f32_16x16x32_bf16 v[188:191], a[244:247], v[92:95], v[188:191]
    s_waitcnt lgkmcnt(1)
    v_mfma_f32_16x16x32_bf16 v[188:191], a[248:251], v[96:99], v[188:191]
    s_waitcnt lgkmcnt(0)
    v_mfma_f32_16x16x32_bf16 v[188:191], a[252:255], v[100:103], v[188:191]
    s_lshl_b32 s25, s22, 6
    s_add_u32 s25, s25, 162816
    v_lshlrev_b32 v186, 4, v25
    v_add_u32 v186, s25, v186
    s_mov_b32 s28, 0x00010001
    s_mov_b32 s29, 0x00010001
    s_mov_b64 exec, s[28:29]
    s_nop 0
    ds_write_b128 v186, v[188:191]
    s_mov_b64 exec, -1
    s_waitcnt lgkmcnt(0)
    s_barrier
    v_lshlrev_b32 v186, 5, v25
    v_add_u32 v186, 162816, v186
    ds_read_b128 v[168:171], v186
    ds_read_b128 v[172:175], v186 offset:16
    ds_read_b128 v[176:179], v186 offset:128
    ds_read_b128 v[180:183], v186 offset:144
    s_mov_b32 s25, 0xbfb8aa3b
    v_mov_b32 v196, s42
    v_mul_f32 v196, s25, v196
    s_waitcnt lgkmcnt(0)
    v_mul_f32 v188, s25, v168
    v_mul_f32 v189, s25, v169
    v_mul_f32 v190, s25, v170
    v_mul_f32 v191, s25, v171
    v_mul_f32 v192, s25, v172
    v_mul_f32 v193, s25, v173
    v_mul_f32 v194, s25, v174
    v_mul_f32 v195, s25, v175
    v_exp_f32 v188, v188
    v_exp_f32 v189, v189
    v_exp_f32 v190, v190
    v_exp_f32 v191, v191
    v_exp_f32 v192, v192
    v_exp_f32 v193, v193
    v_exp_f32 v194, v194
    v_exp_f32 v195, v195
    v_exp_f32 v196, v196
    v_add_f32 v188, 1.0, v188
    v_add_f32 v189, 1.0, v189
    v_add_f32 v190, 1.0, v190
    v_add_f32 v191, 1.0, v191
    v_add_f32 v192, 1.0, v192
    v_add_f32 v193, 1.0, v193
    v_add_f32 v194, 1.0, v194
    v_add_f32 v195, 1.0, v195
    v_add_f32 v196, 1.0, v196
    v_rcp_f32 v188, v188
    v_rcp_f32 v189, v189
    v_rcp_f32 v190, v190
    v_rcp_f32 v191, v191
    v_rcp_f32 v192, v192
    v_rcp_f32 v193, v193
    v_rcp_f32 v194, v194
    v_rcp_f32 v195, v195
    v_rcp_f32 v196, v196
    v_mul_f32 v168, v168, v176
    v_mul_f32 v169, v169, v177
    v_mul_f32 v170, v170, v178
    v_mul_f32 v171, v171, v179
    v_mul_f32 v172, v172, v180
    v_mul_f32 v173, v173, v181
    v_mul_f32 v174, v174, v182
    v_mul_f32 v175, v175, v183
    v_mul_f32 v168, v168, v188
    v_mul_f32 v169, v169, v189
    v_mul_f32 v170, v170, v190
    v_mul_f32 v171, v171, v191
    v_mul_f32 v172, v172, v192
    v_mul_f32 v173, v173, v193
    v_mul_f32 v174, v174, v194
    v_mul_f32 v175, v175, v195
    v_cvt_pk_bf16_f32 v184, v168, v169
    v_cvt_pk_bf16_f32 v185, v170, v171
    v_cvt_pk_bf16_f32 v186, v172, v173
    v_cvt_pk_bf16_f32 v187, v174, v175
    s_nop 1
    v_mfma_f32_16x16x32_bf16 v[40:43], v[184:187], v[224:227], 0
    v_mfma_f32_16x16x32_bf16 v[44:47], v[184:187], v[228:231], 0
    v_mfma_f32_16x16x32_bf16 v[48:51], v[184:187], v[232:235], 0
    v_mfma_f32_16x16x32_bf16 v[52:55], v[184:187], v[236:239], 0
    v_mfma_f32_16x16x32_bf16 v[56:59], v[184:187], v[240:243], 0
    v_mfma_f32_16x16x32_bf16 v[60:63], v[184:187], v[244:247], 0
    v_mfma_f32_16x16x32_bf16 v[64:67], v[184:187], v[248:251], 0
    v_mfma_f32_16x16x32_bf16 v[68:71], v[184:187], v[252:255], 0
    v_cmp_le_u32 s[28:29], 1, v25
    v_cmp_le_u32 s[30:31], 2, v25
    v_cmp_le_u32 vcc, 3, v25
    v_cndmask_b32 v190, v40, v44, s[28:29]
    v_cndmask_b32 v190, v190, v48, s[30:31]
    v_cndmask_b32 v190, v190, v52, vcc
    v_mul_f32 v190, v196, v190
    v_cndmask_b32 v192, v56, v60, s[28:29]
    v_cndmask_b32 v192, v192, v64, s[30:31]
    v_cndmask_b32 v192, v192, v68, vcc
    v_mul_f32 v192, v196, v192
    s_lshl_b32 s25, s46, 12
    s_lshl_b32 s26, s22, 10
    s_add_u32 s25, s25, s26
    s_add_u32 s25, s25, 0x1100000
    v_lshlrev_b32 v186, 3, v1
    v_mov_b32 v191, s23
    v_mov_b32 v193, s23
    buffer_store_dwordx2 v[190:191], v186, s[8:11], s25 offen sc1
    buffer_store_dwordx2 v[192:193], v186, s[8:11], s25 offen offset:512 sc1
NOFFN_134:
    s_lshr_b32 s25, s41, 8
    s_cmp_lg_u32 s25, s20
    s_cbranch_scc1 NOOWN_135
    s_lshr_b32 s25, s41, 6
    s_and_b32 s25, s25, 3
    s_lshr_b32 s26, s21, 3
    s_cmp_lg_u32 s25, s26
    s_cbranch_scc1 NOOWN_135
    v_lshlrev_b32 v186, 3, v1
    s_lshl_b32 s25, s22, 12
    v_add_u32 v186, s25, v186
    s_and_b32 s25, s21, 7
    s_lshl_b32 s25, s25, 9
    s_add_u32 s25, s25, 0x1100000
    s_mov_b32 s76, 0
YTP_136:
    s_add_u32 s26, s25, 0
    buffer_load_dwordx2 v[40:41], v186, s[8:11], s26 offen sc1
    s_add_u32 s26, s25, 16384
    buffer_load_dwordx2 v[42:43], v186, s[8:11], s26 offen sc1
    s_add_u32 s26, s25, 32768
    buffer_load_dwordx2 v[44:45], v186, s[8:11], s26 offen sc1
    s_add_u32 s26, s25, 49152
    buffer_load_dwordx2 v[46:47], v186, s[8:11], s26 offen sc1
    s_add_u32 s26, s25, 65536
    buffer_load_dwordx2 v[48:49], v186, s[8:11], s26 offen sc1
    s_add_u32 s26, s25, 81920
    buffer_load_dwordx2 v[50:51], v186, s[8:11], s26 offen sc1
    s_add_u32 s26, s25, 98304
    buffer_load_dwordx2 v[52:53], v186, s[8:11], s26 offen sc1
    s_add_u32 s26, s25, 114688
    buffer_load_dwordx2 v[54:55], v186, s[8:11], s26 offen sc1
    s_add_u32 s26, s25, 131072
    buffer_load_dwordx2 v[56:57], v186, s[8:11], s26 offen sc1
    s_add_u32 s26, s25, 147456
    buffer_load_dwordx2 v[58:59], v186, s[8:11], s26 offen sc1
    s_add_u32 s26, s25, 163840
    buffer_load_dwordx2 v[60:61], v186, s[8:11], s26 offen sc1
    s_add_u32 s26, s25, 180224
    buffer_load_dwordx2 v[62:63], v186, s[8:11], s26 offen sc1
    s_add_u32 s26, s25, 196608
    buffer_load_dwordx2 v[64:65], v186, s[8:11], s26 offen sc1
    s_add_u32 s26, s25, 212992
    buffer_load_dwordx2 v[66:67], v186, s[8:11], s26 offen sc1
    s_waitcnt vmcnt(0)
    v_xor_b32 v219, s23, v41
    v_xor_b32 v218, s23, v43
    v_or_b32 v219, v219, v218
    v_xor_b32 v218, s23, v45
    v_or_b32 v219, v219, v218
    v_xor_b32 v218, s23, v47
    v_or_b32 v219, v219, v218
    v_xor_b32 v218, s23, v49
    v_or_b32 v219, v219, v218
    v_xor_b32 v218, s23, v51
    v_or_b32 v219, v219, v218
    v_xor_b32 v218, s23, v53
    v_or_b32 v219, v219, v218
    v_xor_b32 v218, s23, v55
    v_or_b32 v219, v219, v218
    v_xor_b32 v218, s23, v57
    v_or_b32 v219, v219, v218
    v_xor_b32 v218, s23, v59
    v_or_b32 v219, v219, v218
    v_xor_b32 v218, s23, v61
    v_or_b32 v219, v219, v218
    v_xor_b32 v218, s23, v63
    v_or_b32 v219, v219, v218
    v_xor_b32 v218, s23, v65
    v_or_b32 v219, v219, v218
    v_xor_b32 v218, s23, v67
    v_or_b32 v219, v219, v218
    v_cmp_ne_u32 vcc, 0, v219
    s_nop 1
    s_cmp_eq_u64 vcc, 0
    s_cbranch_scc1 YTD_137
    s_add_u32 s76, s76, 1
    s_cmp_lt_u32 s76, 0x40000
    s_cbranch_scc1 YTP_136
    s_mov_b32 s12, s66
    s_and_b32 s13, s67, 0xffff
    s_mov_b32 s14, 0x100
    s_mov_b32 s15, 0x20000
    v_mov_b32 v221, 13
    buffer_store_dword v221, off, s[12:15], 0
    s_waitcnt vmcnt(0)
YTD_137:
    v_add_f32 v40, v40, v42
    v_add_f32 v40, v40, v44
    v_add_f32 v40, v40, v46
    v_add_f32 v40, v40, v48
    v_add_f32 v40, v40, v50
    v_add_f32 v40, v40, v52
    v_add_f32 v40, v40, v54
    v_add_f32 v40, v40, v56
    v_add_f32 v40, v40, v58
    v_add_f32 v40, v40, v60
    v_add_f32 v40, v40, v62
    v_add_f32 v40, v40, v64
    v_add_f32 v40, v40, v66
    s_lshl_b32 s25, s22, 8
    s_add_u32 s25, s25, 158720
    v_lshlrev_b32 v186, 2, v1
    v_add_u32 v186, s25, v186
    ds_write_b32 v186, v40
    s_waitcnt lgkmcnt(0)
    s_barrier
    s_lshl_b32 s25, s22, 6
    s_add_u32 s25, s25, 158720
    v_lshlrev_b32 v186, 4, v25
    v_add_u32 v186, s25, v186
    ds_read_b128 v[196:199], v186 offset:0
    ds_read_b128 v[200:203], v186 offset:256
    ds_read_b128 v[204:207], v186 offset:512
    ds_read_b128 v[208:211], v186 offset:768
    s_waitcnt lgkmcnt(0)
    v_add_f32 v196, v196, v200
    v_add_f32 v197, v197, v201
    v_add_f32 v198, v198, v202
    v_add_f32 v199, v199, v203
    v_add_f32 v196, v196, v204
    v_add_f32 v197, v197, v205
    v_add_f32 v198, v198, v206
    v_add_f32 v199, v199, v207
    v_add_f32 v196, v196, v208
    v_add_f32 v197, v197, v209
    v_add_f32 v198, v198, v210
    v_add_f32 v199, v199, v211
    s_lshr_b32 s25, s41, 4
    s_and_b32 s25, s25, 3
    v_mov_b32 v188, v152
    v_mov_b32 v189, v153
    v_mov_b32 v190, v154
    v_mov_b32 v191, v155
    s_cmp_eq_u32 s25, 1
    s_cselect_b64 vcc, -1, 0
    v_cndmask_b32 v188, v188, v156, vcc
    v_cndmask_b32 v189, v189, v157, vcc
    v_cndmask_b32 v190, v190, v158, vcc
    v_cndmask_b32 v191, v191, v159, vcc
    s_cmp_eq_u32 s25, 2
    s_cselect_b64 vcc, -1, 0
    v_cndmask_b32 v188, v188, v160, vcc
    v_cndmask_b32 v189, v189, v161, vcc
    v_cndmask_b32 v190, v190, v162, vcc
    v_cndmask_b32 v191, v191, v163, vcc
    s_cmp_eq_u32 s25, 3
    s_cselect_b64 vcc, -1, 0
    v_cndmask_b32 v188, v188, v164, vcc
    v_cndmask_b32 v189, v189, v165, vcc
    v_cndmask_b32 v190, v190, v166, vcc
    v_cndmask_b32 v191, v191, v167, vcc
    v_add_f32 v188, v188, v196
    v_add_f32 v189, v189, v197
    v_add_f32 v190, v190, v198
    v_add_f32 v191, v191, v199
    v_cvt_pk_bf16_f32 v192, v188, v189
    v_cvt_pk_bf16_f32 v193, v190, v191
    s_and_b32 s25, s41, 63
    s_lshl_b32 s25, s25, 10
    s_add_u32 s25, s25, s37
    s_lshl_b32 s26, s22, 5
    s_add_u32 s25, s25, s26
    v_lshlrev_b32 v186, 3, v25
    s_and_b32 s26, s41, 15
    v_cmp_eq_u32 vcc, s26, v13
    s_nop 1
    s_and_saveexec_b64 s[28:29], vcc
    buffer_store_dwordx2 v[192:193], v186, s[16:19], s25 offen sc1
    s_mov_b64 exec, -1
NOOWN_135:
K_END:
    s_endpgm
.section .rodata,"a"
.p2align 6
.amdhsa_kernel interleave_layers__sliding_block__moe_arch_mod__prompt_kernel
  .amdhsa_next_free_vgpr 512
  .amdhsa_next_free_sgpr 100
  .amdhsa_accum_offset 256
  .amdhsa_group_segment_fixed_size 0
  .amdhsa_kernarg_size 88
  .amdhsa_user_sgpr_count 2
  .amdhsa_user_sgpr_kernarg_segment_ptr 1
  .amdhsa_system_sgpr_workgroup_id_x 1
  .amdhsa_float_denorm_mode_32 3
.end_amdhsa_kernel
```
